```python
import torch

def _softmax(x, axis=-1):
    return torch.softmax(x, dim=axis)
def _gelu(x):
    return torch.nn.functional.gelu(x, approximate="tanh")
def _silu(x):
    return torch.nn.functional.silu(x)
def _sigmoid(x):
    return torch.sigmoid(x)
def _layernorm(x, axis=-1, eps=1e-5):
    m = x.mean(dim=axis, keepdim=True)
    v = x.var(dim=axis, keepdim=True, unbiased=False)
    return (x - m) / torch.sqrt(v + eps)
def _scatter_add(tgt, idx, src, axis=0):
    return tgt.clone().index_add_(axis, idx, src)
def _segment_sum(src, seg, n):
    out = torch.zeros((n,) + src.shape[1:], dtype=src.dtype)
    return out.index_add_(0, seg, src)
def _pad(x, pw):
    flat = tuple(v for pair in reversed(pw) for v in pair)
    return torch.nn.functional.pad(x, flat)

kernel_name = 'sequential_preLN__softmax_full_mha__glu_gated_bilinear__prompt'

def setup_inputs():

    _w = (lambda a: (lambda t: t.to(torch.bfloat16) if t.is_floating_point() else t)(torch.as_tensor(a)))
    def _A_setup():
        B, S, D = 1, 2048, 576
        return {
            "x": _w((lambda *s: torch.randn(*s, dtype=torch.bfloat16) * 0.05)(B, S, D)),
            "wqkv": _w((lambda *s: torch.randn(*s, dtype=torch.bfloat16) * 0.05)(D, 3 * D)),
            "wo": _w((lambda *s: torch.randn(*s, dtype=torch.bfloat16) * 0.05)(D, D)),
        }
    _A_in = _A_setup()

    def _B_setup():
        B, S, D, F = 1, 2048, 576, 4608
        return {
            "x": _w((lambda *s: torch.randn(*s, dtype=torch.bfloat16) * 0.05)(B, S, D)),
            "w_gate": _w((lambda *s: torch.randn(*s, dtype=torch.bfloat16) * 0.4)(D, F) * (D ** -0.5)),
            "w_up": _w((lambda *s: torch.randn(*s, dtype=torch.bfloat16) * 0.4)(D, F) * (D ** -0.5)),
            "w_down": _w((lambda *s: torch.randn(*s, dtype=torch.bfloat16) * 0.4)(F, D) * (F ** -0.5)),
        }
    _B_in = _B_setup()

    return {
        "A_x": _A_in["x"],
        "A_wqkv": _A_in["wqkv"],
        "A_wo": _A_in["wo"],
        "B_x": _B_in["x"],
        "B_w_gate": _B_in["w_gate"],
        "B_w_up": _B_in["w_up"],
        "B_w_down": _B_in["w_down"],
    }

def reference(A_x, A_wqkv, A_wo, B_x, B_w_gate, B_w_up, B_w_down):
    def _A_ref(x, wqkv, wo):
        B, S, D = x.shape
        H = 32; Dh = D // H
        qkv = (lambda x, *d: x.permute(*d))((x @ wqkv).reshape(B, S, 3, H, Dh), 2, 0, 3, 1, 4)
        q, k, v = qkv[0], qkv[1], qkv[2]
        scale = Dh ** -0.5
        scores = torch.einsum("bhqd,bhkd->bhqk", q, k) * scale
        p = _softmax(scores, axis=-1)
        o = torch.einsum("bhqk,bhkd->bhqd", p, v)
        return (lambda x, *d: x.permute(*d))(o, 0, 2, 1, 3).reshape(B, S, D) @ wo

    def _B_ref(x, w_gate, w_up, w_down):
        g = torch.einsum("bsd,df->bsf", x, w_gate)
        u = torch.einsum("bsd,df->bsf", x, w_up)
        h = g * u
        return torch.einsum("bsf,fd->bsd", h, w_down)

    x = A_x
    h = x + _A_ref(_layernorm(x, axis=-1), A_wqkv, A_wo)
    h2 = h + _B_ref(_layernorm(h, axis=-1), B_w_gate, B_w_up, B_w_down)
    return h2
```

```asm
; @launch grid=(256,1,1) block=(512,1,1) lds=163840
.amdgcn_target "amdgcn-amd-amdhsa--gfx950"
.text
.globl sequential_preLN__softmax_full_mha__glu_gated_bilinear__prompt_kernel
.p2align 8
.type sequential_preLN__softmax_full_mha__glu_gated_bilinear__prompt_kernel,@function
sequential_preLN__softmax_full_mha__glu_gated_bilinear__prompt_kernel:
    s_load_dwordx4 s[4:7], s[0:1], 0
    s_load_dwordx2 s[8:9], s[0:1], 72
    s_load_dwordx2 s[56:57], s[0:1], 64
    s_load_dwordx2 s[10:11], s[0:1], 16
    s_load_dwordx4 s[40:43], s[0:1], 32
    s_load_dwordx4 s[44:47], s[0:1], 48
    s_cmp_ge_u32 s2, 256
    s_cbranch_scc1 L_exit
    v_lshrrev_b32 v1, 6, v0
    v_and_b32 v0, 63, v0
    v_readfirstlane_b32 s24, v1
    v_and_b32 v5, 15, v0
    v_lshrrev_b32 v6, 4, v0
    s_mov_b32 s35, 0x3f803f80
    s_cmp_ge_u32 s2, 192
    s_cbranch_scc1 LA_rvec
    s_and_b32 s33, s2, 3
    s_lshl_b32 s27, s33, 2
    s_lshr_b32 s33, s2, 3
    s_and_b32 s34, s33, 3
    s_add_u32 s27, s27, s34
    s_lshr_b32 s28, s33, 2
    s_bfe_u32 s33, s2, 0x10002
    s_mul_i32 s33, s33, 6
    s_add_u32 s28, s28, s33
    s_and_b32 s25, s24, 3
    s_lshr_b32 s26, s24, 2
    v_lshrrev_b32 v1, 3, v0
    v_mul_u32_u24 v1, 1152, v1
    v_and_b32 v2, 7, v0
    v_xor_b32 v2, v2, v6
    v_lshl_add_u32 v7, v2, 4, v1
    v_xor_b32 v2, 4, v2
    v_lshl_add_u32 v8, v2, 4, v1
    v_add_u32 v8, 8192, v8
    s_lshl_b32 s29, s27, 3
    s_add_u32 s29, s29, s24
    s_mul_i32 s29, s29, 18432
    s_lshl_b32 s31, s24, 11
    s_mul_i32 s32, s24, 2304
    s_add_u32 s32, s32, 16384
    s_lshr_b32 s33, s24, 1
    s_lshl_b32 s33, s33, 2
    s_and_b32 s34, s24, 1
    s_add_u32 s33, s33, s34
    s_mul_i32 s30, s33, 13824
    s_mul_i32 s33, s28, 288
    s_add_u32 s30, s30, s33
    v_add_u32 v1, 0, v0
    v_mul_u32_u24 v2, 3641, v1
    v_lshrrev_b32 v2, 16, v2
    v_mul_u32_u24 v3, 18, v2
    v_sub_u32 v1, v1, v3
    v_and_b32 v3, 4, v2
    v_add_u32 v2, v2, v3
    v_mul_u32_u24 v2, 3456, v2
    v_lshl_add_u32 v9, v1, 4, v2
    v_add_u32 v1, 64, v0
    v_mul_u32_u24 v2, 3641, v1
    v_lshrrev_b32 v2, 16, v2
    v_mul_u32_u24 v3, 18, v2
    v_sub_u32 v1, v1, v3
    v_and_b32 v3, 4, v2
    v_add_u32 v2, v2, v3
    v_mul_u32_u24 v2, 3456, v2
    v_lshl_add_u32 v10, v1, 4, v2
    v_subrev_u32 v10, 1024, v10
    v_add_u32 v1, 128, v0
    v_mul_u32_u24 v2, 3641, v1
    v_lshrrev_b32 v2, 16, v2
    v_mul_u32_u24 v3, 18, v2
    v_sub_u32 v1, v1, v3
    v_and_b32 v3, 4, v2
    v_add_u32 v2, v2, v3
    v_mul_u32_u24 v2, 3456, v2
    v_lshl_add_u32 v11, v1, 4, v2
    v_subrev_u32 v11, 2048, v11
    s_waitcnt lgkmcnt(0)
    s_mov_b32 s20, s4
    s_mov_b32 s21, s5
    s_mov_b32 s22, 2359296
    s_mov_b32 s23, 0x20000
    s_mov_b32 s16, s6
    s_mov_b32 s17, s7
    s_mov_b32 s18, 1990656
    s_mov_b32 s19, 0x20000
    s_mov_b32 s12, s8
    s_mov_b32 s13, s9
    s_mov_b32 s14, 67108864
    s_mov_b32 s15, 0x20000
    s_add_u32 m0, s31, 0
    s_add_u32 s61, s29, 0
    buffer_load_dwordx4 v7, s[20:23], s61 offen lds
    buffer_load_dwordx4 v8, s[20:23], s61 offen offset:1024 lds
    s_add_u32 m0, s32, 0
    s_add_u32 s61, s30, 0
    buffer_load_dwordx4 v9, s[16:19], s61 offen lds
    buffer_load_dwordx4 v10, s[16:19], s61 offen offset:1024 lds
    s_mov_b64 exec, 0xffff
    buffer_load_dwordx4 v11, s[16:19], s61 offen offset:2048 lds
    s_mov_b64 exec, -1
    v_lshrrev_b32 v2, 1, v5
    v_xor_b32 v1, v6, v2
    v_lshlrev_b32 v1, 4, v1
    v_lshl_add_u32 v1, v5, 7, v1
    s_lshl_b32 s33, s25, 12
    s_lshl_b32 s34, s26, 11
    s_add_u32 s33, s33, s34
    v_add_u32 v12, s33, v1
    v_xor_b32 v13, 2048, v12
    v_xor_b32 v14, 64, v12
    v_xor_b32 v15, 64, v13
    v_lshrrev_b32 v1, 5, v0
    v_lshlrev_b32 v1, 4, v1
    v_bfe_u32 v2, v0, 2, 3
    v_add_u32 v1, v1, v2
    v_mul_u32_u24 v1, 288, v1
    v_add_u32 v1, 16384, v1
    v_and_b32 v2, 3, v0
    v_lshl_add_u32 v3, v2, 3, v1
    s_mul_i32 s33, s26, 144
    v_add_u32 v20, s33, v3
    v_mul_u32_u24 v2, 72, v2
    v_add3_u32 v21, v1, v2, 32
    s_barrier
    s_add_u32 m0, s31, 34816
    s_add_u32 s61, s29, 128
    buffer_load_dwordx4 v7, s[20:23], s61 offen lds
    buffer_load_dwordx4 v8, s[20:23], s61 offen offset:1024 lds
    s_add_u32 m0, s32, 34816
    s_add_u32 s61, s30, 221184
    buffer_load_dwordx4 v9, s[16:19], s61 offen lds
    buffer_load_dwordx4 v10, s[16:19], s61 offen offset:1024 lds
    s_mov_b64 exec, 0xffff
    buffer_load_dwordx4 v11, s[16:19], s61 offen offset:2048 lds
    s_mov_b64 exec, -1
    v_add_u32 v16, 69632, v12
    v_add_u32 v17, 69632, v13
    v_add_u32 v18, 69632, v14
    v_add_u32 v19, 69632, v15
    v_add_u32 v22, 69632, v20
    v_add_u32 v23, 69632, v21
    v_mov_b32 v221, 0
    s_mov_b32 s60, 0x20000
    s_waitcnt vmcnt(5)
    s_barrier
    ds_read_b128 v[60:63], v12 offset:0
    ds_read_b128 v[68:71], v14 offset:0
    ds_read_b64_tr_b16 v[124:125], v21 offset:0
    ds_read_b64_tr_b16 v[126:127], v21 offset:2304
    ds_read_b64_tr_b16 v[128:129], v21 offset:9216
    ds_read_b64_tr_b16 v[130:131], v21 offset:11520
    ds_read_b64_tr_b16 v[92:93], v20 offset:0
    ds_read_b64_tr_b16 v[94:95], v20 offset:2304
    ds_read_b64_tr_b16 v[96:97], v20 offset:9216
    ds_read_b64_tr_b16 v[98:99], v20 offset:11520
    ds_read_b128 v[64:67], v13 offset:0
    ds_read_b128 v[72:75], v15 offset:0
    ds_read_b64_tr_b16 v[100:101], v20 offset:40
    ds_read_b64_tr_b16 v[102:103], v20 offset:2344
    ds_read_b64_tr_b16 v[104:105], v20 offset:9256
    ds_read_b64_tr_b16 v[106:107], v20 offset:11560
    ds_read_b64_tr_b16 v[108:109], v20 offset:72
    ds_read_b64_tr_b16 v[110:111], v20 offset:2376
    ds_read_b64_tr_b16 v[112:113], v20 offset:9288
    ds_read_b64_tr_b16 v[114:115], v20 offset:11592
    ds_read_b64_tr_b16 v[116:117], v20 offset:112
    ds_read_b64_tr_b16 v[118:119], v20 offset:2416
    ds_read_b64_tr_b16 v[120:121], v20 offset:9328
    ds_read_b64_tr_b16 v[122:123], v20 offset:11632
    s_add_u32 m0, s31, 69632
    s_add_u32 s61, s29, 256
    buffer_load_dwordx4 v7, s[20:23], s61 offen lds
    buffer_load_dwordx4 v8, s[20:23], s61 offen offset:1024 lds
    s_add_u32 m0, s32, 69632
    s_add_u32 s61, s30, 442368
    buffer_load_dwordx4 v9, s[16:19], s61 offen lds
    buffer_load_dwordx4 v10, s[16:19], s61 offen offset:1024 lds
    s_mov_b64 exec, 0xffff
    buffer_load_dwordx4 v11, s[16:19], s61 offen offset:2048 lds
    s_mov_b64 exec, -1
    s_lshl_b32 s36, s27, 7
    s_lshl_b32 s33, s25, 5
    s_add_u32 s36, s36, s33
    s_lshl_b32 s33, s26, 4
    s_add_u32 s36, s36, s33
    s_and_b32 s37, s36, 127
    s_lshl_b32 s37, s37, 2
    s_add_u32 s37, s37, 139264
    s_lshl_b32 s38, s27, 9
    s_add_u32 s38, s38, 54493184
    s_bfe_u32 s33, s24, 0x10001
    s_mul_i32 s33, s33, 7680
    s_add_u32 s38, s38, s33
    s_mul_i32 s39, s28, 576
    s_add_u32 s39, s39, 54508544
    s_cmp_ge_u32 s24, 4
    s_cselect_b32 s38, s39, s38
    s_lshl_b32 s33, s24, 8
    s_add_u32 s38, s38, s33
    s_add_u32 s39, s33, 139264
    s_mul_i32 s50, s26, 288
    s_add_u32 s50, s50, 140288
    s_lshl_b32 s55, s28, 4
    s_add_u32 s55, s55, s27
    s_and_b32 s51, s28, 3
    s_mul_i32 s51, s51, 1179648
    s_lshl_b32 s52, s27, 2
    s_add_u32 s52, s52, s25
    s_cmp_ge_u32 s28, 8
    s_cbranch_scc1 LA_vmain
    s_waitcnt lgkmcnt(15)
    v_mfma_f32_16x16x32_bf16 v[56:59], v[124:127], v[60:63], 0
    s_setprio 3
    s_waitcnt vmcnt(5)
    s_barrier
    ds_read_b128 v[76:79], v12 offset:34816
    ds_read_b128 v[84:87], v14 offset:34816
    v_mfma_f32_16x16x32_bf16 v[56:59], v[128:131], v[68:71], v[56:59]
    ds_read_b64_tr_b16 v[164:165], v21 offset:34816
    s_waitcnt lgkmcnt(15)
    v_mfma_f32_16x16x32_bf16 v[24:27], v[92:95], v[60:63], 0
    ds_read_b64_tr_b16 v[166:167], v21 offset:37120
    s_add_u32 m0, s31, 104448
    s_add_u32 s61, s29, 384
    buffer_load_dwordx4 v7, s[20:23], s61 offen lds
    v_mfma_f32_16x16x32_bf16 v[24:27], v[96:99], v[68:71], v[24:27]
    ds_read_b64_tr_b16 v[168:169], v21 offset:44032
    ds_read_b64_tr_b16 v[170:171], v21 offset:46336
    s_waitcnt lgkmcnt(15)
    v_mfma_f32_16x16x32_bf16 v[40:43], v[92:95], v[64:67], 0
    ds_read_b64_tr_b16 v[132:133], v20 offset:34816
    v_mfma_f32_16x16x32_bf16 v[40:43], v[96:99], v[72:75], v[40:43]
    s_setprio 2
    ds_read_b64_tr_b16 v[134:135], v20 offset:37120
    buffer_load_dwordx4 v8, s[20:23], s61 offen offset:1024 lds
    s_waitcnt lgkmcnt(15)
    v_mfma_f32_16x16x32_bf16 v[28:31], v[100:103], v[60:63], 0
    ds_read_b64_tr_b16 v[136:137], v20 offset:44032
    ds_read_b64_tr_b16 v[138:139], v20 offset:46336
    v_mfma_f32_16x16x32_bf16 v[28:31], v[104:107], v[68:71], v[28:31]
    ds_read_b128 v[80:83], v13 offset:34816
    v_mfma_f32_16x16x32_bf16 v[44:47], v[100:103], v[64:67], 0
    ds_read_b128 v[88:91], v15 offset:34816
    s_add_u32 m0, s32, 104448
    s_add_u32 s61, s30, 663552
    buffer_load_dwordx4 v9, s[16:19], s61 offen lds
    v_mfma_f32_16x16x32_bf16 v[44:47], v[104:107], v[72:75], v[44:47]
    s_setprio 1
    ds_read_b64_tr_b16 v[140:141], v20 offset:34856
    ds_read_b64_tr_b16 v[142:143], v20 offset:37160
    s_waitcnt lgkmcnt(15)
    v_mfma_f32_16x16x32_bf16 v[32:35], v[108:111], v[60:63], 0
    ds_read_b64_tr_b16 v[144:145], v20 offset:44072
    v_mfma_f32_16x16x32_bf16 v[32:35], v[112:115], v[68:71], v[32:35]
    ds_read_b64_tr_b16 v[146:147], v20 offset:46376
    buffer_load_dwordx4 v10, s[16:19], s61 offen offset:1024 lds
    v_mfma_f32_16x16x32_bf16 v[48:51], v[108:111], v[64:67], 0
    ds_read_b64_tr_b16 v[148:149], v20 offset:34888
    ds_read_b64_tr_b16 v[150:151], v20 offset:37192
    v_mfma_f32_16x16x32_bf16 v[48:51], v[112:115], v[72:75], v[48:51]
    ds_read_b64_tr_b16 v[152:153], v20 offset:44104
    s_waitcnt lgkmcnt(15)
    v_mfma_f32_16x16x32_bf16 v[36:39], v[116:119], v[60:63], 0
    s_setprio 0
    ds_read_b64_tr_b16 v[154:155], v20 offset:46408
    s_mov_b64 exec, 0xffff
    buffer_load_dwordx4 v11, s[16:19], s61 offen offset:2048 lds
    s_mov_b64 exec, -1
    v_mfma_f32_16x16x32_bf16 v[36:39], v[120:123], v[68:71], v[36:39]
    ds_read_b64_tr_b16 v[156:157], v20 offset:34928
    ds_read_b64_tr_b16 v[158:159], v20 offset:37232
    v_mfma_f32_16x16x32_bf16 v[52:55], v[116:119], v[64:67], 0
    ds_read_b64_tr_b16 v[160:161], v20 offset:44144
    v_mfma_f32_16x16x32_bf16 v[52:55], v[120:123], v[72:75], v[52:55]
    ds_read_b64_tr_b16 v[162:163], v20 offset:46448
    s_waitcnt lgkmcnt(15)
    v_mfma_f32_16x16x32_bf16 v[56:59], v[164:167], v[76:79], v[56:59]
    s_setprio 3
    s_waitcnt vmcnt(5)
    s_barrier
    ds_read_b128 v[60:63], v16 offset:0
    ds_read_b128 v[68:71], v18 offset:0
    v_mfma_f32_16x16x32_bf16 v[56:59], v[168:171], v[84:87], v[56:59]
    ds_read_b64_tr_b16 v[124:125], v23 offset:0
    s_waitcnt lgkmcnt(15)
    v_mfma_f32_16x16x32_bf16 v[24:27], v[132:135], v[76:79], v[24:27]
    ds_read_b64_tr_b16 v[126:127], v23 offset:2304
    s_add_u32 m0, s31, 0
    s_add_u32 s61, s29, 512
    buffer_load_dwordx4 v7, s[20:23], s61 offen lds
    v_mfma_f32_16x16x32_bf16 v[24:27], v[136:139], v[84:87], v[24:27]
    ds_read_b64_tr_b16 v[128:129], v23 offset:9216
    ds_read_b64_tr_b16 v[130:131], v23 offset:11520
    s_waitcnt lgkmcnt(15)
    v_mfma_f32_16x16x32_bf16 v[40:43], v[132:135], v[80:83], v[40:43]
    ds_read_b64_tr_b16 v[92:93], v22 offset:0
    v_mfma_f32_16x16x32_bf16 v[40:43], v[136:139], v[88:91], v[40:43]
    s_setprio 2
    ds_read_b64_tr_b16 v[94:95], v22 offset:2304
    buffer_load_dwordx4 v8, s[20:23], s61 offen offset:1024 lds
    s_waitcnt lgkmcnt(15)
    v_mfma_f32_16x16x32_bf16 v[28:31], v[140:143], v[76:79], v[28:31]
    ds_read_b64_tr_b16 v[96:97], v22 offset:9216
    ds_read_b64_tr_b16 v[98:99], v22 offset:11520
    v_mfma_f32_16x16x32_bf16 v[28:31], v[144:147], v[84:87], v[28:31]
    ds_read_b128 v[64:67], v17 offset:0
    v_mfma_f32_16x16x32_bf16 v[44:47], v[140:143], v[80:83], v[44:47]
    ds_read_b128 v[72:75], v19 offset:0
    s_add_u32 m0, s32, 0
    s_add_u32 s61, s30, 884736
    buffer_load_dwordx4 v9, s[16:19], s61 offen lds
    v_mfma_f32_16x16x32_bf16 v[44:47], v[144:147], v[88:91], v[44:47]
    s_setprio 1
    ds_read_b64_tr_b16 v[100:101], v22 offset:40
    ds_read_b64_tr_b16 v[102:103], v22 offset:2344
    s_waitcnt lgkmcnt(15)
    v_mfma_f32_16x16x32_bf16 v[32:35], v[148:151], v[76:79], v[32:35]
    ds_read_b64_tr_b16 v[104:105], v22 offset:9256
    v_mfma_f32_16x16x32_bf16 v[32:35], v[152:155], v[84:87], v[32:35]
    ds_read_b64_tr_b16 v[106:107], v22 offset:11560
    buffer_load_dwordx4 v10, s[16:19], s61 offen offset:1024 lds
    v_mfma_f32_16x16x32_bf16 v[48:51], v[148:151], v[80:83], v[48:51]
    ds_read_b64_tr_b16 v[108:109], v22 offset:72
    ds_read_b64_tr_b16 v[110:111], v22 offset:2376
    v_mfma_f32_16x16x32_bf16 v[48:51], v[152:155], v[88:91], v[48:51]
    ds_read_b64_tr_b16 v[112:113], v22 offset:9288
    s_waitcnt lgkmcnt(15)
    v_mfma_f32_16x16x32_bf16 v[36:39], v[156:159], v[76:79], v[36:39]
    s_setprio 0
    ds_read_b64_tr_b16 v[114:115], v22 offset:11592
    s_mov_b64 exec, 0xffff
    buffer_load_dwordx4 v11, s[16:19], s61 offen offset:2048 lds
    s_mov_b64 exec, -1
    v_mfma_f32_16x16x32_bf16 v[36:39], v[160:163], v[84:87], v[36:39]
    ds_read_b64_tr_b16 v[116:117], v22 offset:112
    ds_read_b64_tr_b16 v[118:119], v22 offset:2416
    v_mfma_f32_16x16x32_bf16 v[52:55], v[156:159], v[80:83], v[52:55]
    ds_read_b64_tr_b16 v[120:121], v22 offset:9328
    v_mfma_f32_16x16x32_bf16 v[52:55], v[160:163], v[88:91], v[52:55]
    ds_read_b64_tr_b16 v[122:123], v22 offset:11632
    s_waitcnt lgkmcnt(15)
    v_mfma_f32_16x16x32_bf16 v[56:59], v[124:127], v[60:63], v[56:59]
    s_setprio 3
    s_waitcnt vmcnt(5)
    s_barrier
    ds_read_b128 v[76:79], v16 offset:34816
    ds_read_b128 v[84:87], v18 offset:34816
    v_mfma_f32_16x16x32_bf16 v[56:59], v[128:131], v[68:71], v[56:59]
    ds_read_b64_tr_b16 v[164:165], v23 offset:34816
    s_waitcnt lgkmcnt(15)
    v_mfma_f32_16x16x32_bf16 v[24:27], v[92:95], v[60:63], v[24:27]
    ds_read_b64_tr_b16 v[166:167], v23 offset:37120
    s_add_u32 m0, s31, 34816
    s_add_u32 s61, s29, 640
    buffer_load_dwordx4 v7, s[20:23], s61 offen lds
    v_mfma_f32_16x16x32_bf16 v[24:27], v[96:99], v[68:71], v[24:27]
    ds_read_b64_tr_b16 v[168:169], v23 offset:44032
    ds_read_b64_tr_b16 v[170:171], v23 offset:46336
    s_waitcnt lgkmcnt(15)
    v_mfma_f32_16x16x32_bf16 v[40:43], v[92:95], v[64:67], v[40:43]
    ds_read_b64_tr_b16 v[132:133], v22 offset:34816
    v_mfma_f32_16x16x32_bf16 v[40:43], v[96:99], v[72:75], v[40:43]
    s_setprio 2
    ds_read_b64_tr_b16 v[134:135], v22 offset:37120
    buffer_load_dwordx4 v8, s[20:23], s61 offen offset:1024 lds
    s_waitcnt lgkmcnt(15)
    v_mfma_f32_16x16x32_bf16 v[28:31], v[100:103], v[60:63], v[28:31]
    ds_read_b64_tr_b16 v[136:137], v22 offset:44032
    ds_read_b64_tr_b16 v[138:139], v22 offset:46336
    v_mfma_f32_16x16x32_bf16 v[28:31], v[104:107], v[68:71], v[28:31]
    ds_read_b128 v[80:83], v17 offset:34816
    v_mfma_f32_16x16x32_bf16 v[44:47], v[100:103], v[64:67], v[44:47]
    ds_read_b128 v[88:91], v19 offset:34816
    s_add_u32 m0, s32, 34816
    s_add_u32 s61, s30, 1105920
    buffer_load_dwordx4 v9, s[16:19], s61 offen lds
    v_mfma_f32_16x16x32_bf16 v[44:47], v[104:107], v[72:75], v[44:47]
    s_setprio 1
    ds_read_b64_tr_b16 v[140:141], v22 offset:34856
    ds_read_b64_tr_b16 v[142:143], v22 offset:37160
    s_waitcnt lgkmcnt(15)
    v_mfma_f32_16x16x32_bf16 v[32:35], v[108:111], v[60:63], v[32:35]
    ds_read_b64_tr_b16 v[144:145], v22 offset:44072
    v_mfma_f32_16x16x32_bf16 v[32:35], v[112:115], v[68:71], v[32:35]
    ds_read_b64_tr_b16 v[146:147], v22 offset:46376
    buffer_load_dwordx4 v10, s[16:19], s61 offen offset:1024 lds
    v_mfma_f32_16x16x32_bf16 v[48:51], v[108:111], v[64:67], v[48:51]
    ds_read_b64_tr_b16 v[148:149], v22 offset:34888
    ds_read_b64_tr_b16 v[150:151], v22 offset:37192
    v_mfma_f32_16x16x32_bf16 v[48:51], v[112:115], v[72:75], v[48:51]
    ds_read_b64_tr_b16 v[152:153], v22 offset:44104
    s_waitcnt lgkmcnt(15)
    v_mfma_f32_16x16x32_bf16 v[36:39], v[116:119], v[60:63], v[36:39]
    s_setprio 0
    ds_read_b64_tr_b16 v[154:155], v22 offset:46408
    s_mov_b64 exec, 0xffff
    buffer_load_dwordx4 v11, s[16:19], s61 offen offset:2048 lds
    s_mov_b64 exec, -1
    v_mfma_f32_16x16x32_bf16 v[36:39], v[120:123], v[68:71], v[36:39]
    ds_read_b64_tr_b16 v[156:157], v22 offset:34928
    ds_read_b64_tr_b16 v[158:159], v22 offset:37232
    v_mfma_f32_16x16x32_bf16 v[52:55], v[116:119], v[64:67], v[52:55]
    ds_read_b64_tr_b16 v[160:161], v22 offset:44144
    v_mfma_f32_16x16x32_bf16 v[52:55], v[120:123], v[72:75], v[52:55]
    ds_read_b64_tr_b16 v[162:163], v22 offset:46448
    s_waitcnt lgkmcnt(15)
    v_mfma_f32_16x16x32_bf16 v[56:59], v[164:167], v[76:79], v[56:59]
    s_setprio 3
    s_waitcnt vmcnt(5)
    s_barrier
    ds_read_b128 v[60:63], v12 offset:0
    ds_read_b128 v[68:71], v14 offset:0
    v_mfma_f32_16x16x32_bf16 v[56:59], v[168:171], v[84:87], v[56:59]
    ds_read_b64_tr_b16 v[124:125], v21 offset:0
    s_waitcnt lgkmcnt(15)
    v_mfma_f32_16x16x32_bf16 v[24:27], v[132:135], v[76:79], v[24:27]
    ds_read_b64_tr_b16 v[126:127], v21 offset:2304
    s_add_u32 m0, s31, 69632
    s_add_u32 s61, s29, 768
    buffer_load_dwordx4 v7, s[20:23], s61 offen lds
    v_mfma_f32_16x16x32_bf16 v[24:27], v[136:139], v[84:87], v[24:27]
    ds_read_b64_tr_b16 v[128:129], v21 offset:9216
    ds_read_b64_tr_b16 v[130:131], v21 offset:11520
    s_waitcnt lgkmcnt(15)
    v_mfma_f32_16x16x32_bf16 v[40:43], v[132:135], v[80:83], v[40:43]
    ds_read_b64_tr_b16 v[92:93], v20 offset:0
    v_mfma_f32_16x16x32_bf16 v[40:43], v[136:139], v[88:91], v[40:43]
    s_setprio 2
    ds_read_b64_tr_b16 v[94:95], v20 offset:2304
    buffer_load_dwordx4 v8, s[20:23], s61 offen offset:1024 lds
    s_waitcnt lgkmcnt(15)
    v_mfma_f32_16x16x32_bf16 v[28:31], v[140:143], v[76:79], v[28:31]
    ds_read_b64_tr_b16 v[96:97], v20 offset:9216
    ds_read_b64_tr_b16 v[98:99], v20 offset:11520
    v_mfma_f32_16x16x32_bf16 v[28:31], v[144:147], v[84:87], v[28:31]
    ds_read_b128 v[64:67], v13 offset:0
    v_mfma_f32_16x16x32_bf16 v[44:47], v[140:143], v[80:83], v[44:47]
    ds_read_b128 v[72:75], v15 offset:0
    s_add_u32 m0, s32, 69632
    s_add_u32 s61, s30, 1327104
    buffer_load_dwordx4 v9, s[16:19], s61 offen lds
    v_mfma_f32_16x16x32_bf16 v[44:47], v[144:147], v[88:91], v[44:47]
    s_setprio 1
    ds_read_b64_tr_b16 v[100:101], v20 offset:40
    ds_read_b64_tr_b16 v[102:103], v20 offset:2344
    s_waitcnt lgkmcnt(15)
    v_mfma_f32_16x16x32_bf16 v[32:35], v[148:151], v[76:79], v[32:35]
    ds_read_b64_tr_b16 v[104:105], v20 offset:9256
    v_mfma_f32_16x16x32_bf16 v[32:35], v[152:155], v[84:87], v[32:35]
    ds_read_b64_tr_b16 v[106:107], v20 offset:11560
    buffer_load_dwordx4 v10, s[16:19], s61 offen offset:1024 lds
    v_mfma_f32_16x16x32_bf16 v[48:51], v[148:151], v[80:83], v[48:51]
    ds_read_b64_tr_b16 v[108:109], v20 offset:72
    ds_read_b64_tr_b16 v[110:111], v20 offset:2376
    v_mfma_f32_16x16x32_bf16 v[48:51], v[152:155], v[88:91], v[48:51]
    ds_read_b64_tr_b16 v[112:113], v20 offset:9288
    s_waitcnt lgkmcnt(15)
    v_mfma_f32_16x16x32_bf16 v[36:39], v[156:159], v[76:79], v[36:39]
    s_setprio 0
    ds_read_b64_tr_b16 v[114:115], v20 offset:11592
    s_mov_b64 exec, 0xffff
    buffer_load_dwordx4 v11, s[16:19], s61 offen offset:2048 lds
    s_mov_b64 exec, -1
    v_mfma_f32_16x16x32_bf16 v[36:39], v[160:163], v[84:87], v[36:39]
    ds_read_b64_tr_b16 v[116:117], v20 offset:112
    ds_read_b64_tr_b16 v[118:119], v20 offset:2416
    v_mfma_f32_16x16x32_bf16 v[52:55], v[156:159], v[80:83], v[52:55]
    ds_read_b64_tr_b16 v[120:121], v20 offset:9328
    v_mfma_f32_16x16x32_bf16 v[52:55], v[160:163], v[88:91], v[52:55]
    ds_read_b64_tr_b16 v[122:123], v20 offset:11632
    s_waitcnt lgkmcnt(15)
    v_mfma_f32_16x16x32_bf16 v[56:59], v[124:127], v[60:63], v[56:59]
    s_setprio 3
    s_waitcnt vmcnt(5)
    s_barrier
    ds_read_b128 v[76:79], v12 offset:34816
    ds_read_b128 v[84:87], v14 offset:34816
    v_mfma_f32_16x16x32_bf16 v[56:59], v[128:131], v[68:71], v[56:59]
    ds_read_b64_tr_b16 v[164:165], v21 offset:34816
    s_waitcnt lgkmcnt(15)
    v_mfma_f32_16x16x32_bf16 v[24:27], v[92:95], v[60:63], v[24:27]
    ds_read_b64_tr_b16 v[166:167], v21 offset:37120
    s_add_u32 m0, s31, 104448
    s_add_u32 s61, s29, 896
    buffer_load_dwordx4 v7, s[20:23], s61 offen lds
    v_mfma_f32_16x16x32_bf16 v[24:27], v[96:99], v[68:71], v[24:27]
    ds_read_b64_tr_b16 v[168:169], v21 offset:44032
    ds_read_b64_tr_b16 v[170:171], v21 offset:46336
    s_waitcnt lgkmcnt(15)
    v_mfma_f32_16x16x32_bf16 v[40:43], v[92:95], v[64:67], v[40:43]
    ds_read_b64_tr_b16 v[132:133], v20 offset:34816
    v_mfma_f32_16x16x32_bf16 v[40:43], v[96:99], v[72:75], v[40:43]
    s_setprio 2
    ds_read_b64_tr_b16 v[134:135], v20 offset:37120
    buffer_load_dwordx4 v8, s[20:23], s61 offen offset:1024 lds
    s_waitcnt lgkmcnt(15)
    v_mfma_f32_16x16x32_bf16 v[28:31], v[100:103], v[60:63], v[28:31]
    ds_read_b64_tr_b16 v[136:137], v20 offset:44032
    ds_read_b64_tr_b16 v[138:139], v20 offset:46336
    v_mfma_f32_16x16x32_bf16 v[28:31], v[104:107], v[68:71], v[28:31]
    ds_read_b128 v[80:83], v13 offset:34816
    v_mfma_f32_16x16x32_bf16 v[44:47], v[100:103], v[64:67], v[44:47]
    ds_read_b128 v[88:91], v15 offset:34816
    s_add_u32 m0, s32, 104448
    s_add_u32 s61, s30, 1548288
    buffer_load_dwordx4 v9, s[16:19], s61 offen lds
    v_mfma_f32_16x16x32_bf16 v[44:47], v[104:107], v[72:75], v[44:47]
    s_setprio 1
    ds_read_b64_tr_b16 v[140:141], v20 offset:34856
    ds_read_b64_tr_b16 v[142:143], v20 offset:37160
    s_waitcnt lgkmcnt(15)
    v_mfma_f32_16x16x32_bf16 v[32:35], v[108:111], v[60:63], v[32:35]
    ds_read_b64_tr_b16 v[144:145], v20 offset:44072
    v_mfma_f32_16x16x32_bf16 v[32:35], v[112:115], v[68:71], v[32:35]
    ds_read_b64_tr_b16 v[146:147], v20 offset:46376
    buffer_load_dwordx4 v10, s[16:19], s61 offen offset:1024 lds
    v_mfma_f32_16x16x32_bf16 v[48:51], v[108:111], v[64:67], v[48:51]
    ds_read_b64_tr_b16 v[148:149], v20 offset:34888
    ds_read_b64_tr_b16 v[150:151], v20 offset:37192
    v_mfma_f32_16x16x32_bf16 v[48:51], v[112:115], v[72:75], v[48:51]
    ds_read_b64_tr_b16 v[152:153], v20 offset:44104
    s_waitcnt lgkmcnt(15)
    v_mfma_f32_16x16x32_bf16 v[36:39], v[116:119], v[60:63], v[36:39]
    s_setprio 0
    ds_read_b64_tr_b16 v[154:155], v20 offset:46408
    s_mov_b64 exec, 0xffff
    buffer_load_dwordx4 v11, s[16:19], s61 offen offset:2048 lds
    s_mov_b64 exec, -1
    v_mfma_f32_16x16x32_bf16 v[36:39], v[120:123], v[68:71], v[36:39]
    ds_read_b64_tr_b16 v[156:157], v20 offset:34928
    ds_read_b64_tr_b16 v[158:159], v20 offset:37232
    v_mfma_f32_16x16x32_bf16 v[52:55], v[116:119], v[64:67], v[52:55]
    ds_read_b64_tr_b16 v[160:161], v20 offset:44144
    v_mfma_f32_16x16x32_bf16 v[52:55], v[120:123], v[72:75], v[52:55]
    ds_read_b64_tr_b16 v[162:163], v20 offset:46448
    s_waitcnt lgkmcnt(15)
    v_mfma_f32_16x16x32_bf16 v[56:59], v[164:167], v[76:79], v[56:59]
    s_setprio 3
    s_waitcnt vmcnt(5)
    s_barrier
    ds_read_b128 v[60:63], v16 offset:0
    ds_read_b128 v[68:71], v18 offset:0
    v_mfma_f32_16x16x32_bf16 v[56:59], v[168:171], v[84:87], v[56:59]
    ds_read_b64_tr_b16 v[124:125], v23 offset:0
    s_waitcnt lgkmcnt(15)
    v_mfma_f32_16x16x32_bf16 v[24:27], v[132:135], v[76:79], v[24:27]
    ds_read_b64_tr_b16 v[126:127], v23 offset:2304
    v_mov_b32 v220, 64
    s_cmp_lg_u32 s24, 0
    s_cbranch_scc1 LA_nc0
    global_load_dword v220, v221, s[56:57] sc1
    LA_nc0:
    v_mfma_f32_16x16x32_bf16 v[24:27], v[136:139], v[84:87], v[24:27]
    ds_read_b64_tr_b16 v[128:129], v23 offset:9216
    ds_read_b64_tr_b16 v[130:131], v23 offset:11520
    s_waitcnt lgkmcnt(15)
    v_mfma_f32_16x16x32_bf16 v[40:43], v[132:135], v[80:83], v[40:43]
    ds_read_b64_tr_b16 v[92:93], v22 offset:0
    v_mfma_f32_16x16x32_bf16 v[40:43], v[136:139], v[88:91], v[40:43]
    s_setprio 2
    ds_read_b64_tr_b16 v[94:95], v22 offset:2304
    s_add_u32 m0, s31, 0
    s_add_u32 s61, s29, 1024
    buffer_load_dwordx4 v7, s[20:23], s61 offen lds
    s_waitcnt lgkmcnt(15)
    v_mfma_f32_16x16x32_bf16 v[28:31], v[140:143], v[76:79], v[28:31]
    ds_read_b64_tr_b16 v[96:97], v22 offset:9216
    ds_read_b64_tr_b16 v[98:99], v22 offset:11520
    v_mfma_f32_16x16x32_bf16 v[28:31], v[144:147], v[84:87], v[28:31]
    ds_read_b128 v[64:67], v17 offset:0
    v_mfma_f32_16x16x32_bf16 v[44:47], v[140:143], v[80:83], v[44:47]
    ds_read_b128 v[72:75], v19 offset:0
    buffer_load_dwordx4 v8, s[20:23], s61 offen offset:1024 lds
    v_mfma_f32_16x16x32_bf16 v[44:47], v[144:147], v[88:91], v[44:47]
    s_setprio 1
    ds_read_b64_tr_b16 v[100:101], v22 offset:40
    ds_read_b64_tr_b16 v[102:103], v22 offset:2344
    s_waitcnt lgkmcnt(15)
    v_mfma_f32_16x16x32_bf16 v[32:35], v[148:151], v[76:79], v[32:35]
    ds_read_b64_tr_b16 v[104:105], v22 offset:9256
    v_mfma_f32_16x16x32_bf16 v[32:35], v[152:155], v[84:87], v[32:35]
    ds_read_b64_tr_b16 v[106:107], v22 offset:11560
    s_add_u32 m0, s32, 0
    s_add_u32 s61, s30, 1769472
    buffer_load_dwordx4 v9, s[16:19], s61 offen lds
    v_mfma_f32_16x16x32_bf16 v[48:51], v[148:151], v[80:83], v[48:51]
    ds_read_b64_tr_b16 v[108:109], v22 offset:72
    ds_read_b64_tr_b16 v[110:111], v22 offset:2376
    v_mfma_f32_16x16x32_bf16 v[48:51], v[152:155], v[88:91], v[48:51]
    ds_read_b64_tr_b16 v[112:113], v22 offset:9288
    s_waitcnt lgkmcnt(15)
    v_mfma_f32_16x16x32_bf16 v[36:39], v[156:159], v[76:79], v[36:39]
    s_setprio 0
    ds_read_b64_tr_b16 v[114:115], v22 offset:11592
    buffer_load_dwordx4 v10, s[16:19], s61 offen offset:1024 lds
    v_mfma_f32_16x16x32_bf16 v[36:39], v[160:163], v[84:87], v[36:39]
    ds_read_b64_tr_b16 v[116:117], v22 offset:112
    ds_read_b64_tr_b16 v[118:119], v22 offset:2416
    v_mfma_f32_16x16x32_bf16 v[52:55], v[156:159], v[80:83], v[52:55]
    ds_read_b64_tr_b16 v[120:121], v22 offset:9328
    v_mfma_f32_16x16x32_bf16 v[52:55], v[160:163], v[88:91], v[52:55]
    ds_read_b64_tr_b16 v[122:123], v22 offset:11632
    s_mov_b64 exec, 0xffff
    buffer_load_dwordx4 v11, s[16:19], s61 offen offset:2048 lds
    s_mov_b64 exec, -1
    s_waitcnt lgkmcnt(15)
    v_mfma_f32_16x16x32_bf16 v[56:59], v[124:127], v[60:63], v[56:59]
    s_setprio 3
    s_waitcnt vmcnt(5)
    LA_cntchk0:
    v_cmp_gt_u32 vcc, 64, v220
    s_cbranch_vccnz LA_cnt0
    LA_cntok0:
    s_barrier
    v_lshlrev_b32 v1, 4, v0
    s_mov_b32 m0, s39
    s_mov_b64 exec, 0xffff
    buffer_load_dwordx4 v1, s[12:15], s38 offen sc1 lds
    s_mov_b64 exec, -1
    ds_read_b128 v[76:79], v16 offset:34816
    ds_read_b128 v[84:87], v18 offset:34816
    v_mfma_f32_16x16x32_bf16 v[56:59], v[128:131], v[68:71], v[56:59]
    ds_read_b64_tr_b16 v[164:165], v23 offset:34816
    v_lshl_add_u32 v1, v5, 2, s37
    v_xor_b32 v220, 64, v1
    v_lshl_add_u32 v2, v6, 4, s50
    s_waitcnt lgkmcnt(15)
    v_mfma_f32_16x16x32_bf16 v[24:27], v[92:95], v[60:63], v[24:27]
    ds_read_b64_tr_b16 v[166:167], v23 offset:37120
    v_mul_u32_u24 v3, 144, v6
    v_add_u32 v3, 140288, v3
    v_mfma_f32_16x16x32_bf16 v[24:27], v[96:99], v[68:71], v[24:27]
    ds_read_b64_tr_b16 v[168:169], v23 offset:44032
    ds_read_b64_tr_b16 v[170:171], v23 offset:46336
    s_cmp_lt_u32 s28, 4
    s_cselect_b32 s53, 0x3eae1a93, 1.0
    s_cselect_b32 s33, 0, 4718592
    s_add_u32 s51, s51, s33
    s_lshl_b32 s52, s52, 10
    s_add_u32 s52, s52, s51
    s_mul_i32 s33, s26, 589824
    s_add_u32 s52, s52, s33
    s_add_u32 s51, s51, 139264
    s_waitcnt lgkmcnt(15)
    v_mfma_f32_16x16x32_bf16 v[40:43], v[92:95], v[64:67], v[40:43]
    ds_read_b64_tr_b16 v[132:133], v22 offset:34816
    v_mfma_f32_16x16x32_bf16 v[40:43], v[96:99], v[72:75], v[40:43]
    s_setprio 2
    ds_read_b64_tr_b16 v[134:135], v22 offset:37120
    v_and_b32 v222, 1, v6
    v_xor_b32 v222, s26, v222
    v_lshl_add_u32 v222, v222, 4, v5
    s_waitcnt lgkmcnt(15)
    v_mfma_f32_16x16x32_bf16 v[28:31], v[100:103], v[60:63], v[28:31]
    ds_read_b64_tr_b16 v[136:137], v22 offset:44032
    ds_read_b64_tr_b16 v[138:139], v22 offset:46336
    v_mfma_f32_16x16x32_bf16 v[28:31], v[104:107], v[68:71], v[28:31]
    ds_read_b128 v[80:83], v17 offset:34816
    v_lshlrev_b32 v222, 4, v222
    v_lshrrev_b32 v4, 1, v6
    v_lshl_add_u32 v222, v4, 9, v222
    v_mfma_f32_16x16x32_bf16 v[44:47], v[100:103], v[64:67], v[44:47]
    ds_read_b128 v[88:91], v19 offset:34816
    s_mov_b32 s33, 294912
    v_mul_lo_u32 v223, s33, v6
    v_add_u32 v4, s36, v5
    v_lshl_add_u32 v223, v4, 2, v223
    v_mfma_f32_16x16x32_bf16 v[44:47], v[104:107], v[72:75], v[44:47]
    s_setprio 1
    ds_read_b64_tr_b16 v[140:141], v22 offset:34856
    ds_read_b64_tr_b16 v[142:143], v22 offset:37160
    s_waitcnt lgkmcnt(15)
    v_mfma_f32_16x16x32_bf16 v[32:35], v[108:111], v[60:63], v[32:35]
    ds_read_b64_tr_b16 v[144:145], v22 offset:44072
    v_mfma_f32_16x16x32_bf16 v[32:35], v[112:115], v[68:71], v[32:35]
    ds_read_b64_tr_b16 v[146:147], v22 offset:46376
    v_mfma_f32_16x16x32_bf16 v[48:51], v[108:111], v[64:67], v[48:51]
    ds_read_b64_tr_b16 v[148:149], v22 offset:34888
    ds_read_b64_tr_b16 v[150:151], v22 offset:37192
    v_mfma_f32_16x16x32_bf16 v[48:51], v[112:115], v[72:75], v[48:51]
    ds_read_b64_tr_b16 v[152:153], v22 offset:44104
    s_waitcnt lgkmcnt(15)
    v_mfma_f32_16x16x32_bf16 v[36:39], v[116:119], v[60:63], v[36:39]
    s_setprio 0
    ds_read_b64_tr_b16 v[154:155], v22 offset:46408
    v_mfma_f32_16x16x32_bf16 v[36:39], v[120:123], v[68:71], v[36:39]
    ds_read_b64_tr_b16 v[156:157], v22 offset:34928
    ds_read_b64_tr_b16 v[158:159], v22 offset:37232
    v_mfma_f32_16x16x32_bf16 v[52:55], v[116:119], v[64:67], v[52:55]
    ds_read_b64_tr_b16 v[160:161], v22 offset:44144
    v_mfma_f32_16x16x32_bf16 v[52:55], v[120:123], v[72:75], v[52:55]
    ds_read_b64_tr_b16 v[162:163], v22 offset:46448
    s_waitcnt lgkmcnt(15)
    v_mfma_f32_16x16x32_bf16 v[56:59], v[164:167], v[76:79], v[56:59]
    s_setprio 3
    s_waitcnt vmcnt(0)
    s_barrier
    ds_read_b32 v192, v1 offset:0
    ds_read_b32 v193, v220 offset:0
    v_mfma_f32_16x16x32_bf16 v[56:59], v[168:171], v[84:87], v[56:59]
    ds_read_b32 v194, v1 offset:512
    ds_read_b32 v195, v220 offset:512
    s_waitcnt lgkmcnt(15)
    v_mfma_f32_16x16x32_bf16 v[24:27], v[132:135], v[76:79], v[24:27]
    ds_read_b128 v[188:191], v3 offset:64
    ds_read_b128 v[172:175], v2 offset:0
    v_mfma_f32_16x16x32_bf16 v[24:27], v[136:139], v[84:87], v[24:27]
    ds_read_b128 v[176:179], v2 offset:80
    ds_read_b128 v[180:183], v2 offset:144
    s_waitcnt lgkmcnt(15)
    v_mfma_f32_16x16x32_bf16 v[40:43], v[132:135], v[80:83], v[40:43]
    ds_read_b128 v[184:187], v2 offset:224
    ds_read_b128 v[60:63], v12 offset:0
    v_mfma_f32_16x16x32_bf16 v[40:43], v[136:139], v[88:91], v[40:43]
    s_setprio 2
    ds_read_b128 v[68:71], v14 offset:0
    ds_read_b64_tr_b16 v[124:125], v21 offset:0
    s_waitcnt lgkmcnt(15)
    v_mfma_f32_16x16x32_bf16 v[28:31], v[140:143], v[76:79], v[28:31]
    ds_read_b64_tr_b16 v[126:127], v21 offset:2304
    ds_read_b64_tr_b16 v[128:129], v21 offset:9216
    v_mfma_f32_16x16x32_bf16 v[28:31], v[144:147], v[84:87], v[28:31]
    ds_read_b64_tr_b16 v[130:131], v21 offset:11520
    ds_read_b64_tr_b16 v[92:93], v20 offset:0
    v_mfma_f32_16x16x32_bf16 v[44:47], v[140:143], v[80:83], v[44:47]
    ds_read_b64_tr_b16 v[94:95], v20 offset:2304
    ds_read_b64_tr_b16 v[96:97], v20 offset:9216
    v_mfma_f32_16x16x32_bf16 v[44:47], v[144:147], v[88:91], v[44:47]
    s_setprio 1
    ds_read_b64_tr_b16 v[98:99], v20 offset:11520
    ds_read_b128 v[64:67], v13 offset:0
    s_waitcnt lgkmcnt(15)
    v_mfma_f32_16x16x32_bf16 v[32:35], v[148:151], v[76:79], v[32:35]
    ds_read_b128 v[72:75], v15 offset:0
    ds_read_b64_tr_b16 v[100:101], v20 offset:40
    v_mfma_f32_16x16x32_bf16 v[32:35], v[152:155], v[84:87], v[32:35]
    ds_read_b64_tr_b16 v[102:103], v20 offset:2344
    ds_read_b64_tr_b16 v[104:105], v20 offset:9256
    v_mfma_f32_16x16x32_bf16 v[48:51], v[148:151], v[80:83], v[48:51]
    ds_read_b64_tr_b16 v[106:107], v20 offset:11560
    ds_read_b64_tr_b16 v[108:109], v20 offset:72
    v_mfma_f32_16x16x32_bf16 v[48:51], v[152:155], v[88:91], v[48:51]
    ds_read_b64_tr_b16 v[110:111], v20 offset:2376
    ds_read_b64_tr_b16 v[112:113], v20 offset:9288
    s_waitcnt lgkmcnt(15)
    v_mfma_f32_16x16x32_bf16 v[36:39], v[156:159], v[76:79], v[36:39]
    s_setprio 0
    ds_read_b64_tr_b16 v[114:115], v20 offset:11592
    ds_read_b64_tr_b16 v[116:117], v20 offset:112
    v_mfma_f32_16x16x32_bf16 v[36:39], v[160:163], v[84:87], v[36:39]
    ds_read_b64_tr_b16 v[118:119], v20 offset:2416
    ds_read_b64_tr_b16 v[120:121], v20 offset:9328
    v_mfma_f32_16x16x32_bf16 v[52:55], v[156:159], v[80:83], v[52:55]
    ds_read_b64_tr_b16 v[122:123], v20 offset:11632
    v_mfma_f32_16x16x32_bf16 v[52:55], v[160:163], v[88:91], v[52:55]
    s_waitcnt lgkmcnt(15)
    v_mfma_f32_16x16x32_bf16 v[56:59], v[124:127], v[60:63], v[56:59]
    s_setprio 3
    v_mul_f32 v194, s53, v194
    v_mul_f32 v195, s53, v195
    v_mfma_f32_16x16x32_bf16 v[56:59], v[128:131], v[68:71], v[56:59]
    s_waitcnt lgkmcnt(14)
    v_mfma_f32_16x16x32_bf16 v[24:27], v[92:95], v[60:63], v[24:27]
    v_mfma_f32_16x16x32_bf16 v[24:27], v[96:99], v[68:71], v[24:27]
    s_waitcnt lgkmcnt(12)
    v_mfma_f32_16x16x32_bf16 v[40:43], v[92:95], v[64:67], v[40:43]
    s_nop 2
    v_fma_f32 v56, -v192, v188, v56
    v_fma_f32 v57, -v192, v189, v57
    v_fma_f32 v58, -v192, v190, v58
    v_fma_f32 v59, -v192, v191, v59
    v_mfma_f32_16x16x32_bf16 v[40:43], v[96:99], v[72:75], v[40:43]
    s_setprio 2
    v_mul_f32 v56, v194, v56
    v_mul_f32 v57, v194, v57
    v_mul_f32 v58, v194, v58
    v_mul_f32 v59, v194, v59
    v_cvt_pk_bf16_f32 v216, v56, v57
    s_waitcnt lgkmcnt(8)
    v_mfma_f32_16x16x32_bf16 v[28:31], v[100:103], v[60:63], v[28:31]
    v_cvt_pk_bf16_f32 v217, v58, v59
    s_add_u32 s33, s51, 147456
    buffer_store_dword v216, v223, s[12:15], s51 offen sc1
    buffer_store_dword v217, v223, s[12:15], s33 offen sc1
    v_mfma_f32_16x16x32_bf16 v[28:31], v[104:107], v[68:71], v[28:31]
    v_mfma_f32_16x16x32_bf16 v[44:47], v[100:103], v[64:67], v[44:47]
    v_fma_f32 v24, -v192, v172, v24
    v_fma_f32 v25, -v192, v173, v25
    v_fma_f32 v26, -v192, v174, v26
    v_fma_f32 v27, -v192, v175, v27
    v_mul_f32 v24, v194, v24
    v_mul_f32 v25, v194, v25
    v_mul_f32 v26, v194, v26
    v_mul_f32 v27, v194, v27
    v_cvt_pk_bf16_f32 v200, v24, v25
    v_cvt_pk_bf16_f32 v201, v26, v27
    v_fma_f32 v40, -v193, v172, v40
    v_fma_f32 v41, -v193, v173, v41
    v_fma_f32 v42, -v193, v174, v42
    v_mfma_f32_16x16x32_bf16 v[44:47], v[104:107], v[72:75], v[44:47]
    s_setprio 1
    v_fma_f32 v43, -v193, v175, v43
    v_mul_f32 v40, v195, v40
    v_mul_f32 v41, v195, v41
    v_mul_f32 v42, v195, v42
    v_mul_f32 v43, v195, v43
    s_waitcnt lgkmcnt(4)
    v_mfma_f32_16x16x32_bf16 v[32:35], v[108:111], v[60:63], v[32:35]
    v_cvt_pk_bf16_f32 v202, v40, v41
    v_cvt_pk_bf16_f32 v203, v42, v43
    s_add_u32 s33, s52, 0
    s_nop 0
    v_permlane16_swap_b32 v200, v202
    v_permlane16_swap_b32 v201, v203
    buffer_store_dwordx4 v[200:203], v222, s[12:15], s33 offen sc1
    v_mfma_f32_16x16x32_bf16 v[32:35], v[112:115], v[68:71], v[32:35]
    v_mfma_f32_16x16x32_bf16 v[48:51], v[108:111], v[64:67], v[48:51]
    v_fma_f32 v28, -v192, v176, v28
    v_fma_f32 v29, -v192, v177, v29
    v_fma_f32 v30, -v192, v178, v30
    v_fma_f32 v31, -v192, v179, v31
    v_mul_f32 v28, v194, v28
    v_mul_f32 v29, v194, v29
    v_mul_f32 v30, v194, v30
    v_mul_f32 v31, v194, v31
    v_cvt_pk_bf16_f32 v204, v28, v29
    v_cvt_pk_bf16_f32 v205, v30, v31
    v_fma_f32 v44, -v193, v176, v44
    v_fma_f32 v45, -v193, v177, v45
    v_mfma_f32_16x16x32_bf16 v[48:51], v[112:115], v[72:75], v[48:51]
    v_fma_f32 v46, -v193, v178, v46
    v_fma_f32 v47, -v193, v179, v47
    v_mul_f32 v44, v195, v44
    v_mul_f32 v45, v195, v45
    v_mul_f32 v46, v195, v46
    s_waitcnt lgkmcnt(0)
    v_mfma_f32_16x16x32_bf16 v[36:39], v[116:119], v[60:63], v[36:39]
    s_setprio 0
    v_mul_f32 v47, v195, v47
    v_cvt_pk_bf16_f32 v206, v44, v45
    v_cvt_pk_bf16_f32 v207, v46, v47
    s_add_u32 s33, s52, 147456
    s_nop 0
    v_permlane16_swap_b32 v204, v206
    v_permlane16_swap_b32 v205, v207
    buffer_store_dwordx4 v[204:207], v222, s[12:15], s33 offen sc1
    v_mfma_f32_16x16x32_bf16 v[36:39], v[120:123], v[68:71], v[36:39]
    v_mfma_f32_16x16x32_bf16 v[52:55], v[116:119], v[64:67], v[52:55]
    v_fma_f32 v32, -v192, v180, v32
    v_fma_f32 v33, -v192, v181, v33
    v_fma_f32 v34, -v192, v182, v34
    v_fma_f32 v35, -v192, v183, v35
    v_mul_f32 v32, v194, v32
    v_mul_f32 v33, v194, v33
    v_mul_f32 v34, v194, v34
    v_mul_f32 v35, v194, v35
    v_cvt_pk_bf16_f32 v208, v32, v33
    v_cvt_pk_bf16_f32 v209, v34, v35
    v_fma_f32 v48, -v193, v180, v48
    v_mfma_f32_16x16x32_bf16 v[52:55], v[120:123], v[72:75], v[52:55]
    v_fma_f32 v49, -v193, v181, v49
    v_fma_f32 v50, -v193, v182, v50
    v_fma_f32 v51, -v193, v183, v51
    v_mul_f32 v48, v195, v48
    v_mul_f32 v49, v195, v49
    v_mul_f32 v50, v195, v50
    v_mul_f32 v51, v195, v51
    v_cvt_pk_bf16_f32 v210, v48, v49
    v_cvt_pk_bf16_f32 v211, v50, v51
    s_add_u32 s33, s52, 294912
    s_nop 0
    v_permlane16_swap_b32 v208, v210
    v_permlane16_swap_b32 v209, v211
    buffer_store_dwordx4 v[208:211], v222, s[12:15], s33 offen sc1
    s_nop 2
    v_fma_f32 v36, -v192, v184, v36
    v_fma_f32 v37, -v192, v185, v37
    v_fma_f32 v38, -v192, v186, v38
    v_fma_f32 v39, -v192, v187, v39
    v_mul_f32 v36, v194, v36
    v_mul_f32 v37, v194, v37
    v_mul_f32 v38, v194, v38
    v_mul_f32 v39, v194, v39
    v_cvt_pk_bf16_f32 v212, v36, v37
    v_cvt_pk_bf16_f32 v213, v38, v39
    v_fma_f32 v52, -v193, v184, v52
    v_fma_f32 v53, -v193, v185, v53
    v_fma_f32 v54, -v193, v186, v54
    v_fma_f32 v55, -v193, v187, v55
    v_mul_f32 v52, v195, v52
    v_mul_f32 v53, v195, v53
    v_mul_f32 v54, v195, v54
    v_mul_f32 v55, v195, v55
    v_cvt_pk_bf16_f32 v214, v52, v53
    v_cvt_pk_bf16_f32 v215, v54, v55
    s_add_u32 s33, s52, 442368
    s_nop 0
    v_permlane16_swap_b32 v212, v214
    v_permlane16_swap_b32 v213, v215
    buffer_store_dwordx4 v[212:215], v222, s[12:15], s33 offen sc1
    s_branch LA_end
LA_vmain:
    s_waitcnt lgkmcnt(15)
    v_mfma_f32_16x16x32_bf16 v[56:59], v[60:63], v[124:127], 0
    s_setprio 3
    s_waitcnt vmcnt(5)
    s_barrier
    ds_read_b128 v[76:79], v12 offset:34816
    ds_read_b128 v[84:87], v14 offset:34816
    v_mfma_f32_16x16x32_bf16 v[56:59], v[68:71], v[128:131], v[56:59]
    ds_read_b64_tr_b16 v[164:165], v21 offset:34816
    s_waitcnt lgkmcnt(15)
    v_mfma_f32_16x16x32_bf16 v[24:27], v[60:63], v[92:95], 0
    ds_read_b64_tr_b16 v[166:167], v21 offset:37120
    s_add_u32 m0, s31, 104448
    s_add_u32 s61, s29, 384
    buffer_load_dwordx4 v7, s[20:23], s61 offen lds
    v_mfma_f32_16x16x32_bf16 v[24:27], v[68:71], v[96:99], v[24:27]
    ds_read_b64_tr_b16 v[168:169], v21 offset:44032
    ds_read_b64_tr_b16 v[170:171], v21 offset:46336
    s_waitcnt lgkmcnt(15)
    v_mfma_f32_16x16x32_bf16 v[40:43], v[64:67], v[92:95], 0
    ds_read_b64_tr_b16 v[132:133], v20 offset:34816
    v_mfma_f32_16x16x32_bf16 v[40:43], v[72:75], v[96:99], v[40:43]
    s_setprio 2
    ds_read_b64_tr_b16 v[134:135], v20 offset:37120
    buffer_load_dwordx4 v8, s[20:23], s61 offen offset:1024 lds
    s_waitcnt lgkmcnt(15)
    v_mfma_f32_16x16x32_bf16 v[28:31], v[60:63], v[100:103], 0
    ds_read_b64_tr_b16 v[136:137], v20 offset:44032
    ds_read_b64_tr_b16 v[138:139], v20 offset:46336
    v_mfma_f32_16x16x32_bf16 v[28:31], v[68:71], v[104:107], v[28:31]
    ds_read_b128 v[80:83], v13 offset:34816
    v_mfma_f32_16x16x32_bf16 v[44:47], v[64:67], v[100:103], 0
    ds_read_b128 v[88:91], v15 offset:34816
    s_add_u32 m0, s32, 104448
    s_add_u32 s61, s30, 663552
    buffer_load_dwordx4 v9, s[16:19], s61 offen lds
    v_mfma_f32_16x16x32_bf16 v[44:47], v[72:75], v[104:107], v[44:47]
    s_setprio 1
    ds_read_b64_tr_b16 v[140:141], v20 offset:34856
    ds_read_b64_tr_b16 v[142:143], v20 offset:37160
    s_waitcnt lgkmcnt(15)
    v_mfma_f32_16x16x32_bf16 v[32:35], v[60:63], v[108:111], 0
    ds_read_b64_tr_b16 v[144:145], v20 offset:44072
    v_mfma_f32_16x16x32_bf16 v[32:35], v[68:71], v[112:115], v[32:35]
    ds_read_b64_tr_b16 v[146:147], v20 offset:46376
    buffer_load_dwordx4 v10, s[16:19], s61 offen offset:1024 lds
    v_mfma_f32_16x16x32_bf16 v[48:51], v[64:67], v[108:111], 0
    ds_read_b64_tr_b16 v[148:149], v20 offset:34888
    ds_read_b64_tr_b16 v[150:151], v20 offset:37192
    v_mfma_f32_16x16x32_bf16 v[48:51], v[72:75], v[112:115], v[48:51]
    ds_read_b64_tr_b16 v[152:153], v20 offset:44104
    s_waitcnt lgkmcnt(15)
    v_mfma_f32_16x16x32_bf16 v[36:39], v[60:63], v[116:119], 0
    s_setprio 0
    ds_read_b64_tr_b16 v[154:155], v20 offset:46408
    s_mov_b64 exec, 0xffff
    buffer_load_dwordx4 v11, s[16:19], s61 offen offset:2048 lds
    s_mov_b64 exec, -1
    v_mfma_f32_16x16x32_bf16 v[36:39], v[68:71], v[120:123], v[36:39]
    ds_read_b64_tr_b16 v[156:157], v20 offset:34928
    ds_read_b64_tr_b16 v[158:159], v20 offset:37232
    v_mfma_f32_16x16x32_bf16 v[52:55], v[64:67], v[116:119], 0
    ds_read_b64_tr_b16 v[160:161], v20 offset:44144
    v_mfma_f32_16x16x32_bf16 v[52:55], v[72:75], v[120:123], v[52:55]
    ds_read_b64_tr_b16 v[162:163], v20 offset:46448
    s_waitcnt lgkmcnt(15)
    v_mfma_f32_16x16x32_bf16 v[56:59], v[76:79], v[164:167], v[56:59]
    s_setprio 3
    s_waitcnt vmcnt(5)
    s_barrier
    ds_read_b128 v[60:63], v16 offset:0
    ds_read_b128 v[68:71], v18 offset:0
    v_mfma_f32_16x16x32_bf16 v[56:59], v[84:87], v[168:171], v[56:59]
    ds_read_b64_tr_b16 v[124:125], v23 offset:0
    s_waitcnt lgkmcnt(15)
    v_mfma_f32_16x16x32_bf16 v[24:27], v[76:79], v[132:135], v[24:27]
    ds_read_b64_tr_b16 v[126:127], v23 offset:2304
    s_add_u32 m0, s31, 0
    s_add_u32 s61, s29, 512
    buffer_load_dwordx4 v7, s[20:23], s61 offen lds
    v_mfma_f32_16x16x32_bf16 v[24:27], v[84:87], v[136:139], v[24:27]
    ds_read_b64_tr_b16 v[128:129], v23 offset:9216
    ds_read_b64_tr_b16 v[130:131], v23 offset:11520
    s_waitcnt lgkmcnt(15)
    v_mfma_f32_16x16x32_bf16 v[40:43], v[80:83], v[132:135], v[40:43]
    ds_read_b64_tr_b16 v[92:93], v22 offset:0
    v_mfma_f32_16x16x32_bf16 v[40:43], v[88:91], v[136:139], v[40:43]
    s_setprio 2
    ds_read_b64_tr_b16 v[94:95], v22 offset:2304
    buffer_load_dwordx4 v8, s[20:23], s61 offen offset:1024 lds
    s_waitcnt lgkmcnt(15)
    v_mfma_f32_16x16x32_bf16 v[28:31], v[76:79], v[140:143], v[28:31]
    ds_read_b64_tr_b16 v[96:97], v22 offset:9216
    ds_read_b64_tr_b16 v[98:99], v22 offset:11520
    v_mfma_f32_16x16x32_bf16 v[28:31], v[84:87], v[144:147], v[28:31]
    ds_read_b128 v[64:67], v17 offset:0
    v_mfma_f32_16x16x32_bf16 v[44:47], v[80:83], v[140:143], v[44:47]
    ds_read_b128 v[72:75], v19 offset:0
    s_add_u32 m0, s32, 0
    s_add_u32 s61, s30, 884736
    buffer_load_dwordx4 v9, s[16:19], s61 offen lds
    v_mfma_f32_16x16x32_bf16 v[44:47], v[88:91], v[144:147], v[44:47]
    s_setprio 1
    ds_read_b64_tr_b16 v[100:101], v22 offset:40
    ds_read_b64_tr_b16 v[102:103], v22 offset:2344
    s_waitcnt lgkmcnt(15)
    v_mfma_f32_16x16x32_bf16 v[32:35], v[76:79], v[148:151], v[32:35]
    ds_read_b64_tr_b16 v[104:105], v22 offset:9256
    v_mfma_f32_16x16x32_bf16 v[32:35], v[84:87], v[152:155], v[32:35]
    ds_read_b64_tr_b16 v[106:107], v22 offset:11560
    buffer_load_dwordx4 v10, s[16:19], s61 offen offset:1024 lds
    v_mfma_f32_16x16x32_bf16 v[48:51], v[80:83], v[148:151], v[48:51]
    ds_read_b64_tr_b16 v[108:109], v22 offset:72
    ds_read_b64_tr_b16 v[110:111], v22 offset:2376
    v_mfma_f32_16x16x32_bf16 v[48:51], v[88:91], v[152:155], v[48:51]
    ds_read_b64_tr_b16 v[112:113], v22 offset:9288
    s_waitcnt lgkmcnt(15)
    v_mfma_f32_16x16x32_bf16 v[36:39], v[76:79], v[156:159], v[36:39]
    s_setprio 0
    ds_read_b64_tr_b16 v[114:115], v22 offset:11592
    s_mov_b64 exec, 0xffff
    buffer_load_dwordx4 v11, s[16:19], s61 offen offset:2048 lds
    s_mov_b64 exec, -1
    v_mfma_f32_16x16x32_bf16 v[36:39], v[84:87], v[160:163], v[36:39]
    ds_read_b64_tr_b16 v[116:117], v22 offset:112
    ds_read_b64_tr_b16 v[118:119], v22 offset:2416
    v_mfma_f32_16x16x32_bf16 v[52:55], v[80:83], v[156:159], v[52:55]
    ds_read_b64_tr_b16 v[120:121], v22 offset:9328
    v_mfma_f32_16x16x32_bf16 v[52:55], v[88:91], v[160:163], v[52:55]
    ds_read_b64_tr_b16 v[122:123], v22 offset:11632
    s_waitcnt lgkmcnt(15)
    v_mfma_f32_16x16x32_bf16 v[56:59], v[60:63], v[124:127], v[56:59]
    s_setprio 3
    s_waitcnt vmcnt(5)
    s_barrier
    ds_read_b128 v[76:79], v16 offset:34816
    ds_read_b128 v[84:87], v18 offset:34816
    v_mfma_f32_16x16x32_bf16 v[56:59], v[68:71], v[128:131], v[56:59]
    ds_read_b64_tr_b16 v[164:165], v23 offset:34816
    s_waitcnt lgkmcnt(15)
    v_mfma_f32_16x16x32_bf16 v[24:27], v[60:63], v[92:95], v[24:27]
    ds_read_b64_tr_b16 v[166:167], v23 offset:37120
    s_add_u32 m0, s31, 34816
    s_add_u32 s61, s29, 640
    buffer_load_dwordx4 v7, s[20:23], s61 offen lds
    v_mfma_f32_16x16x32_bf16 v[24:27], v[68:71], v[96:99], v[24:27]
    ds_read_b64_tr_b16 v[168:169], v23 offset:44032
    ds_read_b64_tr_b16 v[170:171], v23 offset:46336
    s_waitcnt lgkmcnt(15)
    v_mfma_f32_16x16x32_bf16 v[40:43], v[64:67], v[92:95], v[40:43]
    ds_read_b64_tr_b16 v[132:133], v22 offset:34816
    v_mfma_f32_16x16x32_bf16 v[40:43], v[72:75], v[96:99], v[40:43]
    s_setprio 2
    ds_read_b64_tr_b16 v[134:135], v22 offset:37120
    buffer_load_dwordx4 v8, s[20:23], s61 offen offset:1024 lds
    s_waitcnt lgkmcnt(15)
    v_mfma_f32_16x16x32_bf16 v[28:31], v[60:63], v[100:103], v[28:31]
    ds_read_b64_tr_b16 v[136:137], v22 offset:44032
    ds_read_b64_tr_b16 v[138:139], v22 offset:46336
    v_mfma_f32_16x16x32_bf16 v[28:31], v[68:71], v[104:107], v[28:31]
    ds_read_b128 v[80:83], v17 offset:34816
    v_mfma_f32_16x16x32_bf16 v[44:47], v[64:67], v[100:103], v[44:47]
    ds_read_b128 v[88:91], v19 offset:34816
    s_add_u32 m0, s32, 34816
    s_add_u32 s61, s30, 1105920
    buffer_load_dwordx4 v9, s[16:19], s61 offen lds
    v_mfma_f32_16x16x32_bf16 v[44:47], v[72:75], v[104:107], v[44:47]
    s_setprio 1
    ds_read_b64_tr_b16 v[140:141], v22 offset:34856
    ds_read_b64_tr_b16 v[142:143], v22 offset:37160
    s_waitcnt lgkmcnt(15)
    v_mfma_f32_16x16x32_bf16 v[32:35], v[60:63], v[108:111], v[32:35]
    ds_read_b64_tr_b16 v[144:145], v22 offset:44072
    v_mfma_f32_16x16x32_bf16 v[32:35], v[68:71], v[112:115], v[32:35]
    ds_read_b64_tr_b16 v[146:147], v22 offset:46376
    buffer_load_dwordx4 v10, s[16:19], s61 offen offset:1024 lds
    v_mfma_f32_16x16x32_bf16 v[48:51], v[64:67], v[108:111], v[48:51]
    ds_read_b64_tr_b16 v[148:149], v22 offset:34888
    ds_read_b64_tr_b16 v[150:151], v22 offset:37192
    v_mfma_f32_16x16x32_bf16 v[48:51], v[72:75], v[112:115], v[48:51]
    ds_read_b64_tr_b16 v[152:153], v22 offset:44104
    s_waitcnt lgkmcnt(15)
    v_mfma_f32_16x16x32_bf16 v[36:39], v[60:63], v[116:119], v[36:39]
    s_setprio 0
    ds_read_b64_tr_b16 v[154:155], v22 offset:46408
    s_mov_b64 exec, 0xffff
    buffer_load_dwordx4 v11, s[16:19], s61 offen offset:2048 lds
    s_mov_b64 exec, -1
    v_mfma_f32_16x16x32_bf16 v[36:39], v[68:71], v[120:123], v[36:39]
    ds_read_b64_tr_b16 v[156:157], v22 offset:34928
    ds_read_b64_tr_b16 v[158:159], v22 offset:37232
    v_mfma_f32_16x16x32_bf16 v[52:55], v[64:67], v[116:119], v[52:55]
    ds_read_b64_tr_b16 v[160:161], v22 offset:44144
    v_mfma_f32_16x16x32_bf16 v[52:55], v[72:75], v[120:123], v[52:55]
    ds_read_b64_tr_b16 v[162:163], v22 offset:46448
    s_waitcnt lgkmcnt(15)
    v_mfma_f32_16x16x32_bf16 v[56:59], v[76:79], v[164:167], v[56:59]
    s_setprio 3
    s_waitcnt vmcnt(5)
    s_barrier
    ds_read_b128 v[60:63], v12 offset:0
    ds_read_b128 v[68:71], v14 offset:0
    v_mfma_f32_16x16x32_bf16 v[56:59], v[84:87], v[168:171], v[56:59]
    ds_read_b64_tr_b16 v[124:125], v21 offset:0
    s_waitcnt lgkmcnt(15)
    v_mfma_f32_16x16x32_bf16 v[24:27], v[76:79], v[132:135], v[24:27]
    ds_read_b64_tr_b16 v[126:127], v21 offset:2304
    s_add_u32 m0, s31, 69632
    s_add_u32 s61, s29, 768
    buffer_load_dwordx4 v7, s[20:23], s61 offen lds
    v_mfma_f32_16x16x32_bf16 v[24:27], v[84:87], v[136:139], v[24:27]
    ds_read_b64_tr_b16 v[128:129], v21 offset:9216
    ds_read_b64_tr_b16 v[130:131], v21 offset:11520
    s_waitcnt lgkmcnt(15)
    v_mfma_f32_16x16x32_bf16 v[40:43], v[80:83], v[132:135], v[40:43]
    ds_read_b64_tr_b16 v[92:93], v20 offset:0
    v_mfma_f32_16x16x32_bf16 v[40:43], v[88:91], v[136:139], v[40:43]
    s_setprio 2
    ds_read_b64_tr_b16 v[94:95], v20 offset:2304
    buffer_load_dwordx4 v8, s[20:23], s61 offen offset:1024 lds
    s_waitcnt lgkmcnt(15)
    v_mfma_f32_16x16x32_bf16 v[28:31], v[76:79], v[140:143], v[28:31]
    ds_read_b64_tr_b16 v[96:97], v20 offset:9216
    ds_read_b64_tr_b16 v[98:99], v20 offset:11520
    v_mfma_f32_16x16x32_bf16 v[28:31], v[84:87], v[144:147], v[28:31]
    ds_read_b128 v[64:67], v13 offset:0
    v_mfma_f32_16x16x32_bf16 v[44:47], v[80:83], v[140:143], v[44:47]
    ds_read_b128 v[72:75], v15 offset:0
    s_add_u32 m0, s32, 69632
    s_add_u32 s61, s30, 1327104
    buffer_load_dwordx4 v9, s[16:19], s61 offen lds
    v_mfma_f32_16x16x32_bf16 v[44:47], v[88:91], v[144:147], v[44:47]
    s_setprio 1
    ds_read_b64_tr_b16 v[100:101], v20 offset:40
    ds_read_b64_tr_b16 v[102:103], v20 offset:2344
    s_waitcnt lgkmcnt(15)
    v_mfma_f32_16x16x32_bf16 v[32:35], v[76:79], v[148:151], v[32:35]
    ds_read_b64_tr_b16 v[104:105], v20 offset:9256
    v_mfma_f32_16x16x32_bf16 v[32:35], v[84:87], v[152:155], v[32:35]
    ds_read_b64_tr_b16 v[106:107], v20 offset:11560
    buffer_load_dwordx4 v10, s[16:19], s61 offen offset:1024 lds
    v_mfma_f32_16x16x32_bf16 v[48:51], v[80:83], v[148:151], v[48:51]
    ds_read_b64_tr_b16 v[108:109], v20 offset:72
    ds_read_b64_tr_b16 v[110:111], v20 offset:2376
    v_mfma_f32_16x16x32_bf16 v[48:51], v[88:91], v[152:155], v[48:51]
    ds_read_b64_tr_b16 v[112:113], v20 offset:9288
    s_waitcnt lgkmcnt(15)
    v_mfma_f32_16x16x32_bf16 v[36:39], v[76:79], v[156:159], v[36:39]
    s_setprio 0
    ds_read_b64_tr_b16 v[114:115], v20 offset:11592
    s_mov_b64 exec, 0xffff
    buffer_load_dwordx4 v11, s[16:19], s61 offen offset:2048 lds
    s_mov_b64 exec, -1
    v_mfma_f32_16x16x32_bf16 v[36:39], v[84:87], v[160:163], v[36:39]
    ds_read_b64_tr_b16 v[116:117], v20 offset:112
    ds_read_b64_tr_b16 v[118:119], v20 offset:2416
    v_mfma_f32_16x16x32_bf16 v[52:55], v[80:83], v[156:159], v[52:55]
    ds_read_b64_tr_b16 v[120:121], v20 offset:9328
    v_mfma_f32_16x16x32_bf16 v[52:55], v[88:91], v[160:163], v[52:55]
    ds_read_b64_tr_b16 v[122:123], v20 offset:11632
    s_waitcnt lgkmcnt(15)
    v_mfma_f32_16x16x32_bf16 v[56:59], v[60:63], v[124:127], v[56:59]
    s_setprio 3
    s_waitcnt vmcnt(5)
    s_barrier
    ds_read_b128 v[76:79], v12 offset:34816
    ds_read_b128 v[84:87], v14 offset:34816
    v_mfma_f32_16x16x32_bf16 v[56:59], v[68:71], v[128:131], v[56:59]
    ds_read_b64_tr_b16 v[164:165], v21 offset:34816
    s_waitcnt lgkmcnt(15)
    v_mfma_f32_16x16x32_bf16 v[24:27], v[60:63], v[92:95], v[24:27]
    ds_read_b64_tr_b16 v[166:167], v21 offset:37120
    s_add_u32 m0, s31, 104448
    s_add_u32 s61, s29, 896
    buffer_load_dwordx4 v7, s[20:23], s61 offen lds
    v_mfma_f32_16x16x32_bf16 v[24:27], v[68:71], v[96:99], v[24:27]
    ds_read_b64_tr_b16 v[168:169], v21 offset:44032
    ds_read_b64_tr_b16 v[170:171], v21 offset:46336
    s_waitcnt lgkmcnt(15)
    v_mfma_f32_16x16x32_bf16 v[40:43], v[64:67], v[92:95], v[40:43]
    ds_read_b64_tr_b16 v[132:133], v20 offset:34816
    v_mfma_f32_16x16x32_bf16 v[40:43], v[72:75], v[96:99], v[40:43]
    s_setprio 2
    ds_read_b64_tr_b16 v[134:135], v20 offset:37120
    buffer_load_dwordx4 v8, s[20:23], s61 offen offset:1024 lds
    s_waitcnt lgkmcnt(15)
    v_mfma_f32_16x16x32_bf16 v[28:31], v[60:63], v[100:103], v[28:31]
    ds_read_b64_tr_b16 v[136:137], v20 offset:44032
    ds_read_b64_tr_b16 v[138:139], v20 offset:46336
    v_mfma_f32_16x16x32_bf16 v[28:31], v[68:71], v[104:107], v[28:31]
    ds_read_b128 v[80:83], v13 offset:34816
    v_mfma_f32_16x16x32_bf16 v[44:47], v[64:67], v[100:103], v[44:47]
    ds_read_b128 v[88:91], v15 offset:34816
    s_add_u32 m0, s32, 104448
    s_add_u32 s61, s30, 1548288
    buffer_load_dwordx4 v9, s[16:19], s61 offen lds
    v_mfma_f32_16x16x32_bf16 v[44:47], v[72:75], v[104:107], v[44:47]
    s_setprio 1
    ds_read_b64_tr_b16 v[140:141], v20 offset:34856
    ds_read_b64_tr_b16 v[142:143], v20 offset:37160
    s_waitcnt lgkmcnt(15)
    v_mfma_f32_16x16x32_bf16 v[32:35], v[60:63], v[108:111], v[32:35]
    ds_read_b64_tr_b16 v[144:145], v20 offset:44072
    v_mfma_f32_16x16x32_bf16 v[32:35], v[68:71], v[112:115], v[32:35]
    ds_read_b64_tr_b16 v[146:147], v20 offset:46376
    buffer_load_dwordx4 v10, s[16:19], s61 offen offset:1024 lds
    v_mfma_f32_16x16x32_bf16 v[48:51], v[64:67], v[108:111], v[48:51]
    ds_read_b64_tr_b16 v[148:149], v20 offset:34888
    ds_read_b64_tr_b16 v[150:151], v20 offset:37192
    v_mfma_f32_16x16x32_bf16 v[48:51], v[72:75], v[112:115], v[48:51]
    ds_read_b64_tr_b16 v[152:153], v20 offset:44104
    s_waitcnt lgkmcnt(15)
    v_mfma_f32_16x16x32_bf16 v[36:39], v[60:63], v[116:119], v[36:39]
    s_setprio 0
    ds_read_b64_tr_b16 v[154:155], v20 offset:46408
    s_mov_b64 exec, 0xffff
    buffer_load_dwordx4 v11, s[16:19], s61 offen offset:2048 lds
    s_mov_b64 exec, -1
    v_mfma_f32_16x16x32_bf16 v[36:39], v[68:71], v[120:123], v[36:39]
    ds_read_b64_tr_b16 v[156:157], v20 offset:34928
    ds_read_b64_tr_b16 v[158:159], v20 offset:37232
    v_mfma_f32_16x16x32_bf16 v[52:55], v[64:67], v[116:119], v[52:55]
    ds_read_b64_tr_b16 v[160:161], v20 offset:44144
    v_mfma_f32_16x16x32_bf16 v[52:55], v[72:75], v[120:123], v[52:55]
    ds_read_b64_tr_b16 v[162:163], v20 offset:46448
    s_waitcnt lgkmcnt(15)
    v_mfma_f32_16x16x32_bf16 v[56:59], v[76:79], v[164:167], v[56:59]
    s_setprio 3
    s_waitcnt vmcnt(5)
    s_barrier
    ds_read_b128 v[60:63], v16 offset:0
    ds_read_b128 v[68:71], v18 offset:0
    v_mfma_f32_16x16x32_bf16 v[56:59], v[84:87], v[168:171], v[56:59]
    ds_read_b64_tr_b16 v[124:125], v23 offset:0
    s_waitcnt lgkmcnt(15)
    v_mfma_f32_16x16x32_bf16 v[24:27], v[76:79], v[132:135], v[24:27]
    ds_read_b64_tr_b16 v[126:127], v23 offset:2304
    v_mov_b32 v220, 64
    s_cmp_lg_u32 s24, 0
    s_cbranch_scc1 LA_nc1
    global_load_dword v220, v221, s[56:57] sc1
    LA_nc1:
    v_mfma_f32_16x16x32_bf16 v[24:27], v[84:87], v[136:139], v[24:27]
    ds_read_b64_tr_b16 v[128:129], v23 offset:9216
    ds_read_b64_tr_b16 v[130:131], v23 offset:11520
    s_waitcnt lgkmcnt(15)
    v_mfma_f32_16x16x32_bf16 v[40:43], v[80:83], v[132:135], v[40:43]
    ds_read_b64_tr_b16 v[92:93], v22 offset:0
    v_mfma_f32_16x16x32_bf16 v[40:43], v[88:91], v[136:139], v[40:43]
    s_setprio 2
    ds_read_b64_tr_b16 v[94:95], v22 offset:2304
    s_add_u32 m0, s31, 0
    s_add_u32 s61, s29, 1024
    buffer_load_dwordx4 v7, s[20:23], s61 offen lds
    s_waitcnt lgkmcnt(15)
    v_mfma_f32_16x16x32_bf16 v[28:31], v[76:79], v[140:143], v[28:31]
    ds_read_b64_tr_b16 v[96:97], v22 offset:9216
    ds_read_b64_tr_b16 v[98:99], v22 offset:11520
    v_mfma_f32_16x16x32_bf16 v[28:31], v[84:87], v[144:147], v[28:31]
    ds_read_b128 v[64:67], v17 offset:0
    v_mfma_f32_16x16x32_bf16 v[44:47], v[80:83], v[140:143], v[44:47]
    ds_read_b128 v[72:75], v19 offset:0
    buffer_load_dwordx4 v8, s[20:23], s61 offen offset:1024 lds
    v_mfma_f32_16x16x32_bf16 v[44:47], v[88:91], v[144:147], v[44:47]
    s_setprio 1
    ds_read_b64_tr_b16 v[100:101], v22 offset:40
    ds_read_b64_tr_b16 v[102:103], v22 offset:2344
    s_waitcnt lgkmcnt(15)
    v_mfma_f32_16x16x32_bf16 v[32:35], v[76:79], v[148:151], v[32:35]
    ds_read_b64_tr_b16 v[104:105], v22 offset:9256
    v_mfma_f32_16x16x32_bf16 v[32:35], v[84:87], v[152:155], v[32:35]
    ds_read_b64_tr_b16 v[106:107], v22 offset:11560
    s_add_u32 m0, s32, 0
    s_add_u32 s61, s30, 1769472
    buffer_load_dwordx4 v9, s[16:19], s61 offen lds
    v_mfma_f32_16x16x32_bf16 v[48:51], v[80:83], v[148:151], v[48:51]
    ds_read_b64_tr_b16 v[108:109], v22 offset:72
    ds_read_b64_tr_b16 v[110:111], v22 offset:2376
    v_mfma_f32_16x16x32_bf16 v[48:51], v[88:91], v[152:155], v[48:51]
    ds_read_b64_tr_b16 v[112:113], v22 offset:9288
    s_waitcnt lgkmcnt(15)
    v_mfma_f32_16x16x32_bf16 v[36:39], v[76:79], v[156:159], v[36:39]
    s_setprio 0
    ds_read_b64_tr_b16 v[114:115], v22 offset:11592
    buffer_load_dwordx4 v10, s[16:19], s61 offen offset:1024 lds
    v_mfma_f32_16x16x32_bf16 v[36:39], v[84:87], v[160:163], v[36:39]
    ds_read_b64_tr_b16 v[116:117], v22 offset:112
    ds_read_b64_tr_b16 v[118:119], v22 offset:2416
    v_mfma_f32_16x16x32_bf16 v[52:55], v[80:83], v[156:159], v[52:55]
    ds_read_b64_tr_b16 v[120:121], v22 offset:9328
    v_mfma_f32_16x16x32_bf16 v[52:55], v[88:91], v[160:163], v[52:55]
    ds_read_b64_tr_b16 v[122:123], v22 offset:11632
    s_mov_b64 exec, 0xffff
    buffer_load_dwordx4 v11, s[16:19], s61 offen offset:2048 lds
    s_mov_b64 exec, -1
    s_waitcnt lgkmcnt(15)
    v_mfma_f32_16x16x32_bf16 v[56:59], v[60:63], v[124:127], v[56:59]
    s_setprio 3
    s_waitcnt vmcnt(5)
    LA_cntchk1:
    v_cmp_gt_u32 vcc, 64, v220
    s_cbranch_vccnz LA_cnt1
    LA_cntok1:
    s_barrier
    v_lshlrev_b32 v1, 4, v0
    s_mov_b32 m0, s39
    s_mov_b64 exec, 0xffff
    buffer_load_dwordx4 v1, s[12:15], s38 offen sc1 lds
    s_mov_b64 exec, -1
    ds_read_b128 v[76:79], v16 offset:34816
    ds_read_b128 v[84:87], v18 offset:34816
    v_mfma_f32_16x16x32_bf16 v[56:59], v[68:71], v[128:131], v[56:59]
    ds_read_b64_tr_b16 v[164:165], v23 offset:34816
    v_lshl_add_u32 v1, v6, 4, s37
    v_xor_b32 v220, 64, v1
    v_lshl_add_u32 v2, v5, 2, s50
    s_waitcnt lgkmcnt(15)
    v_mfma_f32_16x16x32_bf16 v[24:27], v[60:63], v[92:95], v[24:27]
    ds_read_b64_tr_b16 v[166:167], v23 offset:37120
    v_lshrrev_b32 v3, 2, v5
    v_lshlrev_b32 v3, 5, v3
    v_add_u32 v3, v3, v5
    v_lshlrev_b32 v3, 2, v3
    v_add_u32 v3, 140288, v3
    v_mfma_f32_16x16x32_bf16 v[24:27], v[68:71], v[96:99], v[24:27]
    ds_read_b64_tr_b16 v[168:169], v23 offset:44032
    ds_read_b64_tr_b16 v[170:171], v23 offset:46336
    s_add_u32 s51, s51, 4784128
    s_mul_i32 s52, s52, 1152
    s_add_u32 s51, s51, s52
    s_mul_i32 s52, s26, 589824
    s_add_u32 s52, s52, s51
    s_lshl_b32 s33, s26, 6
    s_add_u32 s51, s51, s33
    s_waitcnt lgkmcnt(15)
    v_mfma_f32_16x16x32_bf16 v[40:43], v[64:67], v[92:95], v[40:43]
    ds_read_b64_tr_b16 v[132:133], v22 offset:34816
    v_mfma_f32_16x16x32_bf16 v[40:43], v[72:75], v[96:99], v[40:43]
    s_setprio 2
    ds_read_b64_tr_b16 v[134:135], v22 offset:37120
    v_lshrrev_b32 v222, 1, v6
    v_xor_b32 v222, s26, v222
    v_lshlrev_b32 v222, 9, v222
    s_waitcnt lgkmcnt(15)
    v_mfma_f32_16x16x32_bf16 v[28:31], v[60:63], v[100:103], v[28:31]
    ds_read_b64_tr_b16 v[136:137], v22 offset:44032
    ds_read_b64_tr_b16 v[138:139], v22 offset:46336
    v_mfma_f32_16x16x32_bf16 v[28:31], v[68:71], v[104:107], v[28:31]
    ds_read_b128 v[80:83], v17 offset:34816
    v_and_b32 v4, 1, v6
    v_lshl_add_u32 v222, v4, 8, v222
    v_lshl_add_u32 v222, v5, 4, v222
    v_mfma_f32_16x16x32_bf16 v[44:47], v[64:67], v[100:103], v[44:47]
    ds_read_b128 v[88:91], v19 offset:34816
    v_lshrrev_b32 v223, 1, v5
    s_mov_b32 s33, 147456
    v_mul_lo_u32 v223, s33, v223
    v_lshl_add_u32 v223, v4, 5, v223
    v_mfma_f32_16x16x32_bf16 v[44:47], v[72:75], v[104:107], v[44:47]
    s_setprio 1
    ds_read_b64_tr_b16 v[140:141], v22 offset:34856
    ds_read_b64_tr_b16 v[142:143], v22 offset:37160
    v_and_b32 v4, 1, v5
    v_lshl_add_u32 v223, v4, 4, v223
    s_waitcnt lgkmcnt(15)
    v_mfma_f32_16x16x32_bf16 v[32:35], v[60:63], v[108:111], v[32:35]
    ds_read_b64_tr_b16 v[144:145], v22 offset:44072
    v_mfma_f32_16x16x32_bf16 v[32:35], v[68:71], v[112:115], v[32:35]
    ds_read_b64_tr_b16 v[146:147], v22 offset:46376
    v_mfma_f32_16x16x32_bf16 v[48:51], v[64:67], v[108:111], v[48:51]
    ds_read_b64_tr_b16 v[148:149], v22 offset:34888
    ds_read_b64_tr_b16 v[150:151], v22 offset:37192
    v_mfma_f32_16x16x32_bf16 v[48:51], v[72:75], v[112:115], v[48:51]
    ds_read_b64_tr_b16 v[152:153], v22 offset:44104
    s_waitcnt lgkmcnt(15)
    v_mfma_f32_16x16x32_bf16 v[36:39], v[60:63], v[116:119], v[36:39]
    s_setprio 0
    ds_read_b64_tr_b16 v[154:155], v22 offset:46408
    v_mfma_f32_16x16x32_bf16 v[36:39], v[68:71], v[120:123], v[36:39]
    ds_read_b64_tr_b16 v[156:157], v22 offset:34928
    ds_read_b64_tr_b16 v[158:159], v22 offset:37232
    v_mfma_f32_16x16x32_bf16 v[52:55], v[64:67], v[116:119], v[52:55]
    ds_read_b64_tr_b16 v[160:161], v22 offset:44144
    v_mfma_f32_16x16x32_bf16 v[52:55], v[72:75], v[120:123], v[52:55]
    ds_read_b64_tr_b16 v[162:163], v22 offset:46448
    s_waitcnt lgkmcnt(15)
    v_mfma_f32_16x16x32_bf16 v[56:59], v[76:79], v[164:167], v[56:59]
    s_setprio 3
    s_waitcnt vmcnt(0)
    s_barrier
    ds_read_b128 v[172:175], v1 offset:0
    ds_read_b128 v[176:179], v220 offset:0
    v_mfma_f32_16x16x32_bf16 v[56:59], v[84:87], v[168:171], v[56:59]
    ds_read_b128 v[180:183], v1 offset:512
    ds_read_b128 v[184:187], v220 offset:512
    s_waitcnt lgkmcnt(15)
    v_mfma_f32_16x16x32_bf16 v[24:27], v[76:79], v[132:135], v[24:27]
    ds_read_b32 v196, v3 offset:64
    ds_read_b32 v192, v2 offset:0
    v_mfma_f32_16x16x32_bf16 v[24:27], v[84:87], v[136:139], v[24:27]
    ds_read_b32 v193, v2 offset:80
    ds_read_b32 v194, v2 offset:144
    s_waitcnt lgkmcnt(15)
    v_mfma_f32_16x16x32_bf16 v[40:43], v[80:83], v[132:135], v[40:43]
    ds_read_b32 v195, v2 offset:224
    ds_read_b128 v[60:63], v12 offset:0
    v_mfma_f32_16x16x32_bf16 v[40:43], v[88:91], v[136:139], v[40:43]
    s_setprio 2
    ds_read_b128 v[68:71], v14 offset:0
    ds_read_b64_tr_b16 v[124:125], v21 offset:0
    s_waitcnt lgkmcnt(15)
    v_mfma_f32_16x16x32_bf16 v[28:31], v[76:79], v[140:143], v[28:31]
    ds_read_b64_tr_b16 v[126:127], v21 offset:2304
    ds_read_b64_tr_b16 v[128:129], v21 offset:9216
    v_mfma_f32_16x16x32_bf16 v[28:31], v[84:87], v[144:147], v[28:31]
    ds_read_b64_tr_b16 v[130:131], v21 offset:11520
    ds_read_b64_tr_b16 v[92:93], v20 offset:0
    v_mfma_f32_16x16x32_bf16 v[44:47], v[80:83], v[140:143], v[44:47]
    ds_read_b64_tr_b16 v[94:95], v20 offset:2304
    ds_read_b64_tr_b16 v[96:97], v20 offset:9216
    v_mfma_f32_16x16x32_bf16 v[44:47], v[88:91], v[144:147], v[44:47]
    s_setprio 1
    ds_read_b64_tr_b16 v[98:99], v20 offset:11520
    ds_read_b128 v[64:67], v13 offset:0
    s_waitcnt lgkmcnt(15)
    v_mfma_f32_16x16x32_bf16 v[32:35], v[76:79], v[148:151], v[32:35]
    ds_read_b128 v[72:75], v15 offset:0
    ds_read_b64_tr_b16 v[100:101], v20 offset:40
    v_mfma_f32_16x16x32_bf16 v[32:35], v[84:87], v[152:155], v[32:35]
    ds_read_b64_tr_b16 v[102:103], v20 offset:2344
    ds_read_b64_tr_b16 v[104:105], v20 offset:9256
    v_mfma_f32_16x16x32_bf16 v[48:51], v[80:83], v[148:151], v[48:51]
    ds_read_b64_tr_b16 v[106:107], v20 offset:11560
    ds_read_b64_tr_b16 v[108:109], v20 offset:72
    v_mfma_f32_16x16x32_bf16 v[48:51], v[88:91], v[152:155], v[48:51]
    ds_read_b64_tr_b16 v[110:111], v20 offset:2376
    ds_read_b64_tr_b16 v[112:113], v20 offset:9288
    s_waitcnt lgkmcnt(15)
    v_mfma_f32_16x16x32_bf16 v[36:39], v[76:79], v[156:159], v[36:39]
    s_setprio 0
    ds_read_b64_tr_b16 v[114:115], v20 offset:11592
    ds_read_b64_tr_b16 v[116:117], v20 offset:112
    v_mfma_f32_16x16x32_bf16 v[36:39], v[84:87], v[160:163], v[36:39]
    ds_read_b64_tr_b16 v[118:119], v20 offset:2416
    ds_read_b64_tr_b16 v[120:121], v20 offset:9328
    v_mfma_f32_16x16x32_bf16 v[52:55], v[80:83], v[156:159], v[52:55]
    ds_read_b64_tr_b16 v[122:123], v20 offset:11632
    v_mfma_f32_16x16x32_bf16 v[52:55], v[88:91], v[160:163], v[52:55]
    s_waitcnt lgkmcnt(15)
    v_mfma_f32_16x16x32_bf16 v[56:59], v[60:63], v[124:127], v[56:59]
    s_setprio 3
    v_mfma_f32_16x16x32_bf16 v[56:59], v[68:71], v[128:131], v[56:59]
    s_waitcnt lgkmcnt(14)
    v_mfma_f32_16x16x32_bf16 v[24:27], v[60:63], v[92:95], v[24:27]
    v_mfma_f32_16x16x32_bf16 v[24:27], v[68:71], v[96:99], v[24:27]
    s_waitcnt lgkmcnt(12)
    v_mfma_f32_16x16x32_bf16 v[40:43], v[64:67], v[92:95], v[40:43]
    s_nop 2
    v_fma_f32 v56, -v172, v196, v56
    v_fma_f32 v57, -v173, v196, v57
    v_fma_f32 v58, -v174, v196, v58
    v_fma_f32 v59, -v175, v196, v59
    v_mfma_f32_16x16x32_bf16 v[40:43], v[72:75], v[96:99], v[40:43]
    s_setprio 2
    v_mul_f32 v56, v180, v56
    v_mul_f32 v57, v181, v57
    v_mul_f32 v58, v182, v58
    v_mul_f32 v59, v183, v59
    v_cvt_pk_bf16_f32 v216, v56, v57
    s_waitcnt lgkmcnt(8)
    v_mfma_f32_16x16x32_bf16 v[28:31], v[60:63], v[100:103], v[28:31]
    v_cvt_pk_bf16_f32 v217, v58, v59
    v_mov_b32 v218, v216
    v_mov_b32 v219, v217
    s_nop 1
    v_permlane32_swap_b32 v216, v218
    v_permlane32_swap_b32 v217, v219
    s_mov_b32 exec_hi, 0
    buffer_store_dwordx4 v[216:219], v223, s[12:15], s51 offen offset:1024 sc1
    s_mov_b32 exec_hi, -1
    v_mfma_f32_16x16x32_bf16 v[28:31], v[68:71], v[104:107], v[28:31]
    v_mfma_f32_16x16x32_bf16 v[44:47], v[64:67], v[100:103], v[44:47]
    v_fma_f32 v24, -v172, v192, v24
    v_fma_f32 v25, -v173, v192, v25
    v_fma_f32 v26, -v174, v192, v26
    v_fma_f32 v27, -v175, v192, v27
    v_mul_f32 v24, v180, v24
    v_mul_f32 v25, v181, v25
    v_mul_f32 v26, v182, v26
    v_mul_f32 v27, v183, v27
    v_cvt_pk_bf16_f32 v200, v24, v25
    v_cvt_pk_bf16_f32 v201, v26, v27
    v_fma_f32 v40, -v176, v192, v40
    v_fma_f32 v41, -v177, v192, v41
    v_fma_f32 v42, -v178, v192, v42
    v_mfma_f32_16x16x32_bf16 v[44:47], v[72:75], v[104:107], v[44:47]
    s_setprio 1
    v_fma_f32 v43, -v179, v192, v43
    v_mul_f32 v40, v184, v40
    v_mul_f32 v41, v185, v41
    v_mul_f32 v42, v186, v42
    v_mul_f32 v43, v187, v43
    s_waitcnt lgkmcnt(4)
    v_mfma_f32_16x16x32_bf16 v[32:35], v[60:63], v[108:111], v[32:35]
    v_cvt_pk_bf16_f32 v202, v40, v41
    v_cvt_pk_bf16_f32 v203, v42, v43
    s_add_u32 s33, s52, 0
    s_nop 0
    v_permlane32_swap_b32 v200, v202
    v_permlane32_swap_b32 v201, v203
    buffer_store_dwordx4 v[200:203], v222, s[12:15], s33 offen sc1
    v_mfma_f32_16x16x32_bf16 v[32:35], v[68:71], v[112:115], v[32:35]
    v_mfma_f32_16x16x32_bf16 v[48:51], v[64:67], v[108:111], v[48:51]
    v_fma_f32 v28, -v172, v193, v28
    v_fma_f32 v29, -v173, v193, v29
    v_fma_f32 v30, -v174, v193, v30
    v_fma_f32 v31, -v175, v193, v31
    v_mul_f32 v28, v180, v28
    v_mul_f32 v29, v181, v29
    v_mul_f32 v30, v182, v30
    v_mul_f32 v31, v183, v31
    v_cvt_pk_bf16_f32 v204, v28, v29
    v_cvt_pk_bf16_f32 v205, v30, v31
    v_fma_f32 v44, -v176, v193, v44
    v_fma_f32 v45, -v177, v193, v45
    v_mfma_f32_16x16x32_bf16 v[48:51], v[72:75], v[112:115], v[48:51]
    v_fma_f32 v46, -v178, v193, v46
    v_fma_f32 v47, -v179, v193, v47
    v_mul_f32 v44, v184, v44
    v_mul_f32 v45, v185, v45
    v_mul_f32 v46, v186, v46
    s_waitcnt lgkmcnt(0)
    v_mfma_f32_16x16x32_bf16 v[36:39], v[60:63], v[116:119], v[36:39]
    s_setprio 0
    v_mul_f32 v47, v187, v47
    v_cvt_pk_bf16_f32 v206, v44, v45
    v_cvt_pk_bf16_f32 v207, v46, v47
    s_add_u32 s33, s52, 147456
    s_nop 0
    v_permlane32_swap_b32 v204, v206
    v_permlane32_swap_b32 v205, v207
    buffer_store_dwordx4 v[204:207], v222, s[12:15], s33 offen sc1
    v_mfma_f32_16x16x32_bf16 v[36:39], v[68:71], v[120:123], v[36:39]
    v_mfma_f32_16x16x32_bf16 v[52:55], v[64:67], v[116:119], v[52:55]
    v_fma_f32 v32, -v172, v194, v32
    v_fma_f32 v33, -v173, v194, v33
    v_fma_f32 v34, -v174, v194, v34
    v_fma_f32 v35, -v175, v194, v35
    v_mul_f32 v32, v180, v32
    v_mul_f32 v33, v181, v33
    v_mul_f32 v34, v182, v34
    v_mul_f32 v35, v183, v35
    v_cvt_pk_bf16_f32 v208, v32, v33
    v_cvt_pk_bf16_f32 v209, v34, v35
    v_fma_f32 v48, -v176, v194, v48
    v_mfma_f32_16x16x32_bf16 v[52:55], v[72:75], v[120:123], v[52:55]
    v_fma_f32 v49, -v177, v194, v49
    v_fma_f32 v50, -v178, v194, v50
    v_fma_f32 v51, -v179, v194, v51
    v_mul_f32 v48, v184, v48
    v_mul_f32 v49, v185, v49
    v_mul_f32 v50, v186, v50
    v_mul_f32 v51, v187, v51
    v_cvt_pk_bf16_f32 v210, v48, v49
    v_cvt_pk_bf16_f32 v211, v50, v51
    s_add_u32 s33, s52, 294912
    s_nop 0
    v_permlane32_swap_b32 v208, v210
    v_permlane32_swap_b32 v209, v211
    buffer_store_dwordx4 v[208:211], v222, s[12:15], s33 offen sc1
    s_nop 2
    v_fma_f32 v36, -v172, v195, v36
    v_fma_f32 v37, -v173, v195, v37
    v_fma_f32 v38, -v174, v195, v38
    v_fma_f32 v39, -v175, v195, v39
    v_mul_f32 v36, v180, v36
    v_mul_f32 v37, v181, v37
    v_mul_f32 v38, v182, v38
    v_mul_f32 v39, v183, v39
    v_cvt_pk_bf16_f32 v212, v36, v37
    v_cvt_pk_bf16_f32 v213, v38, v39
    v_fma_f32 v52, -v176, v195, v52
    v_fma_f32 v53, -v177, v195, v53
    v_fma_f32 v54, -v178, v195, v54
    v_fma_f32 v55, -v179, v195, v55
    v_mul_f32 v52, v184, v52
    v_mul_f32 v53, v185, v53
    v_mul_f32 v54, v186, v54
    v_mul_f32 v55, v187, v55
    v_cvt_pk_bf16_f32 v214, v52, v53
    v_cvt_pk_bf16_f32 v215, v54, v55
    s_add_u32 s33, s52, 442368
    s_nop 0
    v_permlane32_swap_b32 v212, v214
    v_permlane32_swap_b32 v213, v215
    buffer_store_dwordx4 v[212:215], v222, s[12:15], s33 offen sc1
    s_branch LA_end
LA_rvec:
    s_waitcnt lgkmcnt(0)
    s_mov_b32 s12, s8
    s_mov_b32 s13, s9
    s_mov_b32 s14, 67108864
    s_mov_b32 s15, 0x20000
    s_mov_b32 s20, s4
    s_mov_b32 s21, s5
    s_mov_b32 s22, 2359296
    s_mov_b32 s23, 0x20000
    s_mov_b32 s16, s6
    s_mov_b32 s17, s7
    s_mov_b32 s18, 1990656
    s_mov_b32 s19, 0x20000
    s_sub_u32 s62, s2, 192
    s_lshl_b32 s62, s62, 3
    s_add_u32 s62, s62, s24
    s_lshl_b32 s62, s62, 10
    s_add_u32 s62, s62, 54538240
    v_lshlrev_b32 v3, 7, v0
    v_mov_b32 v4, 0
    s_mov_b64 exec, 0xff
    buffer_store_dword v4, v3, s[12:15], s62 offen sc1
    s_mov_b64 exec, -1
    s_mov_b32 s55, s2
    s_mov_b32 s60, 0x20000
    s_bfe_u32 s36, s2, 0x30003
    v_lshrrev_b32 v54, 3, v0
    v_and_b32 v2, 7, v0
    s_cmp_ge_u32 s36, 4
    s_cbranch_scc1 LA_col
    s_and_b32 s33, s2, 3
    s_lshl_b32 s33, s33, 3
    s_and_b32 s34, s2, 4
    s_add_u32 s33, s33, s34
    s_add_u32 s33, s33, s36
    s_lshl_b32 s33, s33, 3
    s_add_u32 s37, s33, s24
    s_mul_i32 s33, s37, 9216
    v_mul_u32_u24 v1, 1152, v54
    v_lshl_add_u32 v1, v2, 4, v1
    buffer_load_dwordx4 v[16:19], v1, s[20:23], s33 offen offset:0
    buffer_load_dwordx4 v[20:23], v1, s[20:23], s33 offen offset:128
    buffer_load_dwordx4 v[24:27], v1, s[20:23], s33 offen offset:256
    buffer_load_dwordx4 v[28:31], v1, s[20:23], s33 offen offset:384
    buffer_load_dwordx4 v[32:35], v1, s[20:23], s33 offen offset:512
    buffer_load_dwordx4 v[36:39], v1, s[20:23], s33 offen offset:640
    buffer_load_dwordx4 v[40:43], v1, s[20:23], s33 offen offset:768
    buffer_load_dwordx4 v[44:47], v1, s[20:23], s33 offen offset:896
    buffer_load_dwordx4 v[48:51], v1, s[20:23], s33 offen offset:1024
    v_mov_b32 v52, 0
    v_mov_b32 v53, 0
    s_waitcnt vmcnt(8)
    v_dot2c_f32_bf16 v52, s35, v16
    v_dot2c_f32_bf16 v53, v16, v16
    v_dot2c_f32_bf16 v52, s35, v17
    v_dot2c_f32_bf16 v53, v17, v17
    v_dot2c_f32_bf16 v52, s35, v18
    v_dot2c_f32_bf16 v53, v18, v18
    v_dot2c_f32_bf16 v52, s35, v19
    v_dot2c_f32_bf16 v53, v19, v19
    s_waitcnt vmcnt(7)
    v_dot2c_f32_bf16 v52, s35, v20
    v_dot2c_f32_bf16 v53, v20, v20
    v_dot2c_f32_bf16 v52, s35, v21
    v_dot2c_f32_bf16 v53, v21, v21
    v_dot2c_f32_bf16 v52, s35, v22
    v_dot2c_f32_bf16 v53, v22, v22
    v_dot2c_f32_bf16 v52, s35, v23
    v_dot2c_f32_bf16 v53, v23, v23
    s_waitcnt vmcnt(6)
    v_dot2c_f32_bf16 v52, s35, v24
    v_dot2c_f32_bf16 v53, v24, v24
    v_dot2c_f32_bf16 v52, s35, v25
    v_dot2c_f32_bf16 v53, v25, v25
    v_dot2c_f32_bf16 v52, s35, v26
    v_dot2c_f32_bf16 v53, v26, v26
    v_dot2c_f32_bf16 v52, s35, v27
    v_dot2c_f32_bf16 v53, v27, v27
    s_waitcnt vmcnt(5)
    v_dot2c_f32_bf16 v52, s35, v28
    v_dot2c_f32_bf16 v53, v28, v28
    v_dot2c_f32_bf16 v52, s35, v29
    v_dot2c_f32_bf16 v53, v29, v29
    v_dot2c_f32_bf16 v52, s35, v30
    v_dot2c_f32_bf16 v53, v30, v30
    v_dot2c_f32_bf16 v52, s35, v31
    v_dot2c_f32_bf16 v53, v31, v31
    s_waitcnt vmcnt(4)
    v_dot2c_f32_bf16 v52, s35, v32
    v_dot2c_f32_bf16 v53, v32, v32
    v_dot2c_f32_bf16 v52, s35, v33
    v_dot2c_f32_bf16 v53, v33, v33
    v_dot2c_f32_bf16 v52, s35, v34
    v_dot2c_f32_bf16 v53, v34, v34
    v_dot2c_f32_bf16 v52, s35, v35
    v_dot2c_f32_bf16 v53, v35, v35
    s_waitcnt vmcnt(3)
    v_dot2c_f32_bf16 v52, s35, v36
    v_dot2c_f32_bf16 v53, v36, v36
    v_dot2c_f32_bf16 v52, s35, v37
    v_dot2c_f32_bf16 v53, v37, v37
    v_dot2c_f32_bf16 v52, s35, v38
    v_dot2c_f32_bf16 v53, v38, v38
    v_dot2c_f32_bf16 v52, s35, v39
    v_dot2c_f32_bf16 v53, v39, v39
    s_waitcnt vmcnt(2)
    v_dot2c_f32_bf16 v52, s35, v40
    v_dot2c_f32_bf16 v53, v40, v40
    v_dot2c_f32_bf16 v52, s35, v41
    v_dot2c_f32_bf16 v53, v41, v41
    v_dot2c_f32_bf16 v52, s35, v42
    v_dot2c_f32_bf16 v53, v42, v42
    v_dot2c_f32_bf16 v52, s35, v43
    v_dot2c_f32_bf16 v53, v43, v43
    s_waitcnt vmcnt(1)
    v_dot2c_f32_bf16 v52, s35, v44
    v_dot2c_f32_bf16 v53, v44, v44
    v_dot2c_f32_bf16 v52, s35, v45
    v_dot2c_f32_bf16 v53, v45, v45
    v_dot2c_f32_bf16 v52, s35, v46
    v_dot2c_f32_bf16 v53, v46, v46
    v_dot2c_f32_bf16 v52, s35, v47
    v_dot2c_f32_bf16 v53, v47, v47
    s_waitcnt vmcnt(0)
    v_dot2c_f32_bf16 v52, s35, v48
    v_dot2c_f32_bf16 v53, v48, v48
    v_dot2c_f32_bf16 v52, s35, v49
    v_dot2c_f32_bf16 v53, v49, v49
    v_dot2c_f32_bf16 v52, s35, v50
    v_dot2c_f32_bf16 v53, v50, v50
    v_dot2c_f32_bf16 v52, s35, v51
    v_dot2c_f32_bf16 v53, v51, v51
    s_nop 3
    v_add_f32_dpp v52, v52, v52 quad_perm:[1,0,3,2] row_mask:0xf bank_mask:0xf
    s_nop 1
    v_add_f32_dpp v52, v52, v52 quad_perm:[2,3,0,1] row_mask:0xf bank_mask:0xf
    s_nop 1
    v_add_f32_dpp v52, v52, v52 row_half_mirror row_mask:0xf bank_mask:0xf
    v_add_f32_dpp v53, v53, v53 quad_perm:[1,0,3,2] row_mask:0xf bank_mask:0xf
    s_nop 1
    v_add_f32_dpp v53, v53, v53 quad_perm:[2,3,0,1] row_mask:0xf bank_mask:0xf
    s_nop 1
    v_add_f32_dpp v53, v53, v53 row_half_mirror row_mask:0xf bank_mask:0xf
    v_mul_f32 v64, 0x3ae38e39, v52
    v_mul_f32 v1, 0x3ae38e39, v53
    v_fma_f32 v1, -v64, v64, v1
    v_max_f32 v1, 0, v1
    v_cvt_pk_bf16_f32 v65, v64, v64
    v_lshlrev_b32 v65, 16, v65
    v_cvt_pk_bf16_f32 v1, v1, v1
    v_lshlrev_b32 v1, 16, v1
    v_add_f32 v1, 0x3727c5ac, v1
    v_cvt_pk_bf16_f32 v1, v1, v1
    v_lshlrev_b32 v1, 16, v1
    v_sqrt_f32 v1, v1
    s_nop 0
    v_cvt_pk_bf16_f32 v1, v1, v1
    v_lshlrev_b32 v1, 16, v1
    v_rcp_f32 v66, v1
    s_nop 0
    v_lshlrev_b32 v1, 2, v54
    s_lshl_b32 s37, s37, 5
    s_add_u32 s33, s37, 54493184
    s_add_u32 s34, s37, 54501376
    s_add_u32 s37, s37, 54525952
    s_mov_b32 exec_lo, 0x01010101
    s_mov_b32 exec_hi, 0x01010101
    buffer_store_dword v65, v1, s[12:15], s33 offen sc1
    buffer_store_dword v66, v1, s[12:15], s34 offen sc1
    buffer_store_dword v64, v1, s[12:15], s37 offen sc1
    s_mov_b64 exec, -1
    s_branch LA_hdone
LA_col:
    s_and_b32 s36, s36, 3
    s_lshl_b32 s36, s36, 2
    s_and_b32 s33, s2, 3
    s_add_u32 s36, s36, s33
    s_bfe_u32 s37, s2, 0x10002
    s_sub_u32 s33, 14, s37
    s_cmp_ge_u32 s36, s33
    s_cbranch_scc1 LA_rv
    s_mul_i32 s37, s37, 14
    s_add_u32 s37, s37, s36
    s_mul_i32 s33, s24, 27648
    s_lshl_b32 s34, s37, 7
    s_add_u32 s33, s33, s34
    v_mul_u32_u24 v1, 3456, v54
    v_lshl_add_u32 v1, v2, 4, v1
    buffer_load_dwordx4 v[16:19], v1, s[16:19], s33 offen
    s_add_u32 s33, s33, 221184
    buffer_load_dwordx4 v[20:23], v1, s[16:19], s33 offen
    s_add_u32 s33, s33, 221184
    buffer_load_dwordx4 v[24:27], v1, s[16:19], s33 offen
    s_add_u32 s33, s33, 221184
    buffer_load_dwordx4 v[28:31], v1, s[16:19], s33 offen
    s_add_u32 s33, s33, 221184
    buffer_load_dwordx4 v[32:35], v1, s[16:19], s33 offen
    s_add_u32 s33, s33, 221184
    buffer_load_dwordx4 v[36:39], v1, s[16:19], s33 offen
    s_add_u32 s33, s33, 221184
    buffer_load_dwordx4 v[40:43], v1, s[16:19], s33 offen
    s_add_u32 s33, s33, 221184
    buffer_load_dwordx4 v[44:47], v1, s[16:19], s33 offen
    s_add_u32 s33, s33, 221184
    buffer_load_dwordx4 v[48:51], v1, s[16:19], s33 offen
    v_and_b32 v1, 1, v0
    v_lshlrev_b32 v1, 4, v1
    v_mov_b32 v3, 0x3f80
    v_lshlrev_b32 v1, v1, v3
    v_lshrrev_b32 v3, 1, v5
    v_cmp_eq_u32 vcc, 0, v3
    s_nop 1
    v_cndmask_b32 v56, 0, v1, vcc
    v_cmp_eq_u32 vcc, 1, v3
    s_nop 1
    v_cndmask_b32 v57, 0, v1, vcc
    v_cmp_eq_u32 vcc, 2, v3
    s_nop 1
    v_cndmask_b32 v58, 0, v1, vcc
    v_cmp_eq_u32 vcc, 3, v3
    s_nop 1
    v_cndmask_b32 v59, 0, v1, vcc
    v_lshlrev_b32 v1, 5, v2
    v_lshl_add_u32 v1, v6, 4, v1
    s_lshl_b32 s33, s24, 8
    v_add_u32 v1, s33, v1
    s_waitcnt vmcnt(8)
    v_mfma_f32_16x16x32_bf16 v[60:63], v[56:59], v[16:19], 0
    s_waitcnt vmcnt(7)
    v_mfma_f32_16x16x32_bf16 v[60:63], v[56:59], v[20:23], v[60:63]
    s_waitcnt vmcnt(6)
    v_mfma_f32_16x16x32_bf16 v[60:63], v[56:59], v[24:27], v[60:63]
    s_waitcnt vmcnt(5)
    v_mfma_f32_16x16x32_bf16 v[60:63], v[56:59], v[28:31], v[60:63]
    s_waitcnt vmcnt(4)
    v_mfma_f32_16x16x32_bf16 v[60:63], v[56:59], v[32:35], v[60:63]
    s_waitcnt vmcnt(3)
    v_mfma_f32_16x16x32_bf16 v[60:63], v[56:59], v[36:39], v[60:63]
    s_waitcnt vmcnt(2)
    v_mfma_f32_16x16x32_bf16 v[60:63], v[56:59], v[40:43], v[60:63]
    s_waitcnt vmcnt(1)
    v_mfma_f32_16x16x32_bf16 v[60:63], v[56:59], v[44:47], v[60:63]
    s_waitcnt vmcnt(0)
    v_mfma_f32_16x16x32_bf16 v[60:63], v[56:59], v[48:51], v[60:63]
    s_nop 7
    v_add_f32_dpp v60, v60, v60 row_ror:8 row_mask:0xf bank_mask:0xf
    v_add_f32_dpp v61, v61, v61 row_ror:8 row_mask:0xf bank_mask:0xf
    v_add_f32_dpp v62, v62, v62 row_ror:8 row_mask:0xf bank_mask:0xf
    v_add_f32_dpp v63, v63, v63 row_ror:8 row_mask:0xf bank_mask:0xf
    s_mov_b64 exec, 0x00ff00ff
    ds_write_b128 v1, v[60:63]
    s_mov_b64 exec, -1
    v_lshlrev_b32 v1, 2, v0
    s_waitcnt lgkmcnt(0)
    s_barrier
    s_cmp_lg_u32 s24, 0
    s_cbranch_scc1 LA_hdone
    ds_read_b32 v16, v1 offset:0
    ds_read_b32 v17, v1 offset:256
    ds_read_b32 v18, v1 offset:512
    ds_read_b32 v19, v1 offset:768
    ds_read_b32 v20, v1 offset:1024
    ds_read_b32 v21, v1 offset:1280
    ds_read_b32 v22, v1 offset:1536
    ds_read_b32 v23, v1 offset:1792
    s_waitcnt lgkmcnt(0)
    v_add_f32 v16, v16, v17
    v_add_f32 v16, v16, v18
    v_add_f32 v16, v16, v19
    v_add_f32 v16, v16, v20
    v_add_f32 v16, v16, v21
    v_add_f32 v16, v16, v22
    v_add_f32 v16, v16, v23
    s_lshl_b32 s33, s37, 8
    s_add_u32 s33, s33, 54509568
    buffer_store_dword v16, v1, s[12:15], s33 offen sc1
    s_branch LA_hdone
LA_rv:
    s_waitcnt vmcnt(0)
    s_barrier
    s_cmp_lg_u32 s24, 0
    s_cbranch_scc1 LA_arr0
    v_mov_b32 v1, 0
    v_mov_b32 v2, 1
    s_mov_b64 exec, 1
    global_atomic_add v1, v2, s[56:57] offset:0 sc1
    s_mov_b64 exec, -1
    LA_arr0:
    s_mov_b32 s16, s10
    s_mov_b32 s17, s11
    s_mov_b32 s18, 663552
    s_mov_b32 s19, 0x20000
    s_sub_u32 s36, s36, s33
    s_lshl_b32 s37, s37, 1
    s_add_u32 s36, s36, s37
    s_lshl_b32 s36, s36, 3
    s_add_u32 s36, s36, s24
    s_lshl_b32 s36, s36, 4
    s_mov_b32 s38, 2
    v_add_u32 v54, s36, v54
    LA_rvl:
    s_cmp_ge_u32 s36, 576
    s_cbranch_scc1 LA_rvd
    v_mul_u32_u24 v1, 1152, v54
    v_and_b32 v2, 7, v0
    v_lshl_add_u32 v1, v2, 4, v1
    buffer_load_dwordx4 v[16:19], v1, s[16:19], 0 offen offset:0
    buffer_load_dwordx4 v[20:23], v1, s[16:19], 0 offen offset:128
    buffer_load_dwordx4 v[24:27], v1, s[16:19], 0 offen offset:256
    buffer_load_dwordx4 v[28:31], v1, s[16:19], 0 offen offset:384
    buffer_load_dwordx4 v[32:35], v1, s[16:19], 0 offen offset:512
    buffer_load_dwordx4 v[36:39], v1, s[16:19], 0 offen offset:640
    buffer_load_dwordx4 v[40:43], v1, s[16:19], 0 offen offset:768
    buffer_load_dwordx4 v[44:47], v1, s[16:19], 0 offen offset:896
    buffer_load_dwordx4 v[48:51], v1, s[16:19], 0 offen offset:1024
    v_mov_b32 v52, 0
    v_mul_u32_u24 v1, 1821, v54
    v_lshrrev_b32 v1, 16, v1
    v_mul_u32_u24 v2, 36, v1
    v_sub_u32 v2, v54, v2
    v_lshl_add_u32 v3, v1, 5, v2
    v_subrev_u32 v4, 4, v3
    v_cmp_lt_u32 vcc, 19, v2
    s_nop 1
    v_cndmask_b32 v3, v3, v4, vcc
    v_lshl_add_u32 v4, v1, 2, v2
    v_add_u32 v4, 496, v4
    v_lshrrev_b32 v2, 2, v2
    v_cmp_eq_u32 vcc, 4, v2
    s_nop 1
    v_cndmask_b32 v3, v3, v4, vcc
    v_and_b32 v1, 4294967283, v3
    v_and_b32 v2, 4, v3
    v_lshl_or_b32 v1, v2, 1, v1
    v_and_b32 v2, 8, v3
    v_lshrrev_b32 v2, 1, v2
    v_or_b32 v1, v1, v2
    v_lshlrev_b32 v1, 1, v1
    s_waitcnt vmcnt(0)
    v_dot2c_f32_bf16 v52, s35, v16
    v_dot2c_f32_bf16 v52, s35, v17
    v_dot2c_f32_bf16 v52, s35, v18
    v_dot2c_f32_bf16 v52, s35, v19
    v_dot2c_f32_bf16 v52, s35, v20
    v_dot2c_f32_bf16 v52, s35, v21
    v_dot2c_f32_bf16 v52, s35, v22
    v_dot2c_f32_bf16 v52, s35, v23
    v_dot2c_f32_bf16 v52, s35, v24
    v_dot2c_f32_bf16 v52, s35, v25
    v_dot2c_f32_bf16 v52, s35, v26
    v_dot2c_f32_bf16 v52, s35, v27
    v_dot2c_f32_bf16 v52, s35, v28
    v_dot2c_f32_bf16 v52, s35, v29
    v_dot2c_f32_bf16 v52, s35, v30
    v_dot2c_f32_bf16 v52, s35, v31
    v_dot2c_f32_bf16 v52, s35, v32
    v_dot2c_f32_bf16 v52, s35, v33
    v_dot2c_f32_bf16 v52, s35, v34
    v_dot2c_f32_bf16 v52, s35, v35
    v_dot2c_f32_bf16 v52, s35, v36
    v_dot2c_f32_bf16 v52, s35, v37
    v_dot2c_f32_bf16 v52, s35, v38
    v_dot2c_f32_bf16 v52, s35, v39
    v_dot2c_f32_bf16 v52, s35, v40
    v_dot2c_f32_bf16 v52, s35, v41
    v_dot2c_f32_bf16 v52, s35, v42
    v_dot2c_f32_bf16 v52, s35, v43
    v_dot2c_f32_bf16 v52, s35, v44
    v_dot2c_f32_bf16 v52, s35, v45
    v_dot2c_f32_bf16 v52, s35, v46
    v_dot2c_f32_bf16 v52, s35, v47
    v_dot2c_f32_bf16 v52, s35, v48
    v_dot2c_f32_bf16 v52, s35, v49
    v_dot2c_f32_bf16 v52, s35, v50
    v_dot2c_f32_bf16 v52, s35, v51
    s_nop 3
    v_add_f32_dpp v52, v52, v52 quad_perm:[1,0,3,2] row_mask:0xf bank_mask:0xf
    s_nop 1
    v_add_f32_dpp v52, v52, v52 quad_perm:[2,3,0,1] row_mask:0xf bank_mask:0xf
    s_nop 1
    v_add_f32_dpp v52, v52, v52 row_half_mirror row_mask:0xf bank_mask:0xf
    v_mul_f32 v52, 0x3ae38e39, v52
    v_cvt_pk_bf16_f32 v53, v52, v52
    v_lshlrev_b32 v2, 16, v53
    v_sub_f32 v52, v52, v2
    v_cvt_pk_bf16_f32 v52, v52, v52
    s_mov_b32 exec_lo, 0x01010101
    s_mov_b32 exec_hi, 0x01010101
    s_mov_b32 s33, 54534144
    buffer_store_short v53, v1, s[12:15], s33 offen sc1
    buffer_store_short v52, v1, s[12:15], s33 offen offset:1152 sc1
    s_mov_b64 exec, -1
    v_add_u32 v54, 8, v54
    s_sub_u32 s38, s38, 1
    s_cmp_lg_u32 s38, 0
    s_cbranch_scc1 LA_rvl
    LA_rvd:
    s_mov_b32 s16, s6
    s_mov_b32 s17, s7
    s_mov_b32 s18, 1990656
    s_mov_b32 s19, 0x20000
    s_waitcnt vmcnt(0)
    s_barrier
    s_cmp_lg_u32 s24, 0
    s_cbranch_scc1 LA_arr2
    v_mov_b32 v1, 0
    v_mov_b32 v2, 1
    s_mov_b64 exec, 1
    global_atomic_add v1, v2, s[56:57] offset:128 sc1
    s_mov_b64 exec, -1
    LA_arr2:
    s_branch LA_hpf
LA_hdone:
    s_waitcnt vmcnt(0)
    s_barrier
    s_cmp_lg_u32 s24, 0
    s_cbranch_scc1 LA_arr1
    v_mov_b32 v1, 0
    v_mov_b32 v2, 1
    s_mov_b64 exec, 1
    global_atomic_add v1, v2, s[56:57] offset:0 sc1
    s_mov_b64 exec, -1
    LA_arr1:
LA_hpf:
    s_getpc_b64 s[36:37]
    LA_pc:
    s_add_u32 s36, s36, LA_end-LA_pc
    s_addc_u32 s37, s37, 0
    s_lshl_b32 s33, s24, 13
    v_lshl_add_u32 v1, v0, 7, s33
    v_min_u32 v1, L_exit-LA_end, v1
    global_load_dword v2, v1, s[36:37]
    s_waitcnt vmcnt(0)
LA_end:
    s_setprio 0
    s_mov_b32 s6, s10
    s_mov_b32 s7, s11
    s_mov_b32 s0, s56
    s_mov_b32 s1, s57
    s_and_b32 s64, s2, 0xf8
    v_lshlrev_b32 v5, 4, v0
    s_and_b32 s27, s2, 7
    s_lshl_b32 s27, s27, 2
    s_lshr_b32 s29, s2, 6
    s_add_u32 s27, s27, s29
    s_bfe_u32 s28, s2, 0x30003
    s_and_b32 s25, s24, 3
    s_lshr_b32 s26, s24, 2
    s_mul_i32 s34, s27, 147456
    s_lshl_b32 s29, s28, 3
    s_lshl_b32 s30, s25, 1
    s_add_u32 s29, s29, s30
    s_add_u32 s36, s29, s26
    s_xor_b32 s37, s36, 1
    s_lshl_b32 s38, s24, 10
    s_add_u32 s38, s38, 139264
    s_lshl_b32 s39, s26, 15
    s_lshl_b32 s29, s25, 10
    s_add_u32 s39, s39, s29
    s_mul_i32 s35, s26, 36864
    s_add_u32 s35, s35, s29
    s_add_u32 s35, s35, 65536
    v_mov_b32 v4, 64
    v_mov_b32 v3, 0
    s_cmp_lg_u32 s24, 0
    s_cbranch_scc1 LM_nocnt
    s_cmp_lt_u32 s64, 192
    s_cbranch_scc1 LM_nocnt
    global_load_dword v4, v3, s[56:57] sc1
    LM_nocnt:
    s_mov_b32 s32, 0
    s_mov_b32 s48, 0x3ffff
    s_mov_b32 s49, 0x3ffff
    s_mov_b32 s60, 0x20000
    v_and_b32 v6, 15, v0
    v_lshrrev_b32 v7, 4, v0
    v_lshlrev_b32 v8, 7, v0
    s_lshl_b32 s3, s28, 12
    s_add_u32 s3, s3, 54538240
    s_lshl_b32 s11, s28, 15
    s_add_u32 s11, s11, 54800384
    s_lshl_b32 s10, s27, 3
    s_add_u32 s10, s10, s24
    s_lshl_b32 s10, s10, 7
    s_add_u32 s10, s10, s11
    v_lshrrev_b32 v1, 2, v0
    v_lshlrev_b32 v1, 7, v1
    v_and_b32 v2, 3, v0
    v_lshl_add_u32 v1, v2, 3, v1
    s_lshl_b32 s59, s24, 11
    s_add_u32 s59, s59, 147456
    v_add_u32 v189, s59, v1
    v_mov_b32 v161, 0x3f803f80
    v_mov_b32 v163, 0x3f803f80
    v_mov_b32 v133, 0
    v_and_b32 v1, 27, v0
    v_cmp_eq_u32 vcc, 18, v1
    v_mov_b32 v2, 0x3f803f80
    s_nop 0
    v_cndmask_b32 v1, 0, v2, vcc
    v_mov_b32 v164, v1
    v_mov_b32 v165, v1
    v_mov_b32 v166, v1
    v_mov_b32 v167, v1
    v_mov_b32 v168, v1
    v_mov_b32 v169, v1
    v_mov_b32 v170, v1
    v_mov_b32 v171, v1
    v_mov_b32 v172, v1
    v_mov_b32 v173, v1
    v_mov_b32 v174, v1
    v_mov_b32 v175, v1
    v_mov_b32 v176, v1
    v_mov_b32 v177, v1
    v_mov_b32 v178, v1
    v_mov_b32 v179, v1
    s_lshl_b32 s29, s26, 15
    v_add_u32 v180, s29, v5
    s_lshl_b32 s29, s26, 12
    s_add_u32 s29, s29, 139264
    v_lshl_add_u32 v181, v0, 2, s29
    v_lshrrev_b32 v2, 5, v0
    v_lshlrev_b32 v1, 8, v2
    v_lshlrev_b32 v2, 5, v2
    v_add_u32 v2, 1024, v2
    v_and_b32 v182, 16, v0
    v_cmp_eq_u32 vcc, 0, v182
    v_mov_b32 v183, 512
    s_mul_i32 s29, s26, 36864
    v_cndmask_b32 v1, v2, v1, vcc
    v_cndmask_b32 v183, 64, v183, vcc
    v_lshl_add_u32 v1, v6, 4, v1
    s_add_u32 s29, s29, 65536
    v_add_u32 v182, s29, v1
    v_add_u32 v183, v183, v182
    s_and_b32 s50, s27, 7
    s_lshl_b32 s51, s50, 2
    s_lshr_b32 s29, s50, 1
    s_lshl_b32 s29, s29, 5
    s_add_u32 s29, s29, 896
    s_lshl_b32 s30, s50, 7
    s_sub_u32 s29, s29, s30
    s_bfe_u32 s52, s2, 0x50001
    s_lshl_b32 s52, s52, 2
    s_add_u32 s52, s52, s25
    v_mul_u32_u24 v1, 6554, v0
    v_lshrrev_b32 v1, 16, v1
    v_mul_u32_u24 v2, 10, v1
    v_sub_u32 v2, v0, v2
    v_mul_u32_u24 v1, 1152, v1
    v_lshl_add_u32 v186, v2, 4, v1
    v_lshrrev_b32 v2, 3, v2
    v_mad_u32_u24 v186, v2, s29, v186
    s_lshr_b32 s58, s27, 3
    s_lshl_b32 s58, s58, 11
    s_add_u32 s58, s58, 54734848
    s_lshl_b32 s55, s55, 7
    s_and_b32 s55, s55, 0x1800
    s_add_u32 s55, s55, 54734848
    s_waitcnt vmcnt(0)
    LM_cntchk:
    v_cmp_gt_u32 vcc, 64, v4
    s_cbranch_vccnz LM_cnt
    LM_cntok:
    s_barrier
    s_cmp_lg_u32 s24, 0
    s_cbranch_scc1 LM_a1
    s_cmp_ge_u32 s64, 192
    s_cbranch_scc1 LM_a1
    v_mov_b32 v1, 1
    s_mov_b64 exec, 0xffff
    buffer_atomic_add v1, v8, s[12:15], s55 offen sc1
    s_mov_b64 exec, -1
    LM_a1:
    s_lshl_b32 s29, s28, 1
    s_and_b32 s30, s27, 1
    s_add_u32 s29, s29, s30
    s_lshl_b32 s29, s29, 7
    s_add_u32 s33, s58, s29
    s_add_u32 s53, s64, s24
    s_and_b32 s29, s53, 127
    s_mul_i32 s29, s29, 9
    s_lshr_b32 s29, s29, 1
    s_mul_i32 s29, s29, 9216
    s_and_b32 s30, s2, 7
    s_mul_i32 s30, s30, 1152
    s_add_u32 s29, s29, s30
    v_lshrrev_b32 v193, 3, v0
    v_mul_u32_u24 v193, 8192, v193
    v_add3_u32 v193, v193, v8, s29
    s_mul_i32 s29, s53, 2592
    v_add_u32 v194, s29, v8
    s_mul_i32 s29, s24, 82944
    s_lshl_b32 s30, s51, 5
    s_add_u32 s29, s29, s30
    v_add_u32 v186, s29, v186
    s_mov_b32 s19, 0x20000
    s_lshl_b32 s56, s50, 3
    s_add_u32 s56, s56, s28
    s_lshl_b32 s56, s56, 3
    s_add_u32 s56, s56, s24
    s_lshr_b32 s31, s27, 3
    s_cmp_ge_u32 s56, 324
    s_cbranch_scc1 LM_pkg
    s_mov_b32 s16, s44
    s_mov_b32 s17, s45
    s_mov_b32 s18, 5308416
    s_mul_i32 s57, s56, 7282
    s_lshr_b32 s57, s57, 16
    s_mul_i32 s29, s57, 9
    s_sub_u32 s56, s56, s29
    s_bfe_u32 s29, s57, 0x10003
    s_mul_i32 s29, s29, 18
    s_bfe_u32 s30, s57, 0x20001
    s_lshl_b32 s30, s30, 2
    s_add_u32 s29, s29, s30
    s_bfe_u32 s30, s57, 0x10004
    s_lshl_b32 s30, s30, 1
    s_add_u32 s29, s29, s30
    s_bfe_u32 s30, s57, 0x10001
    s_mul_i32 s30, s30, 18
    s_add_u32 s30, s30, 16
    s_cmp_ge_u32 s57, 32
    s_cselect_b32 s29, s30, s29
    s_and_b32 s30, s57, 1
    s_add_u32 s54, s29, s30
    s_mul_i32 s29, s31, 36
    s_add_u32 s54, s54, s29
    s_mul_i32 s54, s54, 36864
    s_lshl_b32 s29, s56, 7
    s_add_u32 s54, s54, s29
    s_mul_i32 s55, s31, 1327104
    s_lshr_b32 s29, s57, 1
    s_mul_i32 s67, s29, 10240
    s_sub_u32 s67, 262144, s67
    s_mul_i32 s29, s29, 14336
    s_add_u32 s55, s55, s29
    s_lshl_b32 s29, s30, 10
    s_add_u32 s55, s55, s29
    s_add_u32 s55, s55, 46133248
    s_lshl_b32 s66, s31, 1
    s_lshl_b32 s56, s56, 2
    s_add_u32 s29, s56, 0
    s_sub_u32 s30, s29, s66
    s_and_b32 s30, s30, 7
    s_lshr_b32 s29, s29, 3
    s_cmp_eq_u32 s29, 4
    s_cselect_b32 s30, 8, s30
    s_cselect_b32 s29, 0, s29
    s_mul_i32 s58, s29, 331776
    s_add_u32 s58, s58, s55
    s_cmp_lt_u32 s30, 2
    s_cselect_b32 s29, s67, 0
    s_lshl_b32 s30, s30, 11
    s_add_u32 s29, s29, s30
    s_add_u32 s58, s58, s29
    s_add_u32 s29, s56, 1
    s_sub_u32 s30, s29, s66
    s_and_b32 s30, s30, 7
    s_lshr_b32 s29, s29, 3
    s_cmp_eq_u32 s29, 4
    s_cselect_b32 s30, 8, s30
    s_cselect_b32 s29, 1, s29
    s_mul_i32 s61, s29, 331776
    s_add_u32 s61, s61, s55
    s_cmp_lt_u32 s30, 2
    s_cselect_b32 s29, s67, 0
    s_lshl_b32 s30, s30, 11
    s_add_u32 s29, s29, s30
    s_add_u32 s61, s61, s29
    s_add_u32 s29, s56, 2
    s_sub_u32 s30, s29, s66
    s_and_b32 s30, s30, 7
    s_lshr_b32 s29, s29, 3
    s_cmp_eq_u32 s29, 4
    s_cselect_b32 s30, 8, s30
    s_cselect_b32 s29, 2, s29
    s_mul_i32 s62, s29, 331776
    s_add_u32 s62, s62, s55
    s_cmp_lt_u32 s30, 2
    s_cselect_b32 s29, s67, 0
    s_lshl_b32 s30, s30, 11
    s_add_u32 s29, s29, s30
    s_add_u32 s62, s62, s29
    s_add_u32 s29, s56, 3
    s_sub_u32 s30, s29, s66
    s_and_b32 s30, s30, 7
    s_lshr_b32 s29, s29, 3
    s_cmp_eq_u32 s29, 4
    s_cselect_b32 s30, 8, s30
    s_cselect_b32 s29, 3, s29
    s_mul_i32 s63, s29, 331776
    s_add_u32 s63, s63, s55
    s_cmp_lt_u32 s30, 2
    s_cselect_b32 s29, s67, 0
    s_lshl_b32 s30, s30, 11
    s_add_u32 s29, s29, s30
    s_add_u32 s63, s63, s29
    s_cmp_ge_u32 s57, 32
    s_cselect_b32 s56, 4, 0
    s_mov_b32 s55, 18432
    s_mov_b32 s31, 1152
    LM_pkd:
    s_lshl_b32 s29, s31, 3
    s_lshl_b32 s30, s31, 2
    s_cmp_lg_u32 s56, 0
    s_cselect_b32 s57, s55, s29
    s_cselect_b32 s55, s30, s55
    s_add_u32 s55, s55, s54
    v_lshrrev_b32 v188, 3, v0
    v_and_b32 v187, s56, v188
    v_add_u32 v188, v188, v187
    v_mul_u32_u24 v188, s31, v188
    v_and_b32 v187, 7, v0
    v_lshl_add_u32 v188, v187, 4, v188
    v_mov_b32 v192, 64
    s_cmp_lg_u32 s24, 0
    s_cbranch_scc1 LM_a2
    s_mov_b64 exec, 1
    v_mov_b32 v192, 0
    buffer_atomic_or v192, v8, s[12:15], s33 offen sc0 sc1
    s_mov_b64 exec, -1
    LM_a2:
    v_mul_u32_u24 v198, 1152, v6
    v_lshl_add_u32 v198, v7, 3, v198
    s_mul_i32 s29, s52, 18432
    s_lshl_b32 s31, s51, 5
    s_add_u32 s31, s31, s29
    s_lshl_b32 s30, s26, 6
    s_add_u32 s31, s31, s30
    v_add_u32 v197, s31, v198
    s_lshr_b32 s31, s50, 1
    s_lshl_b32 s31, s31, 5
    s_add_u32 s31, s31, s29
    v_add_u32 v198, s31, v198
    s_lshl_b32 s29, s52, 6
    s_add_u32 s29, s29, 54525952
    v_lshl_add_u32 v199, v6, 2, s29
    v_mov_b32 v190, 0
    v_mov_b32 v191, 5
    s_lshl_b32 s66, s26, 15
    s_mul_i32 s67, s26, 36864
    s_add_u32 s67, s67, 45056
    s_cmp_ge_u32 s25, 2
    s_cselect_b32 s66, s67, s66
    s_mul_i32 s29, s25, 10240
    s_add_u32 s66, s66, s29
    s_mul_i32 s67, s24, 1280
    s_add_u32 s67, s67, 147456
    s_cmp_lg_u32 s24, 0
    s_cbranch_scc1 LM_a0
    s_waitcnt vmcnt(0)
    v_cmp_gt_u32 vcc, 48, v192
    s_cbranch_vccz LM_a0
    s_mov_b64 exec, 1
    LM_ap0:
    v_mov_b32 v1, 0
    s_sub_u32 s60, s60, 1
    buffer_atomic_or v1, v8, s[12:15], s33 offen sc0 sc1
    s_cmp_lt_i32 s60, 1
    s_waitcnt vmcnt(0)
    v_cmp_gt_u32 vcc, 48, v1
    s_cbranch_scc1 LM_aq0
    s_cbranch_vccnz LM_ap0
    LM_aq0:
    s_mov_b64 exec, -1
    LM_a0:
    s_barrier
    v_and_b32 v1, 31, v0
    v_lshlrev_b32 v1, 2, v1
    s_lshl_b32 s29, s36, 10
    s_add_u32 s29, s29, s34
    s_lshl_b32 s30, s37, 10
    s_add_u32 s30, s30, s34
    buffer_load_dwordx4 v[124:127], v5, s[12:15], s29 offen sc1
    buffer_load_dwordx4 v[128:131], v5, s[12:15], s30 offen sc1
    s_lshl_b32 s29, s36, 7
    s_add_u32 s29, s29, s34
    s_add_u32 s29, s29, 139264
    s_and_b32 s29, s29, 0xffffff7f
    s_lshl_b32 s30, s26, 7
    v_lshlrev_b32 v2, 2, v0
    v_xor_b32 v2, s30, v2
    buffer_load_dword v132, v2, s[12:15], s29 offen sc1
    s_add_u32 s34, s34, 4718592
    buffer_load_dwordx4 v[136:139], v5, s[12:15], s34 offen sc1
    s_add_u32 s29, s34, 139264
    buffer_load_dword v160, v1, s[12:15], s29 offen sc1
    s_add_u32 m0, s39, 0
    s_add_u32 s29, m0, s34
    buffer_load_dwordx4 v5, s[12:15], s29 offen sc1 lds
    s_add_u32 m0, s38, 0
    s_add_u32 s29, m0, s34
    buffer_load_dwordx4 v5, s[12:15], s29 offen sc1 lds
    s_add_u32 m0, s35, 0
    s_add_u32 s29, m0, s34
    buffer_load_dwordx4 v5, s[12:15], s29 offen sc1 lds
    s_cmp_ge_u32 s25, 2
    s_cselect_b32 s29, 59392, 0
    s_cselect_b32 s30, 4096, 0
    s_add_u32 s30, s30, 32768
    s_mul_i32 s31, s25, 3072
    s_add_u32 s29, s29, s31
    s_add_u32 s29, s29, 20480
    s_mul_i32 s31, s30, s26
    s_sub_u32 s30, s30, s31
    s_add_u32 s31, s31, s29
    s_add_u32 s30, s30, s29
    v_add_u32 v200, s31, v5
    v_add_u32 v201, s30, v5
    s_lshl_b32 s29, s24, 2
    s_add_u32 s29, s29, 163584
    v_mov_b32 v195, s29
    v_and_b32 v196, 7, v0
    v_lshlrev_b32 v196, 2, v196
    v_add_u32 v196, 163584, v196
    v_bfe_u32 v203, v0, 4, 1
    v_lshlrev_b32 v202, 14, v203
    v_lshl_add_u32 v202, v6, 4, v202
    v_lshrrev_b32 v1, 5, v0
    v_lshl_add_u32 v202, v1, 8, v202
    v_lshlrev_b32 v203, 11, v203
    v_lshl_add_u32 v203, v6, 2, v203
    s_lshl_b32 s31, s36, 15
    s_lshl_b32 s29, s27, 9
    s_add_u32 s31, s31, s29
    s_add_u32 s31, s31, 9437184
    v_add_u32 v202, s31, v202
    s_lshl_b32 s30, s36, 12
    s_lshl_b32 s29, s27, 6
    s_add_u32 s30, s30, s29
    s_add_u32 s30, s30, 11534336
    v_add_u32 v203, s30, v203
    s_lshl_b32 s69, s50, 1
    s_add_u32 s69, s69, s26
    s_mul_i32 s29, s52, 18
    s_add_u32 s9, s29, s69
    s_lshl_b32 s9, s9, 10
    s_add_u32 s9, s9, 11796480
    s_lshl_b32 s65, s29, 10
    s_lshl_b32 s30, s50, 8
    s_add_u32 s65, s65, s30
    s_add_u32 s65, s65, 11812864
    s_lshl_b32 s68, s52, 4
    s_add_u32 s68, s68, s69
    s_lshl_b32 s68, s68, 6
    s_add_u32 s68, s68, 16515072
    s_and_b32 s69, s69, 3
    v_lshlrev_b32 v11, 3, v0
    s_lshl_b32 s4, s52, 1
    s_add_u32 s4, s4, s26
    s_lshl_b32 s5, s4, 10
    s_add_u32 s5, s5, 11534336
    s_lshl_b32 s4, s4, 13
    s_add_u32 s4, s4, 9437184
    v_lshrrev_b32 v1, 5, v0
    v_lshlrev_b32 v1, 9, v1
    v_lshl_add_u32 v1, v6, 2, v1
    v_bfe_u32 v2, v0, 4, 1
    v_lshl_add_u32 v247, v2, 7, v1
    s_waitcnt vmcnt(3)
    v_mfma_f32_32x32x16_bf16 v[12:27], v[136:139], v[124:127], 0
    v_mfma_f32_32x32x16_bf16 v[28:43], v[136:139], v[128:131], 0
    s_nop 9
    v_mfma_f32_32x32x4_2b_bf16 v[12:43], v[160:161], v[132:133], v[12:43] cbsz:1 abid:0
    s_nop 15
    s_nop 3
    v_max3_f32 v3, v12, v13, v14
    v_max3_f32 v3, v15, v16, v3
    v_max3_f32 v3, v17, v18, v3
    v_max3_f32 v3, v19, v20, v3
    v_max3_f32 v3, v21, v22, v3
    v_max3_f32 v3, v23, v24, v3
    v_max3_f32 v3, v25, v26, v3
    v_max_f32 v3, v27, v3
    v_max3_f32 v4, v28, v29, v30
    v_max3_f32 v4, v31, v32, v4
    v_max3_f32 v4, v33, v34, v4
    v_max3_f32 v4, v35, v36, v4
    v_max3_f32 v4, v37, v38, v4
    v_max3_f32 v4, v39, v40, v4
    v_max3_f32 v4, v41, v42, v4
    v_max_f32 v4, v43, v4
    s_waitcnt vmcnt(0)
    s_barrier
    v_permlane32_swap_b32 v3, v4
    ds_read_b32 v160, v181
    ds_read_b128 v[136:139], v180 offset:0
    ds_read_b128 v[140:143], v180 offset:1024
    ds_read_b32 v162, v181 offset:256
    s_mov_b64 exec, s[48:49]
    ds_read_b128 v[164:167], v182 offset:0
    ds_read_b128 v[168:171], v183 offset:0
    s_mov_b64 exec, -1
    v_max_f32 v1, v3, v4
    v_cvt_pk_bf16_f32 v2, -v1, -v1
    v_mul_f32 v192, 0x69800000, v1
    v_lshlrev_b32 v2, 16, v2
    v_add_f32 v1, v1, v2
    v_cvt_pk_bf16_f32 v133, v2, -v1
    s_nop 0
    s_waitcnt lgkmcnt(0)
    v_mfma_f32_32x32x4_2b_bf16 v[12:43], v[160:161], v[132:133], 0 cbsz:1 abid:0
    s_nop 15
    s_nop 1
    v_mfma_f32_32x32x16_bf16 v[12:27], v[136:139], v[124:127], v[12:27]
    v_mfma_f32_32x32x16_bf16 v[28:43], v[136:139], v[128:131], v[28:43]
    s_nop 10
    v_exp_f32 v12, v12
    v_exp_f32 v13, v13
    v_mfma_f32_32x32x4_2b_bf16 v[44:75], v[160:161], v[132:133], 0 cbsz:1 abid:1
    s_setprio 3
    v_exp_f32 v14, v14
    v_exp_f32 v15, v15
    v_cvt_pk_bf16_f32 v108, v12, v13
    v_exp_f32 v16, v16
    v_exp_f32 v17, v17
    v_cvt_pk_bf16_f32 v109, v14, v15
    v_exp_f32 v18, v18
    s_add_u32 m0, s35, 4096
    s_add_u32 s29, m0, s34
    buffer_load_dwordx4 v5, s[12:15], s29 offen sc1 lds
    v_exp_f32 v19, v19
    v_cvt_pk_bf16_f32 v110, v16, v17
    v_exp_f32 v20, v20
    v_exp_f32 v21, v21
    v_cvt_pk_bf16_f32 v111, v18, v19
    v_exp_f32 v22, v22
    s_add_u32 m0, s39, 4096
    s_add_u32 s29, m0, s34
    buffer_load_dwordx4 v5, s[12:15], s29 offen sc1 lds
    v_exp_f32 v23, v23
    v_cvt_pk_bf16_f32 v112, v20, v21
    v_exp_f32 v24, v24
    v_exp_f32 v25, v25
    v_cvt_pk_bf16_f32 v113, v22, v23
    v_exp_f32 v26, v26
    v_exp_f32 v27, v27
    v_cvt_pk_bf16_f32 v114, v24, v25
    v_cvt_pk_bf16_f32 v115, v26, v27
    s_waitcnt lgkmcnt(0)
    v_exp_f32 v28, v28
    v_exp_f32 v29, v29
    v_mfma_f32_32x32x16_bf16 v[44:59], v[140:143], v[124:127], v[44:59]
    ds_read_b128 v[136:139], v180 offset:2048
    s_mov_b64 exec, s[48:49]
    ds_read_b128 v[172:175], v182 offset:1152
    ds_read_b128 v[176:179], v183 offset:1152
    s_mov_b64 exec, -1
    v_exp_f32 v30, v30
    v_exp_f32 v31, v31
    v_cvt_pk_bf16_f32 v116, v28, v29
    v_exp_f32 v32, v32
    v_exp_f32 v33, v33
    v_mfma_f32_32x32x16_bf16 v[60:75], v[140:143], v[128:131], v[60:75]
    v_cvt_pk_bf16_f32 v117, v30, v31
    v_exp_f32 v34, v34
    s_add_u32 m0, s35, 8192
    s_add_u32 s29, m0, s34
    buffer_load_dwordx4 v5, s[12:15], s29 offen sc1 lds
    v_exp_f32 v35, v35
    v_cvt_pk_bf16_f32 v118, v32, v33
    v_exp_f32 v36, v36
    v_exp_f32 v37, v37
    v_mfma_f32_32x32x16_bf16 v[76:91], v[164:167], v[108:111], 0
    v_cvt_pk_bf16_f32 v119, v34, v35
    v_exp_f32 v38, v38
    s_add_u32 m0, s39, 8192
    s_add_u32 s29, m0, s34
    buffer_load_dwordx4 v5, s[12:15], s29 offen sc1 lds
    v_exp_f32 v39, v39
    v_cvt_pk_bf16_f32 v120, v36, v37
    v_exp_f32 v40, v40
    v_exp_f32 v41, v41
    v_mfma_f32_32x32x16_bf16 v[76:91], v[168:171], v[112:115], v[76:91]
    v_cvt_pk_bf16_f32 v121, v38, v39
    v_exp_f32 v42, v42
    v_exp_f32 v43, v43
    v_cvt_pk_bf16_f32 v122, v40, v41
    v_cvt_pk_bf16_f32 v123, v42, v43
    v_exp_f32 v44, v44
    v_exp_f32 v45, v45
    v_mfma_f32_32x32x4_2b_bf16 v[12:43], v[162:163], v[132:133], 0 cbsz:1 abid:0
    v_exp_f32 v46, v46
    v_exp_f32 v47, v47
    v_cvt_pk_bf16_f32 v108, v44, v45
    v_exp_f32 v48, v48
    v_exp_f32 v49, v49
    v_cvt_pk_bf16_f32 v109, v46, v47
    v_exp_f32 v50, v50
    v_exp_f32 v51, v51
    v_cvt_pk_bf16_f32 v110, v48, v49
    v_exp_f32 v52, v52
    v_exp_f32 v53, v53
    v_mfma_f32_32x32x16_bf16 v[92:107], v[164:167], v[116:119], 0
    v_cvt_pk_bf16_f32 v111, v50, v51
    v_exp_f32 v54, v54
    v_exp_f32 v55, v55
    v_cvt_pk_bf16_f32 v112, v52, v53
    v_exp_f32 v56, v56
    v_exp_f32 v57, v57
    v_mfma_f32_32x32x16_bf16 v[92:107], v[168:171], v[120:123], v[92:107]
    v_cvt_pk_bf16_f32 v113, v54, v55
    v_exp_f32 v58, v58
    v_exp_f32 v59, v59
    v_cvt_pk_bf16_f32 v114, v56, v57
    v_cvt_pk_bf16_f32 v115, v58, v59
    s_waitcnt lgkmcnt(0)
    v_exp_f32 v60, v60
    v_exp_f32 v61, v61
    v_mfma_f32_32x32x16_bf16 v[12:27], v[136:139], v[124:127], v[12:27]
    s_setprio 2
    ds_read_b128 v[140:143], v180 offset:3072
    ds_read_b32 v160, v181 offset:512
    s_mov_b64 exec, s[48:49]
    ds_read_b128 v[164:167], v182 offset:2304
    ds_read_b128 v[168:171], v183 offset:2304
    s_mov_b64 exec, -1
    v_exp_f32 v62, v62
    v_exp_f32 v63, v63
    v_cvt_pk_bf16_f32 v116, v60, v61
    v_exp_f32 v64, v64
    v_exp_f32 v65, v65
    v_mfma_f32_32x32x16_bf16 v[28:43], v[136:139], v[128:131], v[28:43]
    v_cvt_pk_bf16_f32 v117, v62, v63
    v_exp_f32 v66, v66
    v_exp_f32 v67, v67
    v_cvt_pk_bf16_f32 v118, v64, v65
    v_exp_f32 v68, v68
    v_exp_f32 v69, v69
    v_mfma_f32_32x32x16_bf16 v[76:91], v[172:175], v[108:111], v[76:91]
    v_cvt_pk_bf16_f32 v119, v66, v67
    v_exp_f32 v70, v70
    v_exp_f32 v71, v71
    v_cvt_pk_bf16_f32 v120, v68, v69
    v_exp_f32 v72, v72
    v_exp_f32 v73, v73
    v_mfma_f32_32x32x16_bf16 v[76:91], v[176:179], v[112:115], v[76:91]
    v_cvt_pk_bf16_f32 v121, v70, v71
    v_exp_f32 v74, v74
    v_exp_f32 v75, v75
    v_cvt_pk_bf16_f32 v122, v72, v73
    v_cvt_pk_bf16_f32 v123, v74, v75
    v_exp_f32 v12, v12
    v_exp_f32 v13, v13
    v_mfma_f32_32x32x4_2b_bf16 v[44:75], v[162:163], v[132:133], 0 cbsz:1 abid:1
    s_setprio 0
    v_exp_f32 v14, v14
    v_exp_f32 v15, v15
    v_cvt_pk_bf16_f32 v108, v12, v13
    v_exp_f32 v16, v16
    v_exp_f32 v17, v17
    v_cvt_pk_bf16_f32 v109, v14, v15
    v_exp_f32 v18, v18
    v_exp_f32 v19, v19
    v_cvt_pk_bf16_f32 v110, v16, v17
    v_exp_f32 v20, v20
    v_exp_f32 v21, v21
    v_mfma_f32_32x32x16_bf16 v[92:107], v[172:175], v[116:119], v[92:107]
    v_cvt_pk_bf16_f32 v111, v18, v19
    v_exp_f32 v22, v22
    v_exp_f32 v23, v23
    v_cvt_pk_bf16_f32 v112, v20, v21
    v_exp_f32 v24, v24
    v_exp_f32 v25, v25
    v_mfma_f32_32x32x16_bf16 v[92:107], v[176:179], v[120:123], v[92:107]
    v_cvt_pk_bf16_f32 v113, v22, v23
    v_exp_f32 v26, v26
    v_exp_f32 v27, v27
    v_cvt_pk_bf16_f32 v114, v24, v25
    v_cvt_pk_bf16_f32 v115, v26, v27
    s_waitcnt vmcnt(0)
    s_barrier
    s_waitcnt lgkmcnt(0)
    v_exp_f32 v28, v28
    v_exp_f32 v29, v29
    v_mfma_f32_32x32x16_bf16 v[44:59], v[140:143], v[124:127], v[44:59]
    s_setprio 3
    ds_read_b128 v[136:139], v180 offset:4096
    s_mov_b64 exec, s[48:49]
    ds_read_b128 v[172:175], v182 offset:3456
    ds_read_b128 v[176:179], v183 offset:3456
    s_mov_b64 exec, -1
    v_exp_f32 v30, v30
    v_exp_f32 v31, v31
    v_cvt_pk_bf16_f32 v116, v28, v29
    v_exp_f32 v32, v32
    v_exp_f32 v33, v33
    v_mfma_f32_32x32x16_bf16 v[60:75], v[140:143], v[128:131], v[60:75]
    v_cvt_pk_bf16_f32 v117, v30, v31
    v_exp_f32 v34, v34
    v_exp_f32 v35, v35
    v_cvt_pk_bf16_f32 v118, v32, v33
    v_exp_f32 v36, v36
    v_exp_f32 v37, v37
    v_mfma_f32_32x32x16_bf16 v[76:91], v[164:167], v[108:111], v[76:91]
    v_cvt_pk_bf16_f32 v119, v34, v35
    v_exp_f32 v38, v38
    v_exp_f32 v39, v39
    v_cvt_pk_bf16_f32 v120, v36, v37
    v_exp_f32 v40, v40
    v_exp_f32 v41, v41
    v_mfma_f32_32x32x16_bf16 v[76:91], v[168:171], v[112:115], v[76:91]
    v_cvt_pk_bf16_f32 v121, v38, v39
    v_exp_f32 v42, v42
    v_exp_f32 v43, v43
    v_cvt_pk_bf16_f32 v122, v40, v41
    v_cvt_pk_bf16_f32 v123, v42, v43
    v_exp_f32 v44, v44
    v_exp_f32 v45, v45
    v_mfma_f32_32x32x4_2b_bf16 v[12:43], v[160:161], v[132:133], 0 cbsz:1 abid:0
    v_exp_f32 v46, v46
    v_exp_f32 v47, v47
    v_cvt_pk_bf16_f32 v108, v44, v45
    v_exp_f32 v48, v48
    v_exp_f32 v49, v49
    v_cvt_pk_bf16_f32 v109, v46, v47
    v_exp_f32 v50, v50
    s_add_u32 m0, s35, 12288
    s_add_u32 s29, m0, s34
    buffer_load_dwordx4 v5, s[12:15], s29 offen sc1 lds
    v_exp_f32 v51, v51
    v_cvt_pk_bf16_f32 v110, v48, v49
    v_exp_f32 v52, v52
    v_exp_f32 v53, v53
    v_mfma_f32_32x32x16_bf16 v[92:107], v[164:167], v[116:119], v[92:107]
    v_cvt_pk_bf16_f32 v111, v50, v51
    v_exp_f32 v54, v54
    s_add_u32 m0, s39, 12288
    s_add_u32 s29, m0, s34
    buffer_load_dwordx4 v5, s[12:15], s29 offen sc1 lds
    v_exp_f32 v55, v55
    v_cvt_pk_bf16_f32 v112, v52, v53
    v_exp_f32 v56, v56
    v_exp_f32 v57, v57
    v_mfma_f32_32x32x16_bf16 v[92:107], v[168:171], v[120:123], v[92:107]
    v_cvt_pk_bf16_f32 v113, v54, v55
    v_exp_f32 v58, v58
    v_exp_f32 v59, v59
    v_cvt_pk_bf16_f32 v114, v56, v57
    v_cvt_pk_bf16_f32 v115, v58, v59
    s_waitcnt lgkmcnt(0)
    v_exp_f32 v60, v60
    v_exp_f32 v61, v61
    v_mfma_f32_32x32x16_bf16 v[12:27], v[136:139], v[124:127], v[12:27]
    ds_read_b128 v[140:143], v180 offset:5120
    ds_read_b32 v162, v181 offset:768
    s_mov_b64 exec, s[48:49]
    ds_read_b128 v[164:167], v182 offset:4608
    ds_read_b128 v[168:171], v183 offset:4608
    s_mov_b64 exec, -1
    v_exp_f32 v62, v62
    v_exp_f32 v63, v63
    v_cvt_pk_bf16_f32 v116, v60, v61
    v_exp_f32 v64, v64
    v_exp_f32 v65, v65
    v_mfma_f32_32x32x16_bf16 v[28:43], v[136:139], v[128:131], v[28:43]
    v_cvt_pk_bf16_f32 v117, v62, v63
    v_exp_f32 v66, v66
    s_add_u32 m0, s35, 16384
    s_add_u32 s29, m0, s34
    buffer_load_dwordx4 v5, s[12:15], s29 offen sc1 lds
    v_exp_f32 v67, v67
    v_cvt_pk_bf16_f32 v118, v64, v65
    v_exp_f32 v68, v68
    v_exp_f32 v69, v69
    v_mfma_f32_32x32x16_bf16 v[76:91], v[172:175], v[108:111], v[76:91]
    v_cvt_pk_bf16_f32 v119, v66, v67
    v_exp_f32 v70, v70
    s_add_u32 m0, s39, 16384
    s_add_u32 s29, m0, s34
    buffer_load_dwordx4 v5, s[12:15], s29 offen sc1 lds
    v_exp_f32 v71, v71
    v_cvt_pk_bf16_f32 v120, v68, v69
    v_exp_f32 v72, v72
    v_exp_f32 v73, v73
    v_mfma_f32_32x32x16_bf16 v[76:91], v[176:179], v[112:115], v[76:91]
    v_cvt_pk_bf16_f32 v121, v70, v71
    v_exp_f32 v74, v74
    v_exp_f32 v75, v75
    v_cvt_pk_bf16_f32 v122, v72, v73
    v_cvt_pk_bf16_f32 v123, v74, v75
    v_exp_f32 v12, v12
    v_exp_f32 v13, v13
    v_mfma_f32_32x32x4_2b_bf16 v[44:75], v[160:161], v[132:133], 0 cbsz:1 abid:1
    v_exp_f32 v14, v14
    v_exp_f32 v15, v15
    v_cvt_pk_bf16_f32 v108, v12, v13
    v_exp_f32 v16, v16
    v_exp_f32 v17, v17
    v_cvt_pk_bf16_f32 v109, v14, v15
    v_exp_f32 v18, v18
    s_add_u32 m0, s35, 20480
    s_add_u32 s29, m0, s34
    buffer_load_dwordx4 v5, s[12:15], s29 offen sc1 lds
    v_exp_f32 v19, v19
    v_cvt_pk_bf16_f32 v110, v16, v17
    v_exp_f32 v20, v20
    v_exp_f32 v21, v21
    v_mfma_f32_32x32x16_bf16 v[92:107], v[172:175], v[116:119], v[92:107]
    v_cvt_pk_bf16_f32 v111, v18, v19
    v_exp_f32 v22, v22
    s_add_u32 m0, s39, 20480
    s_add_u32 s29, m0, s34
    buffer_load_dwordx4 v5, s[12:15], s29 offen sc1 lds
    v_exp_f32 v23, v23
    v_cvt_pk_bf16_f32 v112, v20, v21
    v_exp_f32 v24, v24
    v_exp_f32 v25, v25
    v_mfma_f32_32x32x16_bf16 v[92:107], v[176:179], v[120:123], v[92:107]
    v_cvt_pk_bf16_f32 v113, v22, v23
    v_exp_f32 v26, v26
    v_exp_f32 v27, v27
    v_cvt_pk_bf16_f32 v114, v24, v25
    v_cvt_pk_bf16_f32 v115, v26, v27
    s_waitcnt lgkmcnt(0)
    v_exp_f32 v28, v28
    v_exp_f32 v29, v29
    v_mfma_f32_32x32x16_bf16 v[44:59], v[140:143], v[124:127], v[44:59]
    ds_read_b128 v[136:139], v180 offset:6144
    s_mov_b64 exec, s[48:49]
    ds_read_b128 v[172:175], v182 offset:5760
    ds_read_b128 v[176:179], v183 offset:5760
    s_mov_b64 exec, -1
    v_exp_f32 v30, v30
    v_exp_f32 v31, v31
    v_cvt_pk_bf16_f32 v116, v28, v29
    v_exp_f32 v32, v32
    v_exp_f32 v33, v33
    v_mfma_f32_32x32x16_bf16 v[60:75], v[140:143], v[128:131], v[60:75]
    v_cvt_pk_bf16_f32 v117, v30, v31
    v_exp_f32 v34, v34
    s_add_u32 m0, s59, 0
    s_mov_b32 s29, s54
    buffer_load_dwordx4 v188, s[16:19], s29 offen lds
    v_exp_f32 v35, v35
    v_cvt_pk_bf16_f32 v118, v32, v33
    v_exp_f32 v36, v36
    v_exp_f32 v37, v37
    v_mfma_f32_32x32x16_bf16 v[76:91], v[164:167], v[108:111], v[76:91]
    v_cvt_pk_bf16_f32 v119, v34, v35
    v_exp_f32 v38, v38
    s_add_u32 m0, s59, 1024
    s_add_u32 s29, s54, s57
    buffer_load_dwordx4 v188, s[16:19], s29 offen lds
    v_exp_f32 v39, v39
    v_cvt_pk_bf16_f32 v120, v36, v37
    v_exp_f32 v40, v40
    v_exp_f32 v41, v41
    v_mfma_f32_32x32x16_bf16 v[76:91], v[168:171], v[112:115], v[76:91]
    v_cvt_pk_bf16_f32 v121, v38, v39
    v_exp_f32 v42, v42
    v_exp_f32 v43, v43
    v_cvt_pk_bf16_f32 v122, v40, v41
    v_cvt_pk_bf16_f32 v123, v42, v43
    v_exp_f32 v44, v44
    v_exp_f32 v45, v45
    v_mfma_f32_32x32x4_2b_bf16 v[12:43], v[162:163], v[132:133], 0 cbsz:1 abid:0
    v_exp_f32 v46, v46
    v_exp_f32 v47, v47
    v_cvt_pk_bf16_f32 v108, v44, v45
    v_exp_f32 v48, v48
    v_exp_f32 v49, v49
    v_cvt_pk_bf16_f32 v109, v46, v47
    v_exp_f32 v50, v50
    v_exp_f32 v51, v51
    v_cvt_pk_bf16_f32 v110, v48, v49
    v_exp_f32 v52, v52
    v_exp_f32 v53, v53
    v_mfma_f32_32x32x16_bf16 v[92:107], v[164:167], v[116:119], v[92:107]
    v_cvt_pk_bf16_f32 v111, v50, v51
    v_exp_f32 v54, v54
    v_exp_f32 v55, v55
    v_cvt_pk_bf16_f32 v112, v52, v53
    v_exp_f32 v56, v56
    v_exp_f32 v57, v57
    v_mfma_f32_32x32x16_bf16 v[92:107], v[168:171], v[120:123], v[92:107]
    v_cvt_pk_bf16_f32 v113, v54, v55
    v_exp_f32 v58, v58
    v_exp_f32 v59, v59
    v_cvt_pk_bf16_f32 v114, v56, v57
    v_cvt_pk_bf16_f32 v115, v58, v59
    s_waitcnt lgkmcnt(0)
    v_exp_f32 v60, v60
    v_exp_f32 v61, v61
    v_mfma_f32_32x32x16_bf16 v[12:27], v[136:139], v[124:127], v[12:27]
    ds_read_b128 v[140:143], v180 offset:7168
    ds_read_b32 v160, v181 offset:1024
    s_mov_b64 exec, s[48:49]
    ds_read_b128 v[164:167], v182 offset:6912
    ds_read_b128 v[168:171], v183 offset:6912
    s_mov_b64 exec, -1
    v_exp_f32 v62, v62
    v_exp_f32 v63, v63
    v_cvt_pk_bf16_f32 v116, v60, v61
    v_exp_f32 v64, v64
    v_exp_f32 v65, v65
    v_mfma_f32_32x32x16_bf16 v[28:43], v[136:139], v[128:131], v[28:43]
    v_cvt_pk_bf16_f32 v117, v62, v63
    v_exp_f32 v66, v66
    v_exp_f32 v67, v67
    v_cvt_pk_bf16_f32 v118, v64, v65
    v_exp_f32 v68, v68
    v_exp_f32 v69, v69
    v_mfma_f32_32x32x16_bf16 v[76:91], v[172:175], v[108:111], v[76:91]
    v_cvt_pk_bf16_f32 v119, v66, v67
    v_exp_f32 v70, v70
    v_exp_f32 v71, v71
    v_cvt_pk_bf16_f32 v120, v68, v69
    v_exp_f32 v72, v72
    v_exp_f32 v73, v73
    v_mfma_f32_32x32x16_bf16 v[76:91], v[176:179], v[112:115], v[76:91]
    v_cvt_pk_bf16_f32 v121, v70, v71
    v_exp_f32 v74, v74
    v_exp_f32 v75, v75
    v_cvt_pk_bf16_f32 v122, v72, v73
    v_cvt_pk_bf16_f32 v123, v74, v75
    v_exp_f32 v12, v12
    v_exp_f32 v13, v13
    v_mfma_f32_32x32x4_2b_bf16 v[44:75], v[162:163], v[132:133], 0 cbsz:1 abid:1
    s_setprio 2
    v_exp_f32 v14, v14
    v_exp_f32 v15, v15
    v_cvt_pk_bf16_f32 v108, v12, v13
    v_exp_f32 v16, v16
    v_exp_f32 v17, v17
    v_cvt_pk_bf16_f32 v109, v14, v15
    v_exp_f32 v18, v18
    v_exp_f32 v19, v19
    v_cvt_pk_bf16_f32 v110, v16, v17
    v_exp_f32 v20, v20
    v_exp_f32 v21, v21
    v_mfma_f32_32x32x16_bf16 v[92:107], v[172:175], v[116:119], v[92:107]
    v_cvt_pk_bf16_f32 v111, v18, v19
    v_exp_f32 v22, v22
    v_exp_f32 v23, v23
    v_cvt_pk_bf16_f32 v112, v20, v21
    v_exp_f32 v24, v24
    v_exp_f32 v25, v25
    v_mfma_f32_32x32x16_bf16 v[92:107], v[176:179], v[120:123], v[92:107]
    v_cvt_pk_bf16_f32 v113, v22, v23
    v_exp_f32 v26, v26
    v_exp_f32 v27, v27
    v_cvt_pk_bf16_f32 v114, v24, v25
    v_cvt_pk_bf16_f32 v115, v26, v27
    s_waitcnt lgkmcnt(0)
    v_exp_f32 v28, v28
    v_exp_f32 v29, v29
    v_mfma_f32_32x32x16_bf16 v[44:59], v[140:143], v[124:127], v[44:59]
    ds_read_b128 v[136:139], v180 offset:8192
    s_mov_b64 exec, s[48:49]
    ds_read_b128 v[172:175], v182 offset:8064
    ds_read_b128 v[176:179], v183 offset:8064
    s_mov_b64 exec, -1
    v_exp_f32 v30, v30
    v_exp_f32 v31, v31
    v_cvt_pk_bf16_f32 v116, v28, v29
    v_exp_f32 v32, v32
    v_exp_f32 v33, v33
    v_mfma_f32_32x32x16_bf16 v[60:75], v[140:143], v[128:131], v[60:75]
    v_cvt_pk_bf16_f32 v117, v30, v31
    v_exp_f32 v34, v34
    v_exp_f32 v35, v35
    v_cvt_pk_bf16_f32 v118, v32, v33
    v_exp_f32 v36, v36
    v_exp_f32 v37, v37
    v_mfma_f32_32x32x16_bf16 v[76:91], v[164:167], v[108:111], v[76:91]
    v_cvt_pk_bf16_f32 v119, v34, v35
    v_exp_f32 v38, v38
    v_exp_f32 v39, v39
    v_cvt_pk_bf16_f32 v120, v36, v37
    v_exp_f32 v40, v40
    v_exp_f32 v41, v41
    v_mfma_f32_32x32x16_bf16 v[76:91], v[168:171], v[112:115], v[76:91]
    v_cvt_pk_bf16_f32 v121, v38, v39
    v_exp_f32 v42, v42
    v_exp_f32 v43, v43
    v_cvt_pk_bf16_f32 v122, v40, v41
    v_cvt_pk_bf16_f32 v123, v42, v43
    v_exp_f32 v44, v44
    v_exp_f32 v45, v45
    v_mfma_f32_32x32x4_2b_bf16 v[12:43], v[160:161], v[132:133], 0 cbsz:1 abid:0
    v_exp_f32 v46, v46
    v_exp_f32 v47, v47
    v_cvt_pk_bf16_f32 v108, v44, v45
    v_exp_f32 v48, v48
    v_exp_f32 v49, v49
    v_cvt_pk_bf16_f32 v109, v46, v47
    v_exp_f32 v50, v50
    s_waitcnt vmcnt(0)
    ds_read_b64_tr_b16 v[144:145], v189 offset:0
    ds_read_b64_tr_b16 v[148:149], v189 offset:32
    ds_read_b64_tr_b16 v[152:153], v189 offset:64
    ds_read_b64_tr_b16 v[156:157], v189 offset:96
    v_exp_f32 v51, v51
    v_cvt_pk_bf16_f32 v110, v48, v49
    v_exp_f32 v52, v52
    v_exp_f32 v53, v53
    v_mfma_f32_32x32x16_bf16 v[92:107], v[164:167], v[116:119], v[92:107]
    v_cvt_pk_bf16_f32 v111, v50, v51
    v_exp_f32 v54, v54
    v_exp_f32 v55, v55
    v_cvt_pk_bf16_f32 v112, v52, v53
    v_exp_f32 v56, v56
    v_exp_f32 v57, v57
    v_mfma_f32_32x32x16_bf16 v[92:107], v[168:171], v[120:123], v[92:107]
    v_cvt_pk_bf16_f32 v113, v54, v55
    v_exp_f32 v58, v58
    v_exp_f32 v59, v59
    v_cvt_pk_bf16_f32 v114, v56, v57
    v_cvt_pk_bf16_f32 v115, v58, v59
    s_waitcnt lgkmcnt(0)
    v_exp_f32 v60, v60
    v_exp_f32 v61, v61
    v_mfma_f32_32x32x16_bf16 v[12:27], v[136:139], v[124:127], v[12:27]
    ds_read_b128 v[140:143], v180 offset:9216
    ds_read_b32 v162, v181 offset:1280
    s_mov_b64 exec, s[48:49]
    ds_read_b128 v[164:167], v182 offset:9216
    ds_read_b128 v[168:171], v183 offset:9216
    s_mov_b64 exec, -1
    v_exp_f32 v62, v62
    v_exp_f32 v63, v63
    v_cvt_pk_bf16_f32 v116, v60, v61
    v_exp_f32 v64, v64
    v_exp_f32 v65, v65
    v_mfma_f32_32x32x16_bf16 v[28:43], v[136:139], v[128:131], v[28:43]
    v_cvt_pk_bf16_f32 v117, v62, v63
    v_exp_f32 v66, v66
    v_exp_f32 v67, v67
    v_cvt_pk_bf16_f32 v118, v64, v65
    v_exp_f32 v68, v68
    v_exp_f32 v69, v69
    v_mfma_f32_32x32x16_bf16 v[76:91], v[172:175], v[108:111], v[76:91]
    v_cvt_pk_bf16_f32 v119, v66, v67
    v_exp_f32 v70, v70
    v_exp_f32 v71, v71
    v_cvt_pk_bf16_f32 v120, v68, v69
    v_exp_f32 v72, v72
    v_exp_f32 v73, v73
    v_mfma_f32_32x32x16_bf16 v[76:91], v[176:179], v[112:115], v[76:91]
    v_cvt_pk_bf16_f32 v121, v70, v71
    v_exp_f32 v74, v74
    v_exp_f32 v75, v75
    v_cvt_pk_bf16_f32 v122, v72, v73
    v_cvt_pk_bf16_f32 v123, v74, v75
    v_exp_f32 v12, v12
    v_exp_f32 v13, v13
    v_mfma_f32_32x32x4_2b_bf16 v[44:75], v[160:161], v[132:133], 0 cbsz:1 abid:1
    v_exp_f32 v14, v14
    v_exp_f32 v15, v15
    v_cvt_pk_bf16_f32 v108, v12, v13
    v_exp_f32 v16, v16
    v_exp_f32 v17, v17
    v_cvt_pk_bf16_f32 v109, v14, v15
    v_exp_f32 v18, v18
    s_add_u32 m0, s59, 0
    s_mov_b32 s29, s55
    buffer_load_dwordx4 v188, s[16:19], s29 offen lds
    v_exp_f32 v19, v19
    v_cvt_pk_bf16_f32 v110, v16, v17
    v_exp_f32 v20, v20
    v_exp_f32 v21, v21
    v_mfma_f32_32x32x16_bf16 v[92:107], v[172:175], v[116:119], v[92:107]
    v_cvt_pk_bf16_f32 v111, v18, v19
    v_exp_f32 v22, v22
    s_add_u32 m0, s59, 1024
    s_add_u32 s29, s55, s57
    buffer_load_dwordx4 v188, s[16:19], s29 offen lds
    v_exp_f32 v23, v23
    v_cvt_pk_bf16_f32 v112, v20, v21
    v_exp_f32 v24, v24
    v_exp_f32 v25, v25
    v_mfma_f32_32x32x16_bf16 v[92:107], v[176:179], v[120:123], v[92:107]
    v_cvt_pk_bf16_f32 v113, v22, v23
    v_exp_f32 v26, v26
    v_exp_f32 v27, v27
    v_cvt_pk_bf16_f32 v114, v24, v25
    v_cvt_pk_bf16_f32 v115, v26, v27
    s_waitcnt lgkmcnt(0)
    v_exp_f32 v28, v28
    v_exp_f32 v29, v29
    v_mfma_f32_32x32x16_bf16 v[44:59], v[140:143], v[124:127], v[44:59]
    s_setprio 1
    ds_read_b128 v[136:139], v180 offset:10240
    s_mov_b64 exec, s[48:49]
    ds_read_b128 v[172:175], v182 offset:10368
    ds_read_b128 v[176:179], v183 offset:10368
    s_mov_b64 exec, -1
    v_exp_f32 v30, v30
    v_exp_f32 v31, v31
    v_cvt_pk_bf16_f32 v116, v28, v29
    v_exp_f32 v32, v32
    v_exp_f32 v33, v33
    v_mfma_f32_32x32x16_bf16 v[60:75], v[140:143], v[128:131], v[60:75]
    v_cvt_pk_bf16_f32 v117, v30, v31
    v_exp_f32 v34, v34
    v_exp_f32 v35, v35
    v_cvt_pk_bf16_f32 v118, v32, v33
    v_exp_f32 v36, v36
    v_exp_f32 v37, v37
    v_mfma_f32_32x32x16_bf16 v[76:91], v[164:167], v[108:111], v[76:91]
    v_cvt_pk_bf16_f32 v119, v34, v35
    v_exp_f32 v38, v38
    v_exp_f32 v39, v39
    v_cvt_pk_bf16_f32 v120, v36, v37
    v_exp_f32 v40, v40
    v_exp_f32 v41, v41
    v_mfma_f32_32x32x16_bf16 v[76:91], v[168:171], v[112:115], v[76:91]
    v_cvt_pk_bf16_f32 v121, v38, v39
    v_exp_f32 v42, v42
    v_exp_f32 v43, v43
    v_cvt_pk_bf16_f32 v122, v40, v41
    v_cvt_pk_bf16_f32 v123, v42, v43
    v_exp_f32 v44, v44
    v_exp_f32 v45, v45
    v_mfma_f32_32x32x4_2b_bf16 v[12:43], v[162:163], v[132:133], 0 cbsz:1 abid:0
    s_setprio 0
    v_exp_f32 v46, v46
    v_exp_f32 v47, v47
    v_cvt_pk_bf16_f32 v108, v44, v45
    v_exp_f32 v48, v48
    v_exp_f32 v49, v49
    v_cvt_pk_bf16_f32 v109, v46, v47
    v_exp_f32 v50, v50
    v_exp_f32 v51, v51
    v_cvt_pk_bf16_f32 v110, v48, v49
    v_exp_f32 v52, v52
    v_exp_f32 v53, v53
    v_mfma_f32_32x32x16_bf16 v[92:107], v[164:167], v[116:119], v[92:107]
    v_cvt_pk_bf16_f32 v111, v50, v51
    v_exp_f32 v54, v54
    v_exp_f32 v55, v55
    v_cvt_pk_bf16_f32 v112, v52, v53
    v_exp_f32 v56, v56
    v_exp_f32 v57, v57
    v_mfma_f32_32x32x16_bf16 v[92:107], v[168:171], v[120:123], v[92:107]
    v_cvt_pk_bf16_f32 v113, v54, v55
    v_exp_f32 v58, v58
    v_exp_f32 v59, v59
    v_cvt_pk_bf16_f32 v114, v56, v57
    v_cvt_pk_bf16_f32 v115, v58, v59
    s_waitcnt vmcnt(4)
    s_barrier
    s_waitcnt lgkmcnt(0)
    v_exp_f32 v60, v60
    v_exp_f32 v61, v61
    v_mfma_f32_32x32x16_bf16 v[12:27], v[136:139], v[124:127], v[12:27]
    s_setprio 3
    ds_read_b128 v[140:143], v180 offset:11264
    ds_read_b32 v160, v181 offset:1536
    s_mov_b64 exec, s[48:49]
    ds_read_b128 v[164:167], v182 offset:11520
    ds_read_b128 v[168:171], v183 offset:11520
    s_mov_b64 exec, -1
    v_exp_f32 v62, v62
    v_exp_f32 v63, v63
    v_cvt_pk_bf16_f32 v116, v60, v61
    v_exp_f32 v64, v64
    v_exp_f32 v65, v65
    v_mfma_f32_32x32x16_bf16 v[28:43], v[136:139], v[128:131], v[28:43]
    v_cvt_pk_bf16_f32 v117, v62, v63
    v_exp_f32 v66, v66
    v_exp_f32 v67, v67
    v_cvt_pk_bf16_f32 v118, v64, v65
    v_exp_f32 v68, v68
    v_exp_f32 v69, v69
    v_mfma_f32_32x32x16_bf16 v[76:91], v[172:175], v[108:111], v[76:91]
    v_cvt_pk_bf16_f32 v119, v66, v67
    v_exp_f32 v70, v70
    v_exp_f32 v71, v71
    v_cvt_pk_bf16_f32 v120, v68, v69
    v_exp_f32 v72, v72
    v_exp_f32 v73, v73
    v_mfma_f32_32x32x16_bf16 v[76:91], v[176:179], v[112:115], v[76:91]
    v_cvt_pk_bf16_f32 v121, v70, v71
    v_exp_f32 v74, v74
    v_exp_f32 v75, v75
    v_cvt_pk_bf16_f32 v122, v72, v73
    v_cvt_pk_bf16_f32 v123, v74, v75
    v_exp_f32 v12, v12
    v_exp_f32 v13, v13
    v_mfma_f32_32x32x4_2b_bf16 v[44:75], v[162:163], v[132:133], 0 cbsz:1 abid:1
    v_exp_f32 v14, v14
    v_exp_f32 v15, v15
    v_cvt_pk_bf16_f32 v108, v12, v13
    v_exp_f32 v16, v16
    v_exp_f32 v17, v17
    v_cvt_pk_bf16_f32 v109, v14, v15
    v_exp_f32 v18, v18
    s_add_u32 m0, s35, 24576
    s_add_u32 s29, m0, s34
    buffer_load_dwordx4 v5, s[12:15], s29 offen sc1 lds
    v_exp_f32 v19, v19
    v_cvt_pk_bf16_f32 v110, v16, v17
    v_exp_f32 v20, v20
    v_exp_f32 v21, v21
    v_mfma_f32_32x32x16_bf16 v[92:107], v[172:175], v[116:119], v[92:107]
    v_cvt_pk_bf16_f32 v111, v18, v19
    v_exp_f32 v22, v22
    s_add_u32 m0, s39, 24576
    s_add_u32 s29, m0, s34
    buffer_load_dwordx4 v5, s[12:15], s29 offen sc1 lds
    v_exp_f32 v23, v23
    v_cvt_pk_bf16_f32 v112, v20, v21
    v_exp_f32 v24, v24
    v_exp_f32 v25, v25
    v_mfma_f32_32x32x16_bf16 v[92:107], v[176:179], v[120:123], v[92:107]
    v_cvt_pk_bf16_f32 v113, v22, v23
    v_exp_f32 v26, v26
    v_exp_f32 v27, v27
    v_cvt_pk_bf16_f32 v114, v24, v25
    v_cvt_pk_bf16_f32 v115, v26, v27
    s_waitcnt lgkmcnt(0)
    v_exp_f32 v28, v28
    v_exp_f32 v29, v29
    v_mfma_f32_32x32x16_bf16 v[44:59], v[140:143], v[124:127], v[44:59]
    ds_read_b128 v[136:139], v180 offset:12288
    s_mov_b64 exec, s[48:49]
    ds_read_b128 v[172:175], v182 offset:12672
    ds_read_b128 v[176:179], v183 offset:12672
    s_mov_b64 exec, -1
    v_exp_f32 v30, v30
    v_exp_f32 v31, v31
    v_cvt_pk_bf16_f32 v116, v28, v29
    v_exp_f32 v32, v32
    v_exp_f32 v33, v33
    v_mfma_f32_32x32x16_bf16 v[60:75], v[140:143], v[128:131], v[60:75]
    v_cvt_pk_bf16_f32 v117, v30, v31
    v_exp_f32 v34, v34
    s_add_u32 m0, s35, 28672
    s_add_u32 s29, m0, s34
    buffer_load_dwordx4 v5, s[12:15], s29 offen sc1 lds
    v_exp_f32 v35, v35
    v_cvt_pk_bf16_f32 v118, v32, v33
    v_exp_f32 v36, v36
    v_exp_f32 v37, v37
    v_mfma_f32_32x32x16_bf16 v[76:91], v[164:167], v[108:111], v[76:91]
    v_cvt_pk_bf16_f32 v119, v34, v35
    v_exp_f32 v38, v38
    s_add_u32 m0, s39, 28672
    s_add_u32 s29, m0, s34
    buffer_load_dwordx4 v5, s[12:15], s29 offen sc1 lds
    v_exp_f32 v39, v39
    v_cvt_pk_bf16_f32 v120, v36, v37
    v_exp_f32 v40, v40
    v_exp_f32 v41, v41
    v_mfma_f32_32x32x16_bf16 v[76:91], v[168:171], v[112:115], v[76:91]
    v_cvt_pk_bf16_f32 v121, v38, v39
    v_exp_f32 v42, v42
    v_exp_f32 v43, v43
    v_cvt_pk_bf16_f32 v122, v40, v41
    v_cvt_pk_bf16_f32 v123, v42, v43
    v_exp_f32 v44, v44
    v_exp_f32 v45, v45
    v_mfma_f32_32x32x4_2b_bf16 v[12:43], v[160:161], v[132:133], 0 cbsz:1 abid:0
    v_exp_f32 v46, v46
    v_exp_f32 v47, v47
    v_cvt_pk_bf16_f32 v108, v44, v45
    v_exp_f32 v48, v48
    v_exp_f32 v49, v49
    v_cvt_pk_bf16_f32 v109, v46, v47
    v_exp_f32 v50, v50
    s_add_u32 m0, s35, 32768
    s_add_u32 s29, m0, s34
    buffer_load_dwordx4 v5, s[12:15], s29 offen sc1 lds
    v_exp_f32 v51, v51
    v_cvt_pk_bf16_f32 v110, v48, v49
    v_exp_f32 v52, v52
    v_exp_f32 v53, v53
    v_mfma_f32_32x32x16_bf16 v[92:107], v[164:167], v[116:119], v[92:107]
    v_cvt_pk_bf16_f32 v111, v50, v51
    v_exp_f32 v54, v54
    v_exp_f32 v55, v55
    v_cvt_pk_bf16_f32 v112, v52, v53
    v_exp_f32 v56, v56
    v_exp_f32 v57, v57
    v_mfma_f32_32x32x16_bf16 v[92:107], v[168:171], v[120:123], v[92:107]
    v_cvt_pk_bf16_f32 v113, v54, v55
    v_exp_f32 v58, v58
    v_exp_f32 v59, v59
    v_cvt_pk_bf16_f32 v114, v56, v57
    v_cvt_pk_bf16_f32 v115, v58, v59
    s_waitcnt lgkmcnt(0)
    v_exp_f32 v60, v60
    v_exp_f32 v61, v61
    v_mfma_f32_32x32x16_bf16 v[12:27], v[136:139], v[124:127], v[12:27]
    ds_read_b128 v[140:143], v180 offset:13312
    ds_read_b32 v162, v181 offset:1792
    s_mov_b64 exec, s[48:49]
    ds_read_b128 v[164:167], v182 offset:13824
    ds_read_b128 v[168:171], v183 offset:13824
    s_mov_b64 exec, -1
    v_exp_f32 v62, v62
    v_exp_f32 v63, v63
    v_cvt_pk_bf16_f32 v116, v60, v61
    v_exp_f32 v64, v64
    v_exp_f32 v65, v65
    v_mfma_f32_32x32x16_bf16 v[28:43], v[136:139], v[128:131], v[28:43]
    v_cvt_pk_bf16_f32 v117, v62, v63
    v_exp_f32 v66, v66
    v_exp_f32 v67, v67
    v_cvt_pk_bf16_f32 v118, v64, v65
    v_exp_f32 v68, v68
    v_exp_f32 v69, v69
    v_mfma_f32_32x32x16_bf16 v[76:91], v[172:175], v[108:111], v[76:91]
    v_cvt_pk_bf16_f32 v119, v66, v67
    v_exp_f32 v70, v70
    v_exp_f32 v71, v71
    v_cvt_pk_bf16_f32 v120, v68, v69
    v_exp_f32 v72, v72
    v_exp_f32 v73, v73
    v_mfma_f32_32x32x16_bf16 v[76:91], v[176:179], v[112:115], v[76:91]
    v_cvt_pk_bf16_f32 v121, v70, v71
    v_exp_f32 v74, v74
    v_exp_f32 v75, v75
    v_cvt_pk_bf16_f32 v122, v72, v73
    v_cvt_pk_bf16_f32 v123, v74, v75
    v_exp_f32 v12, v12
    v_exp_f32 v13, v13
    v_mfma_f32_32x32x4_2b_bf16 v[44:75], v[160:161], v[132:133], 0 cbsz:1 abid:1
    v_exp_f32 v14, v14
    v_exp_f32 v15, v15
    v_cvt_pk_bf16_f32 v108, v12, v13
    v_exp_f32 v16, v16
    v_exp_f32 v17, v17
    v_cvt_pk_bf16_f32 v109, v14, v15
    v_exp_f32 v18, v18
    s_waitcnt vmcnt(5)
    ds_read_b64_tr_b16 v[146:147], v189 offset:0
    ds_read_b64_tr_b16 v[150:151], v189 offset:32
    ds_read_b64_tr_b16 v[154:155], v189 offset:64
    ds_read_b64_tr_b16 v[158:159], v189 offset:96
    v_exp_f32 v19, v19
    v_cvt_pk_bf16_f32 v110, v16, v17
    v_exp_f32 v20, v20
    v_exp_f32 v21, v21
    v_mfma_f32_32x32x16_bf16 v[92:107], v[172:175], v[116:119], v[92:107]
    v_cvt_pk_bf16_f32 v111, v18, v19
    v_exp_f32 v22, v22
    s_cmp_lt_u32 s53, 128
    s_cselect_b32 s16, s40, s42
    s_cselect_b32 s17, s41, s43
    s_mov_b32 s18, 5308416
    s_mov_b64 exec, 0xffff
    buffer_load_dword v185, v193, s[16:19], 0 offen
    s_mov_b64 exec, -1
    v_exp_f32 v23, v23
    v_cvt_pk_bf16_f32 v112, v20, v21
    v_exp_f32 v24, v24
    v_exp_f32 v25, v25
    v_mfma_f32_32x32x16_bf16 v[92:107], v[176:179], v[120:123], v[92:107]
    v_cvt_pk_bf16_f32 v113, v22, v23
    v_exp_f32 v26, v26
    v_exp_f32 v27, v27
    v_cvt_pk_bf16_f32 v114, v24, v25
    v_cvt_pk_bf16_f32 v115, v26, v27
    s_waitcnt lgkmcnt(0)
    v_exp_f32 v28, v28
    v_exp_f32 v29, v29
    v_mfma_f32_32x32x16_bf16 v[44:59], v[140:143], v[124:127], v[44:59]
    ds_read_b128 v[136:139], v180 offset:14336
    s_mov_b64 exec, s[48:49]
    ds_read_b128 v[172:175], v182 offset:14976
    ds_read_b128 v[176:179], v183 offset:14976
    s_mov_b64 exec, -1
    v_exp_f32 v30, v30
    v_exp_f32 v31, v31
    v_cvt_pk_bf16_f32 v116, v28, v29
    v_exp_f32 v32, v32
    v_exp_f32 v33, v33
    v_mfma_f32_32x32x16_bf16 v[60:75], v[140:143], v[128:131], v[60:75]
    v_cvt_pk_bf16_f32 v117, v30, v31
    v_exp_f32 v34, v34
    v_exp_f32 v35, v35
    v_cvt_pk_bf16_f32 v118, v32, v33
    v_exp_f32 v36, v36
    v_exp_f32 v37, v37
    v_mfma_f32_32x32x16_bf16 v[76:91], v[164:167], v[108:111], v[76:91]
    v_cvt_pk_bf16_f32 v119, v34, v35
    v_exp_f32 v38, v38
    v_exp_f32 v39, v39
    v_cvt_pk_bf16_f32 v120, v36, v37
    v_exp_f32 v40, v40
    v_exp_f32 v41, v41
    v_mfma_f32_32x32x16_bf16 v[76:91], v[168:171], v[112:115], v[76:91]
    v_cvt_pk_bf16_f32 v121, v38, v39
    v_exp_f32 v42, v42
    v_exp_f32 v43, v43
    v_cvt_pk_bf16_f32 v122, v40, v41
    v_cvt_pk_bf16_f32 v123, v42, v43
    v_exp_f32 v44, v44
    v_exp_f32 v45, v45
    v_mfma_f32_32x32x4_2b_bf16 v[12:43], v[162:163], v[132:133], 0 cbsz:1 abid:0
    v_exp_f32 v46, v46
    v_exp_f32 v47, v47
    v_cvt_pk_bf16_f32 v108, v44, v45
    v_exp_f32 v48, v48
    v_exp_f32 v49, v49
    v_cvt_pk_bf16_f32 v109, v46, v47
    v_exp_f32 v50, v50
    buffer_store_dwordx4 v[144:147], v5, s[12:15], s58 offen sc1
    v_exp_f32 v51, v51
    v_cvt_pk_bf16_f32 v110, v48, v49
    v_exp_f32 v52, v52
    v_exp_f32 v53, v53
    v_mfma_f32_32x32x16_bf16 v[92:107], v[164:167], v[116:119], v[92:107]
    v_cvt_pk_bf16_f32 v111, v50, v51
    v_exp_f32 v54, v54
    v_exp_f32 v55, v55
    v_cvt_pk_bf16_f32 v112, v52, v53
    v_exp_f32 v56, v56
    v_exp_f32 v57, v57
    v_mfma_f32_32x32x16_bf16 v[92:107], v[168:171], v[120:123], v[92:107]
    v_cvt_pk_bf16_f32 v113, v54, v55
    v_exp_f32 v58, v58
    v_exp_f32 v59, v59
    v_cvt_pk_bf16_f32 v114, v56, v57
    v_cvt_pk_bf16_f32 v115, v58, v59
    s_waitcnt lgkmcnt(0)
    v_exp_f32 v60, v60
    v_exp_f32 v61, v61
    v_mfma_f32_32x32x16_bf16 v[12:27], v[136:139], v[124:127], v[12:27]
    ds_read_b128 v[140:143], v180 offset:15360
    ds_read_b32 v160, v181 offset:2048
    s_mov_b64 exec, s[48:49]
    ds_read_b128 v[164:167], v182 offset:16128
    ds_read_b128 v[168:171], v183 offset:16128
    s_mov_b64 exec, -1
    v_exp_f32 v62, v62
    v_exp_f32 v63, v63
    v_cvt_pk_bf16_f32 v116, v60, v61
    v_exp_f32 v64, v64
    v_exp_f32 v65, v65
    v_mfma_f32_32x32x16_bf16 v[28:43], v[136:139], v[128:131], v[28:43]
    v_cvt_pk_bf16_f32 v117, v62, v63
    v_exp_f32 v66, v66
    v_exp_f32 v67, v67
    v_cvt_pk_bf16_f32 v118, v64, v65
    v_exp_f32 v68, v68
    v_exp_f32 v69, v69
    v_mfma_f32_32x32x16_bf16 v[76:91], v[172:175], v[108:111], v[76:91]
    v_cvt_pk_bf16_f32 v119, v66, v67
    v_exp_f32 v70, v70
    v_exp_f32 v71, v71
    v_cvt_pk_bf16_f32 v120, v68, v69
    v_exp_f32 v72, v72
    v_exp_f32 v73, v73
    v_mfma_f32_32x32x16_bf16 v[76:91], v[176:179], v[112:115], v[76:91]
    v_cvt_pk_bf16_f32 v121, v70, v71
    v_exp_f32 v74, v74
    v_exp_f32 v75, v75
    v_cvt_pk_bf16_f32 v122, v72, v73
    v_cvt_pk_bf16_f32 v123, v74, v75
    v_exp_f32 v12, v12
    v_exp_f32 v13, v13
    v_mfma_f32_32x32x4_2b_bf16 v[44:75], v[162:163], v[132:133], 0 cbsz:1 abid:1
    v_exp_f32 v14, v14
    v_exp_f32 v15, v15
    v_cvt_pk_bf16_f32 v108, v12, v13
    v_exp_f32 v16, v16
    v_exp_f32 v17, v17
    v_cvt_pk_bf16_f32 v109, v14, v15
    v_exp_f32 v18, v18
    buffer_store_dwordx4 v[148:151], v5, s[12:15], s61 offen sc1
    v_exp_f32 v19, v19
    v_cvt_pk_bf16_f32 v110, v16, v17
    v_exp_f32 v20, v20
    v_exp_f32 v21, v21
    v_mfma_f32_32x32x16_bf16 v[92:107], v[172:175], v[116:119], v[92:107]
    v_cvt_pk_bf16_f32 v111, v18, v19
    v_exp_f32 v22, v22
    v_exp_f32 v23, v23
    v_cvt_pk_bf16_f32 v112, v20, v21
    v_exp_f32 v24, v24
    v_exp_f32 v25, v25
    v_mfma_f32_32x32x16_bf16 v[92:107], v[176:179], v[120:123], v[92:107]
    v_cvt_pk_bf16_f32 v113, v22, v23
    v_exp_f32 v26, v26
    v_exp_f32 v27, v27
    v_cvt_pk_bf16_f32 v114, v24, v25
    v_cvt_pk_bf16_f32 v115, v26, v27
    s_waitcnt lgkmcnt(0)
    v_exp_f32 v28, v28
    v_exp_f32 v29, v29
    v_mfma_f32_32x32x16_bf16 v[44:59], v[140:143], v[124:127], v[44:59]
    ds_read_b128 v[136:139], v180 offset:16384
    s_mov_b64 exec, s[48:49]
    ds_read_b128 v[172:175], v182 offset:17280
    ds_read_b128 v[176:179], v183 offset:17280
    s_mov_b64 exec, -1
    v_exp_f32 v30, v30
    v_exp_f32 v31, v31
    v_cvt_pk_bf16_f32 v116, v28, v29
    v_exp_f32 v32, v32
    v_exp_f32 v33, v33
    v_mfma_f32_32x32x16_bf16 v[60:75], v[140:143], v[128:131], v[60:75]
    v_cvt_pk_bf16_f32 v117, v30, v31
    v_exp_f32 v34, v34
    v_exp_f32 v35, v35
    v_cvt_pk_bf16_f32 v118, v32, v33
    v_exp_f32 v36, v36
    v_exp_f32 v37, v37
    v_mfma_f32_32x32x16_bf16 v[76:91], v[164:167], v[108:111], v[76:91]
    v_cvt_pk_bf16_f32 v119, v34, v35
    v_exp_f32 v38, v38
    v_exp_f32 v39, v39
    v_cvt_pk_bf16_f32 v120, v36, v37
    v_exp_f32 v40, v40
    v_exp_f32 v41, v41
    v_mfma_f32_32x32x16_bf16 v[76:91], v[168:171], v[112:115], v[76:91]
    v_cvt_pk_bf16_f32 v121, v38, v39
    v_exp_f32 v42, v42
    v_exp_f32 v43, v43
    v_cvt_pk_bf16_f32 v122, v40, v41
    v_cvt_pk_bf16_f32 v123, v42, v43
    v_exp_f32 v44, v44
    v_exp_f32 v45, v45
    v_mfma_f32_32x32x4_2b_bf16 v[12:43], v[160:161], v[132:133], 0 cbsz:1 abid:0
    s_setprio 2
    v_exp_f32 v46, v46
    v_exp_f32 v47, v47
    v_cvt_pk_bf16_f32 v108, v44, v45
    v_exp_f32 v48, v48
    v_exp_f32 v49, v49
    v_cvt_pk_bf16_f32 v109, v46, v47
    v_exp_f32 v50, v50
    buffer_store_dwordx4 v[152:155], v5, s[12:15], s62 offen sc1
    v_exp_f32 v51, v51
    v_cvt_pk_bf16_f32 v110, v48, v49
    v_exp_f32 v52, v52
    v_exp_f32 v53, v53
    v_mfma_f32_32x32x16_bf16 v[92:107], v[164:167], v[116:119], v[92:107]
    v_cvt_pk_bf16_f32 v111, v50, v51
    v_exp_f32 v54, v54
    v_exp_f32 v55, v55
    v_cvt_pk_bf16_f32 v112, v52, v53
    v_exp_f32 v56, v56
    v_exp_f32 v57, v57
    v_mfma_f32_32x32x16_bf16 v[92:107], v[168:171], v[120:123], v[92:107]
    v_cvt_pk_bf16_f32 v113, v54, v55
    v_exp_f32 v58, v58
    v_exp_f32 v59, v59
    v_cvt_pk_bf16_f32 v114, v56, v57
    v_cvt_pk_bf16_f32 v115, v58, v59
    s_waitcnt lgkmcnt(0)
    v_exp_f32 v60, v60
    v_exp_f32 v61, v61
    v_mfma_f32_32x32x16_bf16 v[12:27], v[136:139], v[124:127], v[12:27]
    ds_read_b128 v[140:143], v180 offset:17408
    ds_read_b32 v162, v181 offset:2304
    s_mov_b64 exec, s[48:49]
    ds_read_b128 v[164:167], v182 offset:18432
    ds_read_b128 v[168:171], v183 offset:18432
    s_mov_b64 exec, -1
    v_exp_f32 v62, v62
    v_exp_f32 v63, v63
    v_cvt_pk_bf16_f32 v116, v60, v61
    v_exp_f32 v64, v64
    v_exp_f32 v65, v65
    v_mfma_f32_32x32x16_bf16 v[28:43], v[136:139], v[128:131], v[28:43]
    v_cvt_pk_bf16_f32 v117, v62, v63
    v_exp_f32 v66, v66
    s_mov_b32 exec_lo, 0xffff0000
    s_mov_b32 exec_hi, 0
    buffer_load_dword v185, v193, s[16:19], 0 offen
    s_mov_b64 exec, -1
    v_exp_f32 v67, v67
    v_cvt_pk_bf16_f32 v118, v64, v65
    v_exp_f32 v68, v68
    v_exp_f32 v69, v69
    v_mfma_f32_32x32x16_bf16 v[76:91], v[172:175], v[108:111], v[76:91]
    v_cvt_pk_bf16_f32 v119, v66, v67
    v_exp_f32 v70, v70
    v_exp_f32 v71, v71
    v_cvt_pk_bf16_f32 v120, v68, v69
    v_exp_f32 v72, v72
    v_exp_f32 v73, v73
    v_mfma_f32_32x32x16_bf16 v[76:91], v[176:179], v[112:115], v[76:91]
    v_cvt_pk_bf16_f32 v121, v70, v71
    v_exp_f32 v74, v74
    v_exp_f32 v75, v75
    v_cvt_pk_bf16_f32 v122, v72, v73
    v_cvt_pk_bf16_f32 v123, v74, v75
    v_exp_f32 v12, v12
    v_exp_f32 v13, v13
    v_mfma_f32_32x32x4_2b_bf16 v[44:75], v[160:161], v[132:133], 0 cbsz:1 abid:1
    v_exp_f32 v14, v14
    v_exp_f32 v15, v15
    v_cvt_pk_bf16_f32 v108, v12, v13
    v_exp_f32 v16, v16
    v_exp_f32 v17, v17
    v_cvt_pk_bf16_f32 v109, v14, v15
    v_exp_f32 v18, v18
    buffer_store_dwordx4 v[156:159], v5, s[12:15], s63 offen sc1
    v_exp_f32 v19, v19
    v_cvt_pk_bf16_f32 v110, v16, v17
    v_exp_f32 v20, v20
    v_exp_f32 v21, v21
    v_mfma_f32_32x32x16_bf16 v[92:107], v[172:175], v[116:119], v[92:107]
    v_cvt_pk_bf16_f32 v111, v18, v19
    v_exp_f32 v22, v22
    v_exp_f32 v23, v23
    v_cvt_pk_bf16_f32 v112, v20, v21
    v_exp_f32 v24, v24
    v_exp_f32 v25, v25
    v_mfma_f32_32x32x16_bf16 v[92:107], v[176:179], v[120:123], v[92:107]
    v_cvt_pk_bf16_f32 v113, v22, v23
    v_exp_f32 v26, v26
    v_exp_f32 v27, v27
    v_cvt_pk_bf16_f32 v114, v24, v25
    v_cvt_pk_bf16_f32 v115, v26, v27
    s_waitcnt lgkmcnt(0)
    v_exp_f32 v28, v28
    v_exp_f32 v29, v29
    v_mfma_f32_32x32x16_bf16 v[44:59], v[140:143], v[124:127], v[44:59]
    ds_read_b128 v[136:139], v180 offset:18432
    s_mov_b64 exec, s[48:49]
    ds_read_b128 v[172:175], v182 offset:19584
    ds_read_b128 v[176:179], v183 offset:19584
    s_mov_b64 exec, -1
    v_exp_f32 v30, v30
    v_exp_f32 v31, v31
    v_cvt_pk_bf16_f32 v116, v28, v29
    v_exp_f32 v32, v32
    v_exp_f32 v33, v33
    v_mfma_f32_32x32x16_bf16 v[60:75], v[140:143], v[128:131], v[60:75]
    v_cvt_pk_bf16_f32 v117, v30, v31
    v_exp_f32 v34, v34
    v_exp_f32 v35, v35
    v_cvt_pk_bf16_f32 v118, v32, v33
    v_exp_f32 v36, v36
    v_exp_f32 v37, v37
    v_mfma_f32_32x32x16_bf16 v[76:91], v[164:167], v[108:111], v[76:91]
    v_cvt_pk_bf16_f32 v119, v34, v35
    v_exp_f32 v38, v38
    v_exp_f32 v39, v39
    v_cvt_pk_bf16_f32 v120, v36, v37
    v_exp_f32 v40, v40
    v_exp_f32 v41, v41
    v_mfma_f32_32x32x16_bf16 v[76:91], v[168:171], v[112:115], v[76:91]
    v_cvt_pk_bf16_f32 v121, v38, v39
    v_exp_f32 v42, v42
    v_exp_f32 v43, v43
    v_cvt_pk_bf16_f32 v122, v40, v41
    v_cvt_pk_bf16_f32 v123, v42, v43
    v_exp_f32 v44, v44
    v_exp_f32 v45, v45
    v_mfma_f32_32x32x4_2b_bf16 v[12:43], v[162:163], v[132:133], 0 cbsz:1 abid:0
    v_exp_f32 v46, v46
    v_exp_f32 v47, v47
    v_cvt_pk_bf16_f32 v108, v44, v45
    v_exp_f32 v48, v48
    v_exp_f32 v49, v49
    v_cvt_pk_bf16_f32 v109, v46, v47
    v_exp_f32 v50, v50
    v_exp_f32 v51, v51
    v_cvt_pk_bf16_f32 v110, v48, v49
    v_exp_f32 v52, v52
    v_exp_f32 v53, v53
    v_mfma_f32_32x32x16_bf16 v[92:107], v[164:167], v[116:119], v[92:107]
    v_cvt_pk_bf16_f32 v111, v50, v51
    v_exp_f32 v54, v54
    v_exp_f32 v55, v55
    v_cvt_pk_bf16_f32 v112, v52, v53
    v_exp_f32 v56, v56
    v_exp_f32 v57, v57
    v_mfma_f32_32x32x16_bf16 v[92:107], v[168:171], v[120:123], v[92:107]
    v_cvt_pk_bf16_f32 v113, v54, v55
    v_exp_f32 v58, v58
    v_exp_f32 v59, v59
    v_cvt_pk_bf16_f32 v114, v56, v57
    v_cvt_pk_bf16_f32 v115, v58, v59
    s_waitcnt lgkmcnt(0)
    v_exp_f32 v60, v60
    v_exp_f32 v61, v61
    v_mfma_f32_32x32x16_bf16 v[12:27], v[136:139], v[124:127], v[12:27]
    ds_read_b128 v[140:143], v180 offset:19456
    ds_read_b32 v160, v181 offset:2560
    s_mov_b64 exec, s[48:49]
    ds_read_b128 v[164:167], v182 offset:20736
    ds_read_b128 v[168:171], v183 offset:20736
    s_mov_b64 exec, -1
    v_exp_f32 v62, v62
    v_exp_f32 v63, v63
    v_cvt_pk_bf16_f32 v116, v60, v61
    v_exp_f32 v64, v64
    v_exp_f32 v65, v65
    v_mfma_f32_32x32x16_bf16 v[28:43], v[136:139], v[128:131], v[28:43]
    v_cvt_pk_bf16_f32 v117, v62, v63
    v_exp_f32 v66, v66
    s_cmp_lg_u32 s24, 0
    s_cbranch_scc1 LM_rc0
    global_load_dword v191, v190, s[0:1] offset:128 sc1
    LM_rc0:
    v_exp_f32 v67, v67
    v_cvt_pk_bf16_f32 v118, v64, v65
    v_exp_f32 v68, v68
    v_exp_f32 v69, v69
    v_mfma_f32_32x32x16_bf16 v[76:91], v[172:175], v[108:111], v[76:91]
    v_cvt_pk_bf16_f32 v119, v66, v67
    v_exp_f32 v70, v70
    v_exp_f32 v71, v71
    v_cvt_pk_bf16_f32 v120, v68, v69
    v_exp_f32 v72, v72
    v_exp_f32 v73, v73
    v_mfma_f32_32x32x16_bf16 v[76:91], v[176:179], v[112:115], v[76:91]
    v_cvt_pk_bf16_f32 v121, v70, v71
    v_exp_f32 v74, v74
    v_exp_f32 v75, v75
    v_cvt_pk_bf16_f32 v122, v72, v73
    v_cvt_pk_bf16_f32 v123, v74, v75
    v_exp_f32 v12, v12
    v_exp_f32 v13, v13
    v_mfma_f32_32x32x4_2b_bf16 v[44:75], v[162:163], v[132:133], 0 cbsz:1 abid:1
    v_exp_f32 v14, v14
    v_exp_f32 v15, v15
    v_cvt_pk_bf16_f32 v108, v12, v13
    v_exp_f32 v16, v16
    v_exp_f32 v17, v17
    v_cvt_pk_bf16_f32 v109, v14, v15
    v_exp_f32 v18, v18
    v_exp_f32 v19, v19
    v_cvt_pk_bf16_f32 v110, v16, v17
    v_exp_f32 v20, v20
    v_exp_f32 v21, v21
    v_mfma_f32_32x32x16_bf16 v[92:107], v[172:175], v[116:119], v[92:107]
    v_cvt_pk_bf16_f32 v111, v18, v19
    v_exp_f32 v22, v22
    v_exp_f32 v23, v23
    v_cvt_pk_bf16_f32 v112, v20, v21
    v_exp_f32 v24, v24
    v_exp_f32 v25, v25
    v_mfma_f32_32x32x16_bf16 v[92:107], v[176:179], v[120:123], v[92:107]
    v_cvt_pk_bf16_f32 v113, v22, v23
    v_exp_f32 v26, v26
    v_exp_f32 v27, v27
    v_cvt_pk_bf16_f32 v114, v24, v25
    v_cvt_pk_bf16_f32 v115, v26, v27
    s_waitcnt lgkmcnt(0)
    v_exp_f32 v28, v28
    v_exp_f32 v29, v29
    v_mfma_f32_32x32x16_bf16 v[44:59], v[140:143], v[124:127], v[44:59]
    s_setprio 1
    ds_read_b128 v[136:139], v180 offset:20480
    s_mov_b64 exec, s[48:49]
    ds_read_b128 v[172:175], v182 offset:21888
    ds_read_b128 v[176:179], v183 offset:21888
    s_mov_b64 exec, -1
    v_exp_f32 v30, v30
    v_exp_f32 v31, v31
    v_cvt_pk_bf16_f32 v116, v28, v29
    v_exp_f32 v32, v32
    v_exp_f32 v33, v33
    v_mfma_f32_32x32x16_bf16 v[60:75], v[140:143], v[128:131], v[60:75]
    v_cvt_pk_bf16_f32 v117, v30, v31
    v_exp_f32 v34, v34
    s_mov_b32 exec_lo, 0
    s_mov_b32 exec_hi, 0xff
    buffer_load_dword v185, v193, s[16:19], 0 offen
    s_mov_b64 exec, -1
    v_exp_f32 v35, v35
    v_cvt_pk_bf16_f32 v118, v32, v33
    v_exp_f32 v36, v36
    v_exp_f32 v37, v37
    v_mfma_f32_32x32x16_bf16 v[76:91], v[164:167], v[108:111], v[76:91]
    v_cvt_pk_bf16_f32 v119, v34, v35
    v_exp_f32 v38, v38
    v_exp_f32 v39, v39
    v_cvt_pk_bf16_f32 v120, v36, v37
    v_exp_f32 v40, v40
    v_exp_f32 v41, v41
    v_mfma_f32_32x32x16_bf16 v[76:91], v[168:171], v[112:115], v[76:91]
    v_cvt_pk_bf16_f32 v121, v38, v39
    v_exp_f32 v42, v42
    v_exp_f32 v43, v43
    v_cvt_pk_bf16_f32 v122, v40, v41
    v_cvt_pk_bf16_f32 v123, v42, v43
    v_exp_f32 v44, v44
    v_exp_f32 v45, v45
    v_mfma_f32_32x32x4_2b_bf16 v[12:43], v[160:161], v[132:133], 0 cbsz:1 abid:0
    v_exp_f32 v46, v46
    v_exp_f32 v47, v47
    v_cvt_pk_bf16_f32 v108, v44, v45
    v_exp_f32 v48, v48
    v_exp_f32 v49, v49
    v_cvt_pk_bf16_f32 v109, v46, v47
    v_exp_f32 v50, v50
    v_exp_f32 v51, v51
    v_cvt_pk_bf16_f32 v110, v48, v49
    v_exp_f32 v52, v52
    v_exp_f32 v53, v53
    v_mfma_f32_32x32x16_bf16 v[92:107], v[164:167], v[116:119], v[92:107]
    v_cvt_pk_bf16_f32 v111, v50, v51
    v_exp_f32 v54, v54
    v_exp_f32 v55, v55
    v_cvt_pk_bf16_f32 v112, v52, v53
    v_exp_f32 v56, v56
    v_exp_f32 v57, v57
    v_mfma_f32_32x32x16_bf16 v[92:107], v[168:171], v[120:123], v[92:107]
    v_cvt_pk_bf16_f32 v113, v54, v55
    v_exp_f32 v58, v58
    v_exp_f32 v59, v59
    v_cvt_pk_bf16_f32 v114, v56, v57
    v_cvt_pk_bf16_f32 v115, v58, v59
    s_waitcnt lgkmcnt(0)
    v_exp_f32 v60, v60
    v_exp_f32 v61, v61
    v_mfma_f32_32x32x16_bf16 v[12:27], v[136:139], v[124:127], v[12:27]
    ds_read_b128 v[140:143], v180 offset:21504
    ds_read_b32 v162, v181 offset:2816
    s_mov_b64 exec, s[48:49]
    ds_read_b128 v[164:167], v182 offset:23040
    ds_read_b128 v[168:171], v183 offset:23040
    s_mov_b64 exec, -1
    v_exp_f32 v62, v62
    v_exp_f32 v63, v63
    v_cvt_pk_bf16_f32 v116, v60, v61
    v_exp_f32 v64, v64
    v_exp_f32 v65, v65
    v_mfma_f32_32x32x16_bf16 v[28:43], v[136:139], v[128:131], v[28:43]
    v_cvt_pk_bf16_f32 v117, v62, v63
    v_exp_f32 v66, v66
    v_exp_f32 v67, v67
    v_cvt_pk_bf16_f32 v118, v64, v65
    v_exp_f32 v68, v68
    v_exp_f32 v69, v69
    v_mfma_f32_32x32x16_bf16 v[76:91], v[172:175], v[108:111], v[76:91]
    v_cvt_pk_bf16_f32 v119, v66, v67
    v_exp_f32 v70, v70
    v_exp_f32 v71, v71
    v_cvt_pk_bf16_f32 v120, v68, v69
    v_exp_f32 v72, v72
    v_exp_f32 v73, v73
    v_mfma_f32_32x32x16_bf16 v[76:91], v[176:179], v[112:115], v[76:91]
    v_cvt_pk_bf16_f32 v121, v70, v71
    v_exp_f32 v74, v74
    v_exp_f32 v75, v75
    v_cvt_pk_bf16_f32 v122, v72, v73
    v_cvt_pk_bf16_f32 v123, v74, v75
    v_exp_f32 v12, v12
    v_exp_f32 v13, v13
    v_mfma_f32_32x32x4_2b_bf16 v[44:75], v[160:161], v[132:133], 0 cbsz:1 abid:1
    s_setprio 0
    v_exp_f32 v14, v14
    v_exp_f32 v15, v15
    v_cvt_pk_bf16_f32 v108, v12, v13
    v_exp_f32 v16, v16
    v_exp_f32 v17, v17
    v_cvt_pk_bf16_f32 v109, v14, v15
    v_exp_f32 v18, v18
    v_exp_f32 v19, v19
    v_cvt_pk_bf16_f32 v110, v16, v17
    v_exp_f32 v20, v20
    v_exp_f32 v21, v21
    v_mfma_f32_32x32x16_bf16 v[92:107], v[172:175], v[116:119], v[92:107]
    v_cvt_pk_bf16_f32 v111, v18, v19
    v_exp_f32 v22, v22
    v_exp_f32 v23, v23
    v_cvt_pk_bf16_f32 v112, v20, v21
    v_exp_f32 v24, v24
    v_exp_f32 v25, v25
    v_mfma_f32_32x32x16_bf16 v[92:107], v[176:179], v[120:123], v[92:107]
    v_cvt_pk_bf16_f32 v113, v22, v23
    v_exp_f32 v26, v26
    v_exp_f32 v27, v27
    v_cvt_pk_bf16_f32 v114, v24, v25
    v_cvt_pk_bf16_f32 v115, v26, v27
    s_waitcnt vmcnt(7)
    s_barrier
    s_waitcnt vmcnt(1)
    LM_rcchk:
    v_cmp_gt_u32 vcc, 5, v191
    s_cbranch_vccnz LM_rc
    LM_rcok:
    s_waitcnt lgkmcnt(0)
    v_exp_f32 v28, v28
    v_exp_f32 v29, v29
    v_mfma_f32_32x32x16_bf16 v[44:59], v[140:143], v[124:127], v[44:59]
    s_setprio 3
    ds_read_b128 v[136:139], v180 offset:22528
    s_mov_b64 exec, s[48:49]
    ds_read_b128 v[172:175], v182 offset:24192
    ds_read_b128 v[176:179], v183 offset:24192
    s_mov_b64 exec, -1
    v_exp_f32 v30, v30
    v_exp_f32 v31, v31
    v_cvt_pk_bf16_f32 v116, v28, v29
    v_exp_f32 v32, v32
    v_exp_f32 v33, v33
    v_mfma_f32_32x32x16_bf16 v[60:75], v[140:143], v[128:131], v[60:75]
    v_cvt_pk_bf16_f32 v117, v30, v31
    v_exp_f32 v34, v34
    v_exp_f32 v35, v35
    v_cvt_pk_bf16_f32 v118, v32, v33
    v_exp_f32 v36, v36
    v_exp_f32 v37, v37
    v_mfma_f32_32x32x16_bf16 v[76:91], v[164:167], v[108:111], v[76:91]
    v_cvt_pk_bf16_f32 v119, v34, v35
    v_exp_f32 v38, v38
    v_exp_f32 v39, v39
    v_cvt_pk_bf16_f32 v120, v36, v37
    v_exp_f32 v40, v40
    v_exp_f32 v41, v41
    v_mfma_f32_32x32x16_bf16 v[76:91], v[168:171], v[112:115], v[76:91]
    v_cvt_pk_bf16_f32 v121, v38, v39
    v_exp_f32 v42, v42
    v_exp_f32 v43, v43
    v_cvt_pk_bf16_f32 v122, v40, v41
    v_cvt_pk_bf16_f32 v123, v42, v43
    v_exp_f32 v44, v44
    v_exp_f32 v45, v45
    v_mfma_f32_32x32x4_2b_bf16 v[12:43], v[162:163], v[132:133], 0 cbsz:1 abid:0
    v_exp_f32 v46, v46
    v_exp_f32 v47, v47
    v_cvt_pk_bf16_f32 v108, v44, v45
    v_exp_f32 v48, v48
    v_exp_f32 v49, v49
    v_cvt_pk_bf16_f32 v109, v46, v47
    v_exp_f32 v50, v50
    s_mov_b32 s16, s6
    s_mov_b32 s17, s7
    s_mov_b32 s18, 663552
    s_mov_b64 exec, 0x3fffff
    buffer_load_dword v184, v194, s[16:19], 0 offen
    s_mov_b64 exec, -1
    v_exp_f32 v51, v51
    v_cvt_pk_bf16_f32 v110, v48, v49
    v_exp_f32 v52, v52
    v_exp_f32 v53, v53
    v_mfma_f32_32x32x16_bf16 v[92:107], v[164:167], v[116:119], v[92:107]
    v_cvt_pk_bf16_f32 v111, v50, v51
    v_exp_f32 v54, v54
    v_exp_f32 v55, v55
    v_cvt_pk_bf16_f32 v112, v52, v53
    v_exp_f32 v56, v56
    v_exp_f32 v57, v57
    v_mfma_f32_32x32x16_bf16 v[92:107], v[168:171], v[120:123], v[92:107]
    v_cvt_pk_bf16_f32 v113, v54, v55
    v_exp_f32 v58, v58
    v_exp_f32 v59, v59
    v_cvt_pk_bf16_f32 v114, v56, v57
    v_cvt_pk_bf16_f32 v115, v58, v59
    s_waitcnt lgkmcnt(0)
    v_exp_f32 v60, v60
    v_exp_f32 v61, v61
    v_mfma_f32_32x32x16_bf16 v[12:27], v[136:139], v[124:127], v[12:27]
    ds_read_b128 v[140:143], v180 offset:23552
    ds_read_b32 v160, v181 offset:3072
    s_mov_b64 exec, s[48:49]
    ds_read_b128 v[164:167], v182 offset:25344
    ds_read_b128 v[168:171], v183 offset:25344
    s_mov_b64 exec, -1
    v_exp_f32 v62, v62
    v_exp_f32 v63, v63
    v_cvt_pk_bf16_f32 v116, v60, v61
    v_exp_f32 v64, v64
    v_exp_f32 v65, v65
    v_mfma_f32_32x32x16_bf16 v[28:43], v[136:139], v[128:131], v[28:43]
    v_cvt_pk_bf16_f32 v117, v62, v63
    v_exp_f32 v66, v66
    v_exp_f32 v67, v67
    v_cvt_pk_bf16_f32 v118, v64, v65
    v_exp_f32 v68, v68
    v_exp_f32 v69, v69
    v_mfma_f32_32x32x16_bf16 v[76:91], v[172:175], v[108:111], v[76:91]
    v_cvt_pk_bf16_f32 v119, v66, v67
    v_exp_f32 v70, v70
    v_exp_f32 v71, v71
    v_cvt_pk_bf16_f32 v120, v68, v69
    v_exp_f32 v72, v72
    v_exp_f32 v73, v73
    v_mfma_f32_32x32x16_bf16 v[76:91], v[176:179], v[112:115], v[76:91]
    v_cvt_pk_bf16_f32 v121, v70, v71
    v_exp_f32 v74, v74
    v_exp_f32 v75, v75
    v_cvt_pk_bf16_f32 v122, v72, v73
    v_cvt_pk_bf16_f32 v123, v74, v75
    v_exp_f32 v12, v12
    v_exp_f32 v13, v13
    v_mfma_f32_32x32x4_2b_bf16 v[44:75], v[162:163], v[132:133], 0 cbsz:1 abid:1
    v_exp_f32 v14, v14
    v_exp_f32 v15, v15
    v_cvt_pk_bf16_f32 v108, v12, v13
    v_exp_f32 v16, v16
    v_exp_f32 v17, v17
    v_cvt_pk_bf16_f32 v109, v14, v15
    v_exp_f32 v18, v18
    buffer_load_dwordx2 v[248:249], v197, s[20:23], 0 offen
    v_exp_f32 v19, v19
    v_cvt_pk_bf16_f32 v110, v16, v17
    v_exp_f32 v20, v20
    v_exp_f32 v21, v21
    v_mfma_f32_32x32x16_bf16 v[92:107], v[172:175], v[116:119], v[92:107]
    v_cvt_pk_bf16_f32 v111, v18, v19
    v_exp_f32 v22, v22
    buffer_load_dwordx2 v[250:251], v197, s[20:23], 0 offen offset:32
    v_exp_f32 v23, v23
    v_cvt_pk_bf16_f32 v112, v20, v21
    v_exp_f32 v24, v24
    v_exp_f32 v25, v25
    v_mfma_f32_32x32x16_bf16 v[92:107], v[176:179], v[120:123], v[92:107]
    v_cvt_pk_bf16_f32 v113, v22, v23
    v_exp_f32 v26, v26
    v_exp_f32 v27, v27
    v_cvt_pk_bf16_f32 v114, v24, v25
    v_cvt_pk_bf16_f32 v115, v26, v27
    s_waitcnt lgkmcnt(0)
    v_exp_f32 v28, v28
    v_exp_f32 v29, v29
    v_mfma_f32_32x32x16_bf16 v[44:59], v[140:143], v[124:127], v[44:59]
    ds_read_b128 v[136:139], v180 offset:24576
    s_mov_b64 exec, s[48:49]
    ds_read_b128 v[172:175], v182 offset:26496
    ds_read_b128 v[176:179], v183 offset:26496
    s_mov_b64 exec, -1
    v_exp_f32 v30, v30
    v_exp_f32 v31, v31
    v_cvt_pk_bf16_f32 v116, v28, v29
    v_exp_f32 v32, v32
    v_exp_f32 v33, v33
    v_mfma_f32_32x32x16_bf16 v[60:75], v[140:143], v[128:131], v[60:75]
    v_cvt_pk_bf16_f32 v117, v30, v31
    v_exp_f32 v34, v34
    v_exp_f32 v35, v35
    v_cvt_pk_bf16_f32 v118, v32, v33
    v_exp_f32 v36, v36
    v_exp_f32 v37, v37
    v_mfma_f32_32x32x16_bf16 v[76:91], v[164:167], v[108:111], v[76:91]
    v_cvt_pk_bf16_f32 v119, v34, v35
    v_exp_f32 v38, v38
    v_exp_f32 v39, v39
    v_cvt_pk_bf16_f32 v120, v36, v37
    v_exp_f32 v40, v40
    v_exp_f32 v41, v41
    v_mfma_f32_32x32x16_bf16 v[76:91], v[168:171], v[112:115], v[76:91]
    v_cvt_pk_bf16_f32 v121, v38, v39
    v_exp_f32 v42, v42
    v_exp_f32 v43, v43
    v_cvt_pk_bf16_f32 v122, v40, v41
    v_cvt_pk_bf16_f32 v123, v42, v43
    v_exp_f32 v44, v44
    v_exp_f32 v45, v45
    v_mfma_f32_32x32x4_2b_bf16 v[12:43], v[160:161], v[132:133], 0 cbsz:1 abid:0
    s_setprio 2
    v_exp_f32 v46, v46
    v_exp_f32 v47, v47
    v_cvt_pk_bf16_f32 v108, v44, v45
    v_exp_f32 v48, v48
    v_exp_f32 v49, v49
    v_cvt_pk_bf16_f32 v109, v46, v47
    v_exp_f32 v50, v50
    buffer_load_dwordx2 v[252:253], v198, s[20:23], 0 offen offset:1024
    v_exp_f32 v51, v51
    v_cvt_pk_bf16_f32 v110, v48, v49
    v_exp_f32 v52, v52
    v_exp_f32 v53, v53
    v_mfma_f32_32x32x16_bf16 v[92:107], v[164:167], v[116:119], v[92:107]
    v_cvt_pk_bf16_f32 v111, v50, v51
    v_exp_f32 v54, v54
    buffer_load_dword v254, v199, s[12:15], 0 offen sc1
    v_exp_f32 v55, v55
    v_cvt_pk_bf16_f32 v112, v52, v53
    v_exp_f32 v56, v56
    v_exp_f32 v57, v57
    v_mfma_f32_32x32x16_bf16 v[92:107], v[168:171], v[120:123], v[92:107]
    v_cvt_pk_bf16_f32 v113, v54, v55
    v_exp_f32 v58, v58
    v_exp_f32 v59, v59
    v_cvt_pk_bf16_f32 v114, v56, v57
    v_cvt_pk_bf16_f32 v115, v58, v59
    s_waitcnt lgkmcnt(0)
    v_exp_f32 v60, v60
    v_exp_f32 v61, v61
    v_mfma_f32_32x32x16_bf16 v[12:27], v[136:139], v[124:127], v[12:27]
    ds_read_b128 v[140:143], v180 offset:25600
    ds_read_b32 v162, v181 offset:3328
    s_mov_b64 exec, s[48:49]
    ds_read_b128 v[164:167], v182 offset:27648
    ds_read_b128 v[168:171], v183 offset:27648
    s_mov_b64 exec, -1
    v_exp_f32 v62, v62
    v_exp_f32 v63, v63
    v_cvt_pk_bf16_f32 v116, v60, v61
    v_exp_f32 v64, v64
    v_exp_f32 v65, v65
    v_mfma_f32_32x32x16_bf16 v[28:43], v[136:139], v[128:131], v[28:43]
    v_cvt_pk_bf16_f32 v117, v62, v63
    v_exp_f32 v66, v66
    v_exp_f32 v67, v67
    v_cvt_pk_bf16_f32 v118, v64, v65
    v_exp_f32 v68, v68
    v_exp_f32 v69, v69
    v_mfma_f32_32x32x16_bf16 v[76:91], v[172:175], v[108:111], v[76:91]
    v_cvt_pk_bf16_f32 v119, v66, v67
    v_exp_f32 v70, v70
    v_exp_f32 v71, v71
    v_cvt_pk_bf16_f32 v120, v68, v69
    v_exp_f32 v72, v72
    v_exp_f32 v73, v73
    v_mfma_f32_32x32x16_bf16 v[76:91], v[176:179], v[112:115], v[76:91]
    v_cvt_pk_bf16_f32 v121, v70, v71
    v_exp_f32 v74, v74
    v_exp_f32 v75, v75
    v_cvt_pk_bf16_f32 v122, v72, v73
    v_cvt_pk_bf16_f32 v123, v74, v75
    v_exp_f32 v12, v12
    v_exp_f32 v13, v13
    v_mfma_f32_32x32x4_2b_bf16 v[44:75], v[160:161], v[132:133], 0 cbsz:1 abid:1
    v_exp_f32 v14, v14
    v_exp_f32 v15, v15
    v_cvt_pk_bf16_f32 v108, v12, v13
    v_exp_f32 v16, v16
    v_exp_f32 v17, v17
    v_cvt_pk_bf16_f32 v109, v14, v15
    v_exp_f32 v18, v18
    v_exp_f32 v19, v19
    v_cvt_pk_bf16_f32 v110, v16, v17
    v_exp_f32 v20, v20
    v_exp_f32 v21, v21
    v_mfma_f32_32x32x16_bf16 v[92:107], v[172:175], v[116:119], v[92:107]
    v_cvt_pk_bf16_f32 v111, v18, v19
    v_exp_f32 v22, v22
    v_exp_f32 v23, v23
    v_cvt_pk_bf16_f32 v112, v20, v21
    v_exp_f32 v24, v24
    v_exp_f32 v25, v25
    v_mfma_f32_32x32x16_bf16 v[92:107], v[176:179], v[120:123], v[92:107]
    v_cvt_pk_bf16_f32 v113, v22, v23
    v_exp_f32 v26, v26
    v_exp_f32 v27, v27
    v_cvt_pk_bf16_f32 v114, v24, v25
    v_cvt_pk_bf16_f32 v115, v26, v27
    s_waitcnt lgkmcnt(0)
    v_exp_f32 v28, v28
    v_exp_f32 v29, v29
    v_mfma_f32_32x32x16_bf16 v[44:59], v[140:143], v[124:127], v[44:59]
    s_setprio 1
    ds_read_b128 v[136:139], v180 offset:26624
    s_mov_b64 exec, s[48:49]
    ds_read_b128 v[172:175], v182 offset:28800
    ds_read_b128 v[176:179], v183 offset:28800
    s_mov_b64 exec, -1
    v_exp_f32 v30, v30
    v_exp_f32 v31, v31
    v_cvt_pk_bf16_f32 v116, v28, v29
    v_exp_f32 v32, v32
    v_exp_f32 v33, v33
    v_mfma_f32_32x32x16_bf16 v[60:75], v[140:143], v[128:131], v[60:75]
    v_cvt_pk_bf16_f32 v117, v30, v31
    v_exp_f32 v34, v34
    v_exp_f32 v35, v35
    v_cvt_pk_bf16_f32 v118, v32, v33
    v_exp_f32 v36, v36
    v_exp_f32 v37, v37
    v_mfma_f32_32x32x16_bf16 v[76:91], v[164:167], v[108:111], v[76:91]
    v_cvt_pk_bf16_f32 v119, v34, v35
    v_exp_f32 v38, v38
    v_exp_f32 v39, v39
    v_cvt_pk_bf16_f32 v120, v36, v37
    v_exp_f32 v40, v40
    v_exp_f32 v41, v41
    v_mfma_f32_32x32x16_bf16 v[76:91], v[168:171], v[112:115], v[76:91]
    v_cvt_pk_bf16_f32 v121, v38, v39
    v_exp_f32 v42, v42
    v_exp_f32 v43, v43
    v_cvt_pk_bf16_f32 v122, v40, v41
    v_cvt_pk_bf16_f32 v123, v42, v43
    v_exp_f32 v44, v44
    v_exp_f32 v45, v45
    v_mfma_f32_32x32x4_2b_bf16 v[12:43], v[162:163], v[132:133], 0 cbsz:1 abid:0
    s_setprio 0
    v_exp_f32 v46, v46
    v_exp_f32 v47, v47
    v_cvt_pk_bf16_f32 v108, v44, v45
    v_exp_f32 v48, v48
    v_exp_f32 v49, v49
    v_cvt_pk_bf16_f32 v109, v46, v47
    v_exp_f32 v50, v50
    v_exp_f32 v51, v51
    v_cvt_pk_bf16_f32 v110, v48, v49
    v_exp_f32 v52, v52
    v_exp_f32 v53, v53
    v_mfma_f32_32x32x16_bf16 v[92:107], v[164:167], v[116:119], v[92:107]
    v_cvt_pk_bf16_f32 v111, v50, v51
    v_exp_f32 v54, v54
    v_exp_f32 v55, v55
    v_cvt_pk_bf16_f32 v112, v52, v53
    v_exp_f32 v56, v56
    v_exp_f32 v57, v57
    v_mfma_f32_32x32x16_bf16 v[92:107], v[168:171], v[120:123], v[92:107]
    v_cvt_pk_bf16_f32 v113, v54, v55
    v_exp_f32 v58, v58
    v_exp_f32 v59, v59
    v_cvt_pk_bf16_f32 v114, v56, v57
    v_cvt_pk_bf16_f32 v115, v58, v59
    s_waitcnt lgkmcnt(0)
    s_barrier
    v_exp_f32 v60, v60
    v_exp_f32 v61, v61
    v_mfma_f32_32x32x16_bf16 v[12:27], v[136:139], v[124:127], v[12:27]
    s_setprio 3
    ds_read_b128 v[140:143], v180 offset:27648
    ds_read_b32 v160, v181 offset:3584
    s_mov_b64 exec, s[48:49]
    ds_read_b128 v[164:167], v182 offset:29952
    ds_read_b128 v[168:171], v183 offset:29952
    s_mov_b64 exec, -1
    v_exp_f32 v62, v62
    v_exp_f32 v63, v63
    v_cvt_pk_bf16_f32 v116, v60, v61
    v_exp_f32 v64, v64
    v_exp_f32 v65, v65
    v_mfma_f32_32x32x16_bf16 v[28:43], v[136:139], v[128:131], v[28:43]
    v_cvt_pk_bf16_f32 v117, v62, v63
    v_exp_f32 v66, v66
    v_exp_f32 v67, v67
    v_cvt_pk_bf16_f32 v118, v64, v65
    v_exp_f32 v68, v68
    v_exp_f32 v69, v69
    v_mfma_f32_32x32x16_bf16 v[76:91], v[172:175], v[108:111], v[76:91]
    v_cvt_pk_bf16_f32 v119, v66, v67
    v_exp_f32 v70, v70
    v_exp_f32 v71, v71
    v_cvt_pk_bf16_f32 v120, v68, v69
    v_exp_f32 v72, v72
    v_exp_f32 v73, v73
    v_mfma_f32_32x32x16_bf16 v[76:91], v[176:179], v[112:115], v[76:91]
    v_cvt_pk_bf16_f32 v121, v70, v71
    v_exp_f32 v74, v74
    v_exp_f32 v75, v75
    v_cvt_pk_bf16_f32 v122, v72, v73
    v_cvt_pk_bf16_f32 v123, v74, v75
    v_exp_f32 v12, v12
    v_exp_f32 v13, v13
    v_mfma_f32_32x32x4_2b_bf16 v[44:75], v[162:163], v[132:133], 0 cbsz:1 abid:1
    v_exp_f32 v14, v14
    v_exp_f32 v15, v15
    v_cvt_pk_bf16_f32 v108, v12, v13
    v_exp_f32 v16, v16
    v_exp_f32 v17, v17
    v_cvt_pk_bf16_f32 v109, v14, v15
    v_exp_f32 v18, v18
    s_mov_b32 exec_hi, 0xff
    s_add_u32 m0, s66, 0
    s_mov_b32 s29, 0
    buffer_load_dwordx4 v186, s[16:19], s29 offen lds
    s_mov_b32 exec_hi, -1
    v_exp_f32 v19, v19
    v_cvt_pk_bf16_f32 v110, v16, v17
    v_exp_f32 v20, v20
    v_exp_f32 v21, v21
    v_mfma_f32_32x32x16_bf16 v[92:107], v[172:175], v[116:119], v[92:107]
    v_cvt_pk_bf16_f32 v111, v18, v19
    v_exp_f32 v22, v22
    s_mov_b32 exec_hi, 0xff
    s_add_u32 m0, s66, 640
    s_mov_b32 s29, 4608
    buffer_load_dwordx4 v186, s[16:19], s29 offen lds
    s_mov_b32 exec_hi, -1
    v_exp_f32 v23, v23
    v_cvt_pk_bf16_f32 v112, v20, v21
    v_exp_f32 v24, v24
    v_exp_f32 v25, v25
    v_mfma_f32_32x32x16_bf16 v[92:107], v[176:179], v[120:123], v[92:107]
    v_cvt_pk_bf16_f32 v113, v22, v23
    v_exp_f32 v26, v26
    v_exp_f32 v27, v27
    v_cvt_pk_bf16_f32 v114, v24, v25
    v_cvt_pk_bf16_f32 v115, v26, v27
    s_waitcnt lgkmcnt(0)
    v_exp_f32 v28, v28
    v_exp_f32 v29, v29
    v_mfma_f32_32x32x16_bf16 v[44:59], v[140:143], v[124:127], v[44:59]
    ds_read_b128 v[136:139], v180 offset:28672
    s_mov_b64 exec, s[48:49]
    ds_read_b128 v[172:175], v182 offset:31104
    ds_read_b128 v[176:179], v183 offset:31104
    s_mov_b64 exec, -1
    v_exp_f32 v30, v30
    v_exp_f32 v31, v31
    v_cvt_pk_bf16_f32 v116, v28, v29
    v_exp_f32 v32, v32
    v_exp_f32 v33, v33
    v_mfma_f32_32x32x16_bf16 v[60:75], v[140:143], v[128:131], v[60:75]
    v_cvt_pk_bf16_f32 v117, v30, v31
    v_exp_f32 v34, v34
    s_mov_b32 exec_hi, 0xff
    s_add_u32 m0, s66, 1280
    s_mov_b32 s29, 9216
    buffer_load_dwordx4 v186, s[16:19], s29 offen lds
    s_mov_b32 exec_hi, -1
    v_exp_f32 v35, v35
    v_cvt_pk_bf16_f32 v118, v32, v33
    v_exp_f32 v36, v36
    v_exp_f32 v37, v37
    v_mfma_f32_32x32x16_bf16 v[76:91], v[164:167], v[108:111], v[76:91]
    v_cvt_pk_bf16_f32 v119, v34, v35
    v_exp_f32 v38, v38
    s_mov_b32 exec_hi, 0xff
    s_add_u32 m0, s66, 1920
    s_mov_b32 s29, 13824
    buffer_load_dwordx4 v186, s[16:19], s29 offen lds
    s_mov_b32 exec_hi, -1
    v_exp_f32 v39, v39
    v_cvt_pk_bf16_f32 v120, v36, v37
    v_exp_f32 v40, v40
    v_exp_f32 v41, v41
    v_mfma_f32_32x32x16_bf16 v[76:91], v[168:171], v[112:115], v[76:91]
    v_cvt_pk_bf16_f32 v121, v38, v39
    v_exp_f32 v42, v42
    v_exp_f32 v43, v43
    v_cvt_pk_bf16_f32 v122, v40, v41
    v_cvt_pk_bf16_f32 v123, v42, v43
    v_exp_f32 v44, v44
    v_exp_f32 v45, v45
    v_mfma_f32_32x32x4_2b_bf16 v[12:43], v[160:161], v[132:133], 0 cbsz:1 abid:0
    v_exp_f32 v46, v46
    v_exp_f32 v47, v47
    v_cvt_pk_bf16_f32 v108, v44, v45
    v_exp_f32 v48, v48
    v_exp_f32 v49, v49
    v_cvt_pk_bf16_f32 v109, v46, v47
    v_exp_f32 v50, v50
    s_mov_b32 exec_hi, 0xff
    s_add_u32 m0, s67, 0
    s_mov_b32 s29, 18432
    buffer_load_dwordx4 v186, s[16:19], s29 offen lds
    s_mov_b32 exec_hi, -1
    v_exp_f32 v51, v51
    v_cvt_pk_bf16_f32 v110, v48, v49
    v_exp_f32 v52, v52
    v_exp_f32 v53, v53
    v_mfma_f32_32x32x16_bf16 v[92:107], v[164:167], v[116:119], v[92:107]
    v_cvt_pk_bf16_f32 v111, v50, v51
    v_exp_f32 v54, v54
    s_mov_b32 exec_hi, 0xff
    s_add_u32 m0, s66, 2560
    s_mov_b32 s29, 23040
    buffer_load_dwordx4 v186, s[16:19], s29 offen lds
    s_mov_b32 exec_hi, -1
    v_exp_f32 v55, v55
    v_cvt_pk_bf16_f32 v112, v52, v53
    v_exp_f32 v56, v56
    v_exp_f32 v57, v57
    v_mfma_f32_32x32x16_bf16 v[92:107], v[168:171], v[120:123], v[92:107]
    v_cvt_pk_bf16_f32 v113, v54, v55
    v_exp_f32 v58, v58
    v_exp_f32 v59, v59
    v_cvt_pk_bf16_f32 v114, v56, v57
    v_cvt_pk_bf16_f32 v115, v58, v59
    s_waitcnt lgkmcnt(0)
    v_exp_f32 v60, v60
    v_exp_f32 v61, v61
    v_mfma_f32_32x32x16_bf16 v[12:27], v[136:139], v[124:127], v[12:27]
    ds_read_b128 v[140:143], v180 offset:29696
    ds_read_b32 v162, v181 offset:3840
    s_mov_b64 exec, s[48:49]
    ds_read_b128 v[164:167], v182 offset:32256
    ds_read_b128 v[168:171], v183 offset:32256
    s_mov_b64 exec, -1
    v_exp_f32 v62, v62
    v_exp_f32 v63, v63
    v_cvt_pk_bf16_f32 v116, v60, v61
    v_exp_f32 v64, v64
    v_exp_f32 v65, v65
    v_mfma_f32_32x32x16_bf16 v[28:43], v[136:139], v[128:131], v[28:43]
    v_cvt_pk_bf16_f32 v117, v62, v63
    v_exp_f32 v66, v66
    s_mov_b32 exec_hi, 0xff
    s_add_u32 m0, s66, 3200
    s_mov_b32 s29, 27648
    buffer_load_dwordx4 v186, s[16:19], s29 offen lds
    s_mov_b32 exec_hi, -1
    v_exp_f32 v67, v67
    v_cvt_pk_bf16_f32 v118, v64, v65
    v_exp_f32 v68, v68
    v_exp_f32 v69, v69
    v_mfma_f32_32x32x16_bf16 v[76:91], v[172:175], v[108:111], v[76:91]
    v_cvt_pk_bf16_f32 v119, v66, v67
    v_exp_f32 v70, v70
    s_mov_b32 exec_hi, 0xff
    s_add_u32 m0, s66, 3840
    s_mov_b32 s29, 32256
    buffer_load_dwordx4 v186, s[16:19], s29 offen lds
    s_mov_b32 exec_hi, -1
    v_exp_f32 v71, v71
    v_cvt_pk_bf16_f32 v120, v68, v69
    v_exp_f32 v72, v72
    v_exp_f32 v73, v73
    v_mfma_f32_32x32x16_bf16 v[76:91], v[176:179], v[112:115], v[76:91]
    v_cvt_pk_bf16_f32 v121, v70, v71
    v_exp_f32 v74, v74
    v_exp_f32 v75, v75
    v_cvt_pk_bf16_f32 v122, v72, v73
    v_cvt_pk_bf16_f32 v123, v74, v75
    v_exp_f32 v12, v12
    v_exp_f32 v13, v13
    v_mfma_f32_32x32x4_2b_bf16 v[44:75], v[160:161], v[132:133], 0 cbsz:1 abid:1
    v_exp_f32 v14, v14
    v_exp_f32 v15, v15
    v_cvt_pk_bf16_f32 v108, v12, v13
    v_exp_f32 v16, v16
    v_exp_f32 v17, v17
    v_cvt_pk_bf16_f32 v109, v14, v15
    v_exp_f32 v18, v18
    s_mov_b32 exec_hi, 0xff
    s_add_u32 m0, s66, 4480
    s_mov_b32 s29, 36864
    buffer_load_dwordx4 v186, s[16:19], s29 offen lds
    s_mov_b32 exec_hi, -1
    v_exp_f32 v19, v19
    v_cvt_pk_bf16_f32 v110, v16, v17
    v_exp_f32 v20, v20
    v_exp_f32 v21, v21
    v_mfma_f32_32x32x16_bf16 v[92:107], v[172:175], v[116:119], v[92:107]
    v_cvt_pk_bf16_f32 v111, v18, v19
    v_exp_f32 v22, v22
    s_mov_b32 exec_hi, 0xff
    s_add_u32 m0, s66, 5120
    s_mov_b32 s29, 41472
    buffer_load_dwordx4 v186, s[16:19], s29 offen lds
    s_mov_b32 exec_hi, -1
    v_exp_f32 v23, v23
    v_cvt_pk_bf16_f32 v112, v20, v21
    v_exp_f32 v24, v24
    v_exp_f32 v25, v25
    v_mfma_f32_32x32x16_bf16 v[92:107], v[176:179], v[120:123], v[92:107]
    v_cvt_pk_bf16_f32 v113, v22, v23
    v_exp_f32 v26, v26
    v_exp_f32 v27, v27
    v_cvt_pk_bf16_f32 v114, v24, v25
    v_cvt_pk_bf16_f32 v115, v26, v27
    s_waitcnt lgkmcnt(0)
    v_exp_f32 v28, v28
    v_exp_f32 v29, v29
    v_mfma_f32_32x32x16_bf16 v[44:59], v[140:143], v[124:127], v[44:59]
    ds_read_b128 v[136:139], v180 offset:30720
    s_mov_b64 exec, s[48:49]
    ds_read_b128 v[172:175], v182 offset:33408
    ds_read_b128 v[176:179], v183 offset:33408
    s_mov_b64 exec, -1
    v_exp_f32 v30, v30
    v_exp_f32 v31, v31
    v_cvt_pk_bf16_f32 v116, v28, v29
    v_exp_f32 v32, v32
    v_exp_f32 v33, v33
    v_mfma_f32_32x32x16_bf16 v[60:75], v[140:143], v[128:131], v[60:75]
    v_cvt_pk_bf16_f32 v117, v30, v31
    v_exp_f32 v34, v34
    s_mov_b32 exec_hi, 0xff
    s_add_u32 m0, s66, 5760
    s_mov_b32 s29, 46080
    buffer_load_dwordx4 v186, s[16:19], s29 offen lds
    s_mov_b32 exec_hi, -1
    v_exp_f32 v35, v35
    v_cvt_pk_bf16_f32 v118, v32, v33
    v_exp_f32 v36, v36
    v_exp_f32 v37, v37
    v_mfma_f32_32x32x16_bf16 v[76:91], v[164:167], v[108:111], v[76:91]
    v_cvt_pk_bf16_f32 v119, v34, v35
    v_exp_f32 v38, v38
    s_mov_b32 exec_hi, 0xff
    s_add_u32 m0, s66, 6400
    s_mov_b32 s29, 50688
    buffer_load_dwordx4 v186, s[16:19], s29 offen lds
    s_mov_b32 exec_hi, -1
    v_exp_f32 v39, v39
    v_cvt_pk_bf16_f32 v120, v36, v37
    v_exp_f32 v40, v40
    v_exp_f32 v41, v41
    v_mfma_f32_32x32x16_bf16 v[76:91], v[168:171], v[112:115], v[76:91]
    v_cvt_pk_bf16_f32 v121, v38, v39
    v_exp_f32 v42, v42
    v_exp_f32 v43, v43
    v_cvt_pk_bf16_f32 v122, v40, v41
    v_cvt_pk_bf16_f32 v123, v42, v43
    v_exp_f32 v44, v44
    v_exp_f32 v45, v45
    v_mfma_f32_32x32x4_2b_bf16 v[12:43], v[162:163], v[132:133], 0 cbsz:1 abid:0
    s_setprio 2
    v_exp_f32 v46, v46
    v_exp_f32 v47, v47
    v_cvt_pk_bf16_f32 v108, v44, v45
    v_exp_f32 v48, v48
    v_exp_f32 v49, v49
    v_cvt_pk_bf16_f32 v109, v46, v47
    v_exp_f32 v50, v50
    s_mov_b32 exec_hi, 0xff
    s_add_u32 m0, s66, 7040
    s_mov_b32 s29, 55296
    buffer_load_dwordx4 v186, s[16:19], s29 offen lds
    s_mov_b32 exec_hi, -1
    v_exp_f32 v51, v51
    v_cvt_pk_bf16_f32 v110, v48, v49
    v_exp_f32 v52, v52
    v_exp_f32 v53, v53
    v_mfma_f32_32x32x16_bf16 v[92:107], v[164:167], v[116:119], v[92:107]
    v_cvt_pk_bf16_f32 v111, v50, v51
    v_exp_f32 v54, v54
    s_mov_b32 exec_hi, 0xff
    s_add_u32 m0, s67, 640
    s_mov_b32 s29, 59904
    buffer_load_dwordx4 v186, s[16:19], s29 offen lds
    s_mov_b32 exec_hi, -1
    v_exp_f32 v55, v55
    v_cvt_pk_bf16_f32 v112, v52, v53
    v_exp_f32 v56, v56
    v_exp_f32 v57, v57
    v_mfma_f32_32x32x16_bf16 v[92:107], v[168:171], v[120:123], v[92:107]
    v_cvt_pk_bf16_f32 v113, v54, v55
    v_exp_f32 v58, v58
    v_exp_f32 v59, v59
    v_cvt_pk_bf16_f32 v114, v56, v57
    v_cvt_pk_bf16_f32 v115, v58, v59
    s_waitcnt lgkmcnt(0)
    v_exp_f32 v60, v60
    v_exp_f32 v61, v61
    v_mfma_f32_32x32x16_bf16 v[12:27], v[136:139], v[124:127], v[12:27]
    ds_read_b128 v[140:143], v180 offset:31744
    s_mov_b64 exec, s[48:49]
    ds_read_b128 v[164:167], v182 offset:34560
    ds_read_b128 v[168:171], v183 offset:34560
    s_mov_b64 exec, -1
    v_exp_f32 v62, v62
    v_exp_f32 v63, v63
    v_cvt_pk_bf16_f32 v116, v60, v61
    v_exp_f32 v64, v64
    v_exp_f32 v65, v65
    v_mfma_f32_32x32x16_bf16 v[28:43], v[136:139], v[128:131], v[28:43]
    v_cvt_pk_bf16_f32 v117, v62, v63
    v_exp_f32 v66, v66
    s_mov_b32 exec_hi, 0xff
    s_add_u32 m0, s66, 7680
    s_mov_b32 s29, 64512
    buffer_load_dwordx4 v186, s[16:19], s29 offen lds
    s_mov_b32 exec_hi, -1
    v_exp_f32 v67, v67
    v_cvt_pk_bf16_f32 v118, v64, v65
    v_exp_f32 v68, v68
    v_exp_f32 v69, v69
    v_mfma_f32_32x32x16_bf16 v[76:91], v[172:175], v[108:111], v[76:91]
    v_cvt_pk_bf16_f32 v119, v66, v67
    v_exp_f32 v70, v70
    s_mov_b32 exec_hi, 0xff
    s_add_u32 m0, s66, 8320
    s_mov_b32 s29, 69120
    buffer_load_dwordx4 v186, s[16:19], s29 offen lds
    s_mov_b32 exec_hi, -1
    v_exp_f32 v71, v71
    v_cvt_pk_bf16_f32 v120, v68, v69
    v_exp_f32 v72, v72
    v_exp_f32 v73, v73
    v_mfma_f32_32x32x16_bf16 v[76:91], v[176:179], v[112:115], v[76:91]
    v_cvt_pk_bf16_f32 v121, v70, v71
    v_exp_f32 v74, v74
    v_exp_f32 v75, v75
    v_cvt_pk_bf16_f32 v122, v72, v73
    v_cvt_pk_bf16_f32 v123, v74, v75
    v_exp_f32 v12, v12
    v_exp_f32 v13, v13
    v_mfma_f32_32x32x4_2b_bf16 v[44:75], v[162:163], v[132:133], 0 cbsz:1 abid:1
    v_exp_f32 v14, v14
    v_exp_f32 v15, v15
    v_cvt_pk_bf16_f32 v108, v12, v13
    v_exp_f32 v16, v16
    v_exp_f32 v17, v17
    v_cvt_pk_bf16_f32 v109, v14, v15
    v_exp_f32 v18, v18
    s_mov_b32 exec_hi, 0xff
    s_add_u32 m0, s66, 8960
    s_mov_b32 s29, 73728
    buffer_load_dwordx4 v186, s[16:19], s29 offen lds
    s_mov_b32 exec_hi, -1
    v_exp_f32 v19, v19
    v_cvt_pk_bf16_f32 v110, v16, v17
    v_exp_f32 v20, v20
    v_exp_f32 v21, v21
    v_mfma_f32_32x32x16_bf16 v[92:107], v[172:175], v[116:119], v[92:107]
    v_cvt_pk_bf16_f32 v111, v18, v19
    v_exp_f32 v22, v22
    s_mov_b32 exec_hi, 0xff
    s_add_u32 m0, s66, 9600
    s_mov_b32 s29, 78336
    buffer_load_dwordx4 v186, s[16:19], s29 offen lds
    s_mov_b32 exec_hi, -1
    v_exp_f32 v23, v23
    v_cvt_pk_bf16_f32 v112, v20, v21
    v_exp_f32 v24, v24
    v_exp_f32 v25, v25
    v_mfma_f32_32x32x16_bf16 v[92:107], v[176:179], v[120:123], v[92:107]
    v_cvt_pk_bf16_f32 v113, v22, v23
    v_exp_f32 v26, v26
    v_exp_f32 v27, v27
    v_cvt_pk_bf16_f32 v114, v24, v25
    v_cvt_pk_bf16_f32 v115, v26, v27
    s_waitcnt lgkmcnt(0)
    v_exp_f32 v28, v28
    v_exp_f32 v29, v29
    v_mfma_f32_32x32x16_bf16 v[44:59], v[140:143], v[124:127], v[44:59]
    s_mov_b64 exec, s[48:49]
    ds_read_b128 v[172:175], v182 offset:35712
    ds_read_b128 v[176:179], v183 offset:35712
    s_mov_b64 exec, -1
    v_exp_f32 v30, v30
    v_exp_f32 v31, v31
    v_cvt_pk_bf16_f32 v116, v28, v29
    v_exp_f32 v32, v32
    v_exp_f32 v33, v33
    v_mfma_f32_32x32x16_bf16 v[60:75], v[140:143], v[128:131], v[60:75]
    v_cvt_pk_bf16_f32 v117, v30, v31
    v_exp_f32 v34, v34
    s_mul_i32 s29, s24, 288
    s_add_u32 m0, s29, 157696
    s_add_u32 s29, s29, 54534144
    s_mov_b64 exec, 0x3ffff
    buffer_load_dwordx4 v5, s[12:15], s29 offen sc1 lds
    s_mov_b64 exec, -1
    v_exp_f32 v35, v35
    v_cvt_pk_bf16_f32 v118, v32, v33
    v_exp_f32 v36, v36
    v_exp_f32 v37, v37
    v_mfma_f32_32x32x16_bf16 v[76:91], v[164:167], v[108:111], v[76:91]
    v_cvt_pk_bf16_f32 v119, v34, v35
    v_exp_f32 v38, v38
    v_exp_f32 v39, v39
    v_cvt_pk_bf16_f32 v120, v36, v37
    v_exp_f32 v40, v40
    v_exp_f32 v41, v41
    v_mfma_f32_32x32x16_bf16 v[76:91], v[168:171], v[112:115], v[76:91]
    v_cvt_pk_bf16_f32 v121, v38, v39
    v_exp_f32 v42, v42
    v_exp_f32 v43, v43
    v_cvt_pk_bf16_f32 v122, v40, v41
    v_cvt_pk_bf16_f32 v123, v42, v43
    v_mfma_f32_32x32x16_bf16 v[92:107], v[164:167], v[116:119], v[92:107]
    s_setprio 1
    v_exp_f32 v44, v44
    v_exp_f32 v45, v45
    v_exp_f32 v46, v46
    v_exp_f32 v47, v47
    v_cvt_pk_bf16_f32 v108, v44, v45
    v_exp_f32 v48, v48
    v_mfma_f32_32x32x16_bf16 v[92:107], v[168:171], v[120:123], v[92:107]
    v_exp_f32 v49, v49
    v_cvt_pk_bf16_f32 v109, v46, v47
    v_exp_f32 v50, v50
    v_exp_f32 v51, v51
    v_cvt_pk_bf16_f32 v110, v48, v49
    v_exp_f32 v52, v52
    v_exp_f32 v53, v53
    v_cvt_pk_bf16_f32 v111, v50, v51
    v_exp_f32 v54, v54
    v_exp_f32 v55, v55
    v_cvt_pk_bf16_f32 v112, v52, v53
    v_exp_f32 v56, v56
    v_exp_f32 v57, v57
    v_cvt_pk_bf16_f32 v113, v54, v55
    v_exp_f32 v58, v58
    v_exp_f32 v59, v59
    v_cvt_pk_bf16_f32 v114, v56, v57
    v_cvt_pk_bf16_f32 v115, v58, v59
    s_waitcnt lgkmcnt(0)
    v_mfma_f32_32x32x16_bf16 v[76:91], v[172:175], v[108:111], v[76:91]
    s_setprio 0
    v_exp_f32 v60, v60
    v_exp_f32 v61, v61
    v_exp_f32 v62, v62
    v_exp_f32 v63, v63
    v_cvt_pk_bf16_f32 v116, v60, v61
    v_exp_f32 v64, v64
    v_mfma_f32_32x32x16_bf16 v[76:91], v[176:179], v[112:115], v[76:91]
    v_exp_f32 v65, v65
    v_cvt_pk_bf16_f32 v117, v62, v63
    v_exp_f32 v66, v66
    v_exp_f32 v67, v67
    v_cvt_pk_bf16_f32 v118, v64, v65
    v_exp_f32 v68, v68
    v_exp_f32 v69, v69
    v_cvt_pk_bf16_f32 v119, v66, v67
    v_exp_f32 v70, v70
    v_exp_f32 v71, v71
    v_cvt_pk_bf16_f32 v120, v68, v69
    v_exp_f32 v72, v72
    v_exp_f32 v73, v73
    v_cvt_pk_bf16_f32 v121, v70, v71
    v_exp_f32 v74, v74
    v_exp_f32 v75, v75
    v_cvt_pk_bf16_f32 v122, v72, v73
    v_cvt_pk_bf16_f32 v123, v74, v75
    s_nop 1
    v_mfma_f32_32x32x16_bf16 v[92:107], v[172:175], v[116:119], v[92:107]
    v_mfma_f32_32x32x16_bf16 v[92:107], v[176:179], v[120:123], v[92:107]
LM_bend:
    v_maximum3_f32 v1, |v76|, |v77|, |v86|
    v_maximum3_f32 v1, |v78|, |v79|, v1
    v_maximum3_f32 v1, |v80|, |v81|, v1
    v_maximum3_f32 v1, |v82|, |v83|, v1
    v_maximum3_f32 v1, |v84|, |v85|, v1
    s_nop 6
    ds_write_b128 v200, v[92:95] offset:0
    ds_write_b128 v200, v[96:99] offset:1024
    ds_write_b128 v200, v[100:103] offset:2048
    v_maximum3_f32 v1, |v92|, |v93|, v1
    v_maximum3_f32 v1, |v94|, |v95|, v1
    v_maximum3_f32 v1, |v96|, |v97|, v1
    v_maximum3_f32 v1, |v98|, |v99|, v1
    v_maximum3_f32 v1, |v100|, |v101|, v1
    v_maximum3_f32 v1, |v102|, |v192|, v1
    v_cmp_ngt_f32 vcc, 0x71800000, v1
    s_nop 1
    s_or_b32 s29, vcc_lo, vcc_hi
    v_mov_b32 v1, s29
    ds_write_b32 v195, v1
    s_waitcnt vmcnt(0) lgkmcnt(0)
    s_barrier
    ds_read_b32 v187, v196
    ds_read_b128 v[12:15], v201 offset:0
    ds_read_b128 v[16:19], v201 offset:1024
    ds_read_b128 v[20:23], v201 offset:2048
    s_waitcnt lgkmcnt(0)
    v_cmp_ne_u32 vcc, 0, v187
    s_cmp_lg_u32 s32, 0
    s_cbranch_scc1 LM_bfin
    s_cbranch_vccnz LM_exact
LM_bfin:
    v_add_f32 v3, v86, v22
    v_rcp_f32 v3, v3
    v_pk_add_f32 v[12:13], v[76:77], v[12:13]
    v_pk_add_f32 v[14:15], v[78:79], v[14:15]
    v_pk_add_f32 v[16:17], v[80:81], v[16:17]
    v_pk_add_f32 v[18:19], v[82:83], v[18:19]
    v_pk_add_f32 v[20:21], v[84:85], v[20:21]
    v_mul_f32 v12, v3, v12
    v_mul_f32 v13, v3, v13
    v_mul_f32 v14, v3, v14
    v_mul_f32 v15, v3, v15
    v_mul_f32 v16, v3, v16
    v_mul_f32 v17, v3, v17
    v_mul_f32 v18, v3, v18
    v_mul_f32 v19, v3, v19
    v_mul_f32 v20, v3, v20
    v_mul_f32 v21, v3, v21
    v_cvt_pk_bf16_f32 v108, v12, v13
    v_cvt_pk_bf16_f32 v109, v14, v15
    v_cvt_pk_bf16_f32 v110, v16, v17
    v_cvt_pk_bf16_f32 v111, v18, v19
    v_cvt_pk_bf16_f32 v112, v20, v21
    buffer_store_dwordx4 v[108:111], v202, s[12:15], 0 offen sc1
    s_mov_b32 exec_hi, 0
    buffer_store_dword v112, v203, s[12:15], 0 offen sc1
    s_mov_b32 exec_hi, -1
    v_lshrrev_b32 v1, 5, v0
    v_lshlrev_b32 v1, 4, v1
    v_bfe_u32 v2, v0, 2, 3
    v_add_u32 v1, v1, v2
    v_mul_u32_u24 v1, 160, v1
    v_and_b32 v2, 3, v0
    v_lshl_add_u32 v1, v2, 3, v1
    s_lshl_b32 s29, s26, 15
    v_add_u32 v209, s29, v1
    s_mul_i32 s29, s26, 36864
    s_add_u32 s29, s29, 65536
    v_add_u32 v213, s29, v1
    s_mul_i32 s29, s26, 5120
    s_add_u32 s29, s29, 147456
    v_add_u32 v241, s29, v1
    s_lshl_b32 s30, s26, 6
    s_xor_b32 s29, s30, 64
    v_add_u32 v208, s30, v209
    v_add_u32 v210, s29, v209
    v_add_u32 v212, s30, v213
    v_add_u32 v214, s29, v213
    v_add_u32 v240, s30, v241
    v_add_u32 v242, s29, v241
    ds_read_b64_tr_b16 v[12:13], v208 offset:0
    ds_read_b64_tr_b16 v[14:15], v208 offset:1280
    ds_read_b64_tr_b16 v[16:17], v208 offset:32
    ds_read_b64_tr_b16 v[18:19], v208 offset:1312
    ds_read_b64_tr_b16 v[20:21], v209 offset:128
    ds_read_b64_tr_b16 v[22:23], v209 offset:1408
    ds_read_b64_tr_b16 v[24:25], v210 offset:0
    ds_read_b64_tr_b16 v[26:27], v210 offset:1280
    ds_read_b64_tr_b16 v[28:29], v210 offset:32
    ds_read_b64_tr_b16 v[30:31], v210 offset:1312
    ds_read_b64_tr_b16 v[32:33], v208 offset:5120
    ds_read_b64_tr_b16 v[34:35], v208 offset:6400
    ds_read_b64_tr_b16 v[36:37], v208 offset:5152
    ds_read_b64_tr_b16 v[38:39], v208 offset:6432
    ds_read_b64_tr_b16 v[40:41], v209 offset:5248
    ds_read_b64_tr_b16 v[42:43], v209 offset:6528
    ds_read_b64_tr_b16 v[44:45], v210 offset:5120
    ds_read_b64_tr_b16 v[46:47], v210 offset:6400
    ds_read_b64_tr_b16 v[48:49], v210 offset:5152
    ds_read_b64_tr_b16 v[50:51], v210 offset:6432
    ds_read_b64_tr_b16 v[52:53], v208 offset:10240
    ds_read_b64_tr_b16 v[54:55], v208 offset:11520
    ds_read_b64_tr_b16 v[56:57], v208 offset:10272
    ds_read_b64_tr_b16 v[58:59], v208 offset:11552
    ds_read_b64_tr_b16 v[60:61], v209 offset:10368
    ds_read_b64_tr_b16 v[62:63], v209 offset:11648
    ds_read_b64_tr_b16 v[64:65], v210 offset:10240
    ds_read_b64_tr_b16 v[66:67], v210 offset:11520
    ds_read_b64_tr_b16 v[68:69], v210 offset:10272
    ds_read_b64_tr_b16 v[70:71], v210 offset:11552
    ds_read_b64_tr_b16 v[72:73], v208 offset:15360
    ds_read_b64_tr_b16 v[74:75], v208 offset:16640
    ds_read_b64_tr_b16 v[76:77], v208 offset:15392
    ds_read_b64_tr_b16 v[78:79], v208 offset:16672
    ds_read_b64_tr_b16 v[80:81], v209 offset:15488
    ds_read_b64_tr_b16 v[82:83], v209 offset:16768
    ds_read_b64_tr_b16 v[84:85], v210 offset:15360
    ds_read_b64_tr_b16 v[86:87], v210 offset:16640
    ds_read_b64_tr_b16 v[88:89], v210 offset:15392
    ds_read_b64_tr_b16 v[90:91], v210 offset:16672
    ds_read_b64_tr_b16 v[92:93], v212 offset:0
    ds_read_b64_tr_b16 v[94:95], v212 offset:1280
    ds_read_b64_tr_b16 v[96:97], v212 offset:32
    ds_read_b64_tr_b16 v[98:99], v212 offset:1312
    ds_read_b64_tr_b16 v[100:101], v213 offset:128
    ds_read_b64_tr_b16 v[102:103], v213 offset:1408
    ds_read_b64_tr_b16 v[104:105], v214 offset:0
    ds_read_b64_tr_b16 v[106:107], v214 offset:1280
    ds_read_b64_tr_b16 v[108:109], v214 offset:32
    ds_read_b64_tr_b16 v[110:111], v214 offset:1312
    s_waitcnt vmcnt(0)
    s_barrier
    s_cmp_lg_u32 s24, 0
    s_cbranch_scc1 LM_p0
    s_add_u32 s29, s3, 163840
    v_mov_b32 v1, 1
    s_mov_b64 exec, 0xff
    buffer_atomic_add v1, v8, s[12:15], s29 offen sc1
    s_mov_b64 exec, -1
    LM_p0:
    ds_read_b64_tr_b16 v[112:113], v212 offset:5120
    ds_read_b64_tr_b16 v[114:115], v212 offset:6400
    ds_read_b64_tr_b16 v[116:117], v212 offset:5152
    ds_read_b64_tr_b16 v[118:119], v212 offset:6432
    ds_read_b64_tr_b16 v[120:121], v213 offset:5248
    ds_read_b64_tr_b16 v[122:123], v213 offset:6528
    ds_read_b64_tr_b16 v[124:125], v214 offset:5120
    ds_read_b64_tr_b16 v[126:127], v214 offset:6400
    ds_read_b64_tr_b16 v[128:129], v214 offset:5152
    ds_read_b64_tr_b16 v[130:131], v214 offset:6432
    ds_read_b64_tr_b16 v[132:133], v212 offset:10240
    ds_read_b64_tr_b16 v[134:135], v212 offset:11520
    ds_read_b64_tr_b16 v[136:137], v212 offset:10272
    ds_read_b64_tr_b16 v[138:139], v212 offset:11552
    ds_read_b64_tr_b16 v[140:141], v213 offset:10368
    ds_read_b64_tr_b16 v[142:143], v213 offset:11648
    ds_read_b64_tr_b16 v[144:145], v214 offset:10240
    ds_read_b64_tr_b16 v[146:147], v214 offset:11520
    ds_read_b64_tr_b16 v[148:149], v214 offset:10272
    ds_read_b64_tr_b16 v[150:151], v214 offset:11552
    ds_read_b64_tr_b16 v[152:153], v212 offset:15360
    ds_read_b64_tr_b16 v[154:155], v212 offset:16640
    ds_read_b64_tr_b16 v[156:157], v212 offset:15392
    ds_read_b64_tr_b16 v[158:159], v212 offset:16672
    ds_read_b64_tr_b16 v[160:161], v213 offset:15488
    ds_read_b64_tr_b16 v[162:163], v213 offset:16768
    ds_read_b64_tr_b16 v[164:165], v214 offset:15360
    ds_read_b64_tr_b16 v[166:167], v214 offset:16640
    ds_read_b64_tr_b16 v[168:169], v214 offset:15392
    ds_read_b64_tr_b16 v[170:171], v214 offset:16672
    v_lshlrev_b32 v4, 2, v6
    v_and_b32 v2, 1, v0
    v_mul_u32_u24 v2, 1152, v2
    v_lshl_add_u32 v2, v7, 4, v2
    s_lshl_b32 s29, s26, 9
    s_add_u32 s29, s29, 157696
    v_add_u32 v10, s29, v2
    s_add_u32 s29, s30, 158720
    v_add_u32 v255, s29, v2
    v_bfe_u32 v2, v0, 4, 1
    v_bfe_u32 v1, v0, 2, 3
    v_mul_u32_u24 v1, 9216, v1
    v_lshlrev_b32 v2, 1, v2
    v_and_b32 v3, 3, v0
    v_xor_b32 v2, v2, v3
    v_lshl_add_u32 v1, v2, 4, v1
    v_lshrrev_b32 v2, 5, v0
    v_lshl_add_u32 v9, v2, 6, v1
    s_cmp_eq_u32 s26, 0
    s_cselect_b32 s16, s40, s42
    s_cselect_b32 s17, s41, s43
    s_mov_b32 s18, 5308416
    s_lshr_b32 s29, s27, 2
    s_mul_i32 s29, s29, 1152
    s_and_b32 s30, s27, 3
    s_lshl_b32 s34, s27, 3
    s_add_u32 s34, s34, s24
    s_mul_i32 s34, s34, 4608
    s_add_u32 s34, s34, 51904512
    s_lshl_b32 s30, s30, 8
    s_add_u32 s29, s29, s30
    s_and_b32 s30, s28, 0
    s_lshl_b32 s30, s30, 7
    s_add_u32 s29, s29, s30
    s_lshl_b32 s59, s30, 1
    s_sub_u32 s59, 128, s59
    s_mul_i32 s32, s25, 73728
    s_add_u32 s32, s32, s29
    s_lshr_b32 s30, s25, 1
    s_mul_i32 s33, s30, 36864
    s_add_u32 s33, s33, s29
    s_and_b32 s30, s25, 1
    s_mul_i32 s30, s30, 147456
    s_add_u32 s33, s33, s30
    s_mul_i32 s35, s26, 24576
    s_lshl_b32 s29, s25, 10
    s_add_u32 s35, s35, s29
    s_cmp_lg_u32 s24, 0
    s_cbranch_scc1 LM_p1
    s_lshl_b32 s29, s50, 7
    s_add_u32 s29, s29, s3
    s_add_u32 s29, s29, 163840
    s_mov_b64 exec, 1
    LM_ap1:
    v_mov_b32 v1, 0
    s_sub_u32 s60, s60, 1
    buffer_atomic_or v1, v8, s[12:15], s29 offen sc0 sc1
    s_cmp_lt_i32 s60, 1
    s_waitcnt vmcnt(0)
    v_cmp_gt_u32 vcc, 32, v1
    s_cbranch_scc1 LM_aq1
    s_cbranch_vccnz LM_ap1
    LM_aq1:
    s_mov_b64 exec, -1
    LM_p1:
    s_waitcnt lgkmcnt(0)
    s_barrier
    ds_read_b128 v[232:235], v10
    ds_read_b128 v[236:239], v10 offset:64
    s_add_u32 s38, s4, 4096
    buffer_load_dwordx4 v[172:175], v5, s[12:15], s4 offen offset:0 sc1
    buffer_load_dwordx4 v[176:179], v5, s[12:15], s4 offen offset:1024 sc1
    buffer_load_dwordx4 v[180:183], v5, s[12:15], s4 offen offset:2048 sc1
    s_barrier
    buffer_load_dwordx4 v[184:187], v5, s[12:15], s4 offen offset:3072 sc1
    buffer_load_dwordx4 v[188:191], v5, s[12:15], s38 offen offset:0 sc1
    buffer_load_dwordx4 v[192:195], v5, s[12:15], s38 offen offset:1024 sc1
    s_barrier
    buffer_load_dwordx4 v[196:199], v5, s[12:15], s38 offen offset:2048 sc1
    buffer_load_dwordx4 v[200:203], v5, s[12:15], s38 offen offset:3072 sc1
    buffer_load_dword v204, v247, s[12:15], s5 offen offset:0 sc1
    buffer_load_dword v205, v247, s[12:15], s5 offen offset:64 sc1
    buffer_load_dword v206, v247, s[12:15], s5 offen offset:256 sc1
    buffer_load_dword v207, v247, s[12:15], s5 offen offset:320 sc1
    s_lshr_b32 s8, s27, 3
    s_lshl_b32 s8, s8, 10
    s_add_u32 s8, s8, 54538240
    s_cmp_lg_u32 s24, 0
    s_cbranch_scc1 LM_ps2
    v_mov_b32 v1, 1
    s_mov_b64 exec, 0xff
    buffer_atomic_add v1, v8, s[12:15], s8 offen sc1
    s_mov_b64 exec, -1
    LM_ps2:
    s_lshl_b32 s29, s24, 12
    s_add_u32 s29, s29, 98304
    v_add_u32 v2, s29, v5
    s_xor_b32 s29, s24, 4
    s_lshl_b32 s29, s29, 12
    s_add_u32 s29, s29, 98304
    v_add_u32 v3, s29, v5
    s_waitcnt vmcnt(11)
    s_waitcnt lgkmcnt(0)
    v_mfma_f32_16x16x32_bf16 v[228:231], v[232:235], v[172:175], 0
    v_mfma_f32_16x16x32_bf16 v[216:219], v[20:23], v[172:175], 0
    v_mfma_f32_16x16x32_bf16 v[220:223], v[24:27], v[172:175], 0
    v_mfma_f32_16x16x32_bf16 v[224:227], v[28:31], v[172:175], 0
    v_mfma_f32_16x16x32_bf16 v[208:211], v[12:15], v[172:175], 0
    v_mfma_f32_16x16x32_bf16 v[212:215], v[16:19], v[172:175], 0
    ds_read_b128 v[232:235], v10 offset:128
    ds_read_b64_tr_b16 v[12:13], v240 offset:0
    ds_read_b64_tr_b16 v[14:15], v240 offset:1280
    ds_read_b64_tr_b16 v[16:17], v240 offset:32
    ds_read_b64_tr_b16 v[18:19], v240 offset:1312
    ds_read_b64_tr_b16 v[20:21], v241 offset:128
    ds_read_b64_tr_b16 v[22:23], v241 offset:1408
    ds_read_b64_tr_b16 v[24:25], v242 offset:0
    ds_read_b64_tr_b16 v[26:27], v242 offset:1280
    ds_read_b64_tr_b16 v[28:29], v242 offset:32
    ds_read_b64_tr_b16 v[30:31], v242 offset:1312
    s_waitcnt vmcnt(10)
    s_waitcnt lgkmcnt(11)
    v_mfma_f32_16x16x32_bf16 v[228:231], v[236:239], v[176:179], v[228:231]
    v_mfma_f32_16x16x32_bf16 v[216:219], v[40:43], v[176:179], v[216:219]
    v_mfma_f32_16x16x32_bf16 v[220:223], v[44:47], v[176:179], v[220:223]
    v_mfma_f32_16x16x32_bf16 v[224:227], v[48:51], v[176:179], v[224:227]
    v_mfma_f32_16x16x32_bf16 v[208:211], v[32:35], v[176:179], v[208:211]
    v_mfma_f32_16x16x32_bf16 v[212:215], v[36:39], v[176:179], v[212:215]
    ds_read_b128 v[236:239], v10 offset:192
    s_waitcnt vmcnt(9)
    s_waitcnt lgkmcnt(1)
    v_mfma_f32_16x16x32_bf16 v[228:231], v[232:235], v[180:183], v[228:231]
    v_mfma_f32_16x16x32_bf16 v[216:219], v[60:63], v[180:183], v[216:219]
    v_mfma_f32_16x16x32_bf16 v[220:223], v[64:67], v[180:183], v[220:223]
    v_mfma_f32_16x16x32_bf16 v[224:227], v[68:71], v[180:183], v[224:227]
    v_mfma_f32_16x16x32_bf16 v[208:211], v[52:55], v[180:183], v[208:211]
    v_mfma_f32_16x16x32_bf16 v[212:215], v[56:59], v[180:183], v[212:215]
    ds_read_b128 v[232:235], v10 offset:256
    s_waitcnt vmcnt(8)
    s_waitcnt lgkmcnt(1)
    v_mfma_f32_16x16x32_bf16 v[228:231], v[236:239], v[184:187], v[228:231]
    v_mfma_f32_16x16x32_bf16 v[216:219], v[80:83], v[184:187], v[216:219]
    v_mfma_f32_16x16x32_bf16 v[220:223], v[84:87], v[184:187], v[220:223]
    v_mfma_f32_16x16x32_bf16 v[224:227], v[88:91], v[184:187], v[224:227]
    v_mfma_f32_16x16x32_bf16 v[208:211], v[72:75], v[184:187], v[208:211]
    v_mfma_f32_16x16x32_bf16 v[212:215], v[76:79], v[184:187], v[212:215]
    ds_read_b128 v[236:239], v10 offset:320
    s_add_u32 m0, s35, 0
    s_add_u32 s29, s32, 0
    buffer_load_dwordx4 v9, s[16:19], s29 offen lds
    s_waitcnt vmcnt(8)
    s_waitcnt lgkmcnt(1)
    v_mfma_f32_16x16x32_bf16 v[228:231], v[232:235], v[188:191], v[228:231]
    v_mfma_f32_16x16x32_bf16 v[216:219], v[100:103], v[188:191], v[216:219]
    v_mfma_f32_16x16x32_bf16 v[220:223], v[104:107], v[188:191], v[220:223]
    v_mfma_f32_16x16x32_bf16 v[224:227], v[108:111], v[188:191], v[224:227]
    v_mfma_f32_16x16x32_bf16 v[208:211], v[92:95], v[188:191], v[208:211]
    v_mfma_f32_16x16x32_bf16 v[212:215], v[96:99], v[188:191], v[212:215]
    ds_read_b128 v[232:235], v10 offset:384
    s_add_u32 m0, s35, 4096
    s_add_u32 s29, s32, 294912
    buffer_load_dwordx4 v9, s[16:19], s29 offen lds
    s_waitcnt vmcnt(8)
    s_waitcnt lgkmcnt(1)
    v_mfma_f32_16x16x32_bf16 v[228:231], v[236:239], v[192:195], v[228:231]
    v_mfma_f32_16x16x32_bf16 v[216:219], v[120:123], v[192:195], v[216:219]
    v_mfma_f32_16x16x32_bf16 v[220:223], v[124:127], v[192:195], v[220:223]
    v_mfma_f32_16x16x32_bf16 v[224:227], v[128:131], v[192:195], v[224:227]
    v_mfma_f32_16x16x32_bf16 v[208:211], v[112:115], v[192:195], v[208:211]
    v_mfma_f32_16x16x32_bf16 v[212:215], v[116:119], v[192:195], v[212:215]
    ds_read_b128 v[236:239], v10 offset:448
    s_add_u32 m0, s35, 8192
    s_add_u32 s29, s32, 589824
    buffer_load_dwordx4 v9, s[16:19], s29 offen lds
    s_waitcnt vmcnt(8)
    s_waitcnt lgkmcnt(1)
    v_mfma_f32_16x16x32_bf16 v[228:231], v[232:235], v[196:199], v[228:231]
    v_mfma_f32_16x16x32_bf16 v[216:219], v[140:143], v[196:199], v[216:219]
    v_mfma_f32_16x16x32_bf16 v[220:223], v[144:147], v[196:199], v[220:223]
    v_mfma_f32_16x16x32_bf16 v[224:227], v[148:151], v[196:199], v[224:227]
    v_mfma_f32_16x16x32_bf16 v[208:211], v[132:135], v[196:199], v[208:211]
    v_mfma_f32_16x16x32_bf16 v[212:215], v[136:139], v[196:199], v[212:215]
    ds_read_b128 v[232:235], v255
    s_add_u32 m0, s35, 12288
    s_add_u32 s29, s32, 884736
    buffer_load_dwordx4 v9, s[16:19], s29 offen lds
    s_waitcnt vmcnt(8)
    s_waitcnt lgkmcnt(1)
    v_mfma_f32_16x16x32_bf16 v[228:231], v[236:239], v[200:203], v[228:231]
    v_mfma_f32_16x16x32_bf16 v[216:219], v[160:163], v[200:203], v[216:219]
    v_mfma_f32_16x16x32_bf16 v[220:223], v[164:167], v[200:203], v[220:223]
    v_mfma_f32_16x16x32_bf16 v[224:227], v[168:171], v[200:203], v[224:227]
    v_mfma_f32_16x16x32_bf16 v[208:211], v[152:155], v[200:203], v[208:211]
    v_mfma_f32_16x16x32_bf16 v[212:215], v[156:159], v[200:203], v[212:215]
    s_add_u32 m0, s35, 16384
    s_add_u32 s29, s32, 1179648
    buffer_load_dwordx4 v9, s[16:19], s29 offen lds
    s_waitcnt vmcnt(5)
    s_waitcnt lgkmcnt(0)
    v_mfma_f32_16x16x32_bf16 v[228:231], v[232:235], v[204:207], v[228:231]
    v_mfma_f32_16x16x32_bf16 v[216:219], v[20:23], v[204:207], v[216:219]
    v_mfma_f32_16x16x32_bf16 v[220:223], v[24:27], v[204:207], v[220:223]
    v_mfma_f32_16x16x32_bf16 v[224:227], v[28:31], v[204:207], v[224:227]
    v_mfma_f32_16x16x32_bf16 v[208:211], v[12:15], v[204:207], v[208:211]
    v_mfma_f32_16x16x32_bf16 v[212:215], v[16:19], v[204:207], v[212:215]
    s_add_u32 m0, s35, 20480
    s_add_u32 s29, s32, 1474560
    buffer_load_dwordx4 v9, s[16:19], s29 offen lds
    s_nop 2
    ds_write_b128 v2, v[228:231]
    v_lshlrev_b32 v172, 16, v248
    v_and_b32 v173, 0xffff0000, v248
    v_lshlrev_b32 v174, 16, v249
    v_and_b32 v175, 0xffff0000, v249
    ds_write_b128 v2, v[216:219] offset:1024
    ds_write_b128 v2, v[220:223] offset:2048
    ds_write_b128 v2, v[224:227] offset:3072
    v_lshlrev_b32 v176, 16, v250
    v_and_b32 v177, 0xffff0000, v250
    v_lshlrev_b32 v178, 16, v251
    v_and_b32 v179, 0xffff0000, v251
    v_lshlrev_b32 v180, 16, v252
    v_and_b32 v181, 0xffff0000, v252
    v_lshlrev_b32 v182, 16, v253
    v_and_b32 v183, 0xffff0000, v253
    v_pk_add_f32 v[208:209], v[208:209], v[172:173]
    v_pk_add_f32 v[210:211], v[210:211], v[174:175]
    v_pk_add_f32 v[212:213], v[212:213], v[176:177]
    v_pk_add_f32 v[214:215], v[214:215], v[178:179]
    v_add_f32 v200, v228, v229
    v_add_f32 v200, v200, v254
    s_waitcnt lgkmcnt(0)
    s_barrier
    ds_read_b128 v[184:187], v3 offset:0
    ds_read_b128 v[192:195], v3 offset:2048
    ds_read_b128 v[196:199], v3 offset:3072
    ds_read_b128 v[188:191], v3 offset:1024
    v_pk_add_f32 v[216:217], v[216:217], v[180:181]
    v_pk_add_f32 v[218:219], v[218:219], v[182:183]
    s_waitcnt lgkmcnt(3)
    v_add_f32 v201, v184, v185
    v_add_f32 v200, v200, v201
    v_cvt_pk_bf16_f32 v202, -v200, -v200
    v_lshlrev_b32 v202, 16, v202
    v_mov_b32 v203, v202
    s_waitcnt lgkmcnt(1)
    v_pk_add_f32 v[208:209], v[208:209], v[192:193]
    v_pk_add_f32 v[210:211], v[210:211], v[194:195]
    v_cvt_pk_bf16_f32 v240, v208, v209
    v_cvt_pk_bf16_f32 v241, v210, v211
    v_lshlrev_b32 v208, 16, v240
    v_and_b32 v209, 0xffff0000, v240
    v_lshlrev_b32 v210, 16, v241
    v_and_b32 v211, 0xffff0000, v241
    v_pk_add_f32 v[208:209], v[208:209], v[202:203]
    v_pk_add_f32 v[210:211], v[210:211], v[202:203]
    v_cvt_pk_bf16_f32 v20, v208, v209
    v_cvt_pk_bf16_f32 v21, v210, v211
    v_pk_add_f32 v[212:213], v[212:213], v[196:197]
    v_pk_add_f32 v[214:215], v[214:215], v[198:199]
    v_cvt_pk_bf16_f32 v242, v212, v213
    v_cvt_pk_bf16_f32 v243, v214, v215
    v_lshlrev_b32 v212, 16, v242
    v_and_b32 v213, 0xffff0000, v242
    v_lshlrev_b32 v214, 16, v243
    v_and_b32 v215, 0xffff0000, v243
    v_pk_add_f32 v[212:213], v[212:213], v[202:203]
    v_pk_add_f32 v[214:215], v[214:215], v[202:203]
    v_cvt_pk_bf16_f32 v22, v212, v213
    v_cvt_pk_bf16_f32 v23, v214, v215
    buffer_store_dwordx4 v[20:23], v5, s[12:15], s9 offen sc1
    v_mov_b32 v204, 0
    v_mov_b32 v205, 0
    s_mov_b32 s29, 0xc1000000
    s_cmp_lg_u32 s69, 0
    s_waitcnt lgkmcnt(0)
    s_cbranch_scc1 LM_c2
    v_pk_add_f32 v[216:217], v[216:217], v[188:189]
    v_pk_add_f32 v[218:219], v[218:219], v[190:191]
    v_cvt_pk_bf16_f32 v244, v216, v217
    v_cvt_pk_bf16_f32 v245, v218, v219
    v_lshlrev_b32 v216, 16, v244
    v_and_b32 v217, 0xffff0000, v244
    v_lshlrev_b32 v218, 16, v245
    v_and_b32 v219, 0xffff0000, v245
    v_pk_add_f32 v[216:217], v[216:217], v[202:203]
    v_pk_add_f32 v[218:219], v[218:219], v[202:203]
    v_cvt_pk_bf16_f32 v24, v216, v217
    v_cvt_pk_bf16_f32 v25, v218, v219
    v_mov_b32 v26, v24
    v_mov_b32 v27, v25
    v_lshlrev_b32 v1, 7, v7
    v_lshl_add_u32 v1, v6, 4, v1
    v_permlane16_swap_b32 v24, v26
    v_permlane16_swap_b32 v25, v27
    s_mov_b32 exec_lo, 0xffff
    s_mov_b32 exec_hi, 0xffff
    buffer_store_dwordx4 v[24:27], v1, s[12:15], s65 offen sc1
    s_mov_b64 exec, -1
    v_pk_fma_f32 v[204:205], v[216:217], v[216:217], v[204:205]
    v_pk_fma_f32 v[204:205], v[218:219], v[218:219], v[204:205]
    s_mov_b32 s29, 0xc1400000
LM_c2:
    v_pk_fma_f32 v[204:205], v[208:209], v[208:209], v[204:205]
    v_pk_fma_f32 v[204:205], v[210:211], v[210:211], v[204:205]
    v_pk_fma_f32 v[204:205], v[212:213], v[212:213], v[204:205]
    v_pk_fma_f32 v[204:205], v[214:215], v[214:215], v[204:205]
    v_add_f32 v200, v200, v202
    v_mul_f32 v200, v200, v200
    v_add_f32 v204, v204, v205
    v_fmac_f32 v204, s29, v200
    v_mov_b32 v1, v204
    s_add_u32 s56, s9, 2359296
    s_add_u32 s57, s65, 2359296
    v_permlane32_swap_b32 v1, v204
    s_nop 1
    v_add_f32 v204, v204, v1
    v_mov_b32 v1, v204
    s_nop 1
    v_permlane16_swap_b32 v1, v204
    s_nop 1
    v_add_f32 v246, v204, v1
    s_waitcnt vmcnt(0)
    s_barrier
    s_cmp_lg_u32 s24, 0
    s_cbranch_scc1 LM_p2
    s_add_u32 s29, s3, 32768
    v_mov_b32 v1, 1
    s_mov_b64 exec, 0xff
    buffer_atomic_add v1, v8, s[12:15], s29 offen sc1
    s_mov_b64 exec, -1
    LM_p2:
    buffer_store_dwordx4 v[240:243], v5, s[12:15], s56 offen sc1
    s_mov_b64 exec, 0xffff
    buffer_store_dword v246, v4, s[12:15], s68 offen sc1
    s_mov_b64 exec, -1
    s_cmp_lg_u32 s69, 0
    s_cbranch_scc1 LM_c3
    buffer_store_dwordx2 v[244:245], v11, s[12:15], s57 offen sc1
    LM_c3:
    s_add_u32 m0, s35, 49152
    s_add_u32 s29, s32, 1769472
    buffer_load_dwordx4 v9, s[16:19], s29 offen lds
    s_add_u32 m0, s35, 53248
    s_add_u32 s29, s32, 2064384
    buffer_load_dwordx4 v9, s[16:19], s29 offen lds
    s_add_u32 m0, s35, 57344
    s_add_u32 s29, s32, 2359296
    buffer_load_dwordx4 v9, s[16:19], s29 offen lds
    s_add_u32 m0, s35, 61440
    s_add_u32 s29, s32, 2654208
    buffer_load_dwordx4 v9, s[16:19], s29 offen lds
    s_add_u32 m0, s35, 65536
    s_add_u32 s29, s32, 2949120
    buffer_load_dwordx4 v9, s[16:19], s29 offen lds
    s_add_u32 m0, s35, 69632
    s_add_u32 s29, s32, 3244032
    buffer_load_dwordx4 v9, s[16:19], s29 offen lds
    s_lshl_b32 s29, s28, 3
    s_add_u32 s29, s29, s24
    s_mul_i32 s53, s29, 36864
    s_add_u32 s53, s53, 11796480
    s_add_u32 s6, s53, 18432
    s_mul_i32 s61, s29, 294912
    s_add_u32 s61, s61, 16777216
    s_lshr_b32 s29, s27, 3
    s_mul_i32 s29, s29, 36864
    s_add_u32 s61, s61, s29
    s_lshl_b32 s29, s50, 9
    s_add_u32 s62, s61, s29
    s_add_u32 s62, s62, 32768
    s_lshl_b32 s29, s50, 11
    s_add_u32 s61, s61, s29
    s_lshl_b32 s37, s50, 7
    s_add_u32 s37, s37, s3
    s_add_u32 s37, s37, 32768
    v_lshl_add_u32 v12, v7, 8, v4
    v_lshrrev_b32 v1, 5, v0
    v_lshlrev_b32 v1, 10, v1
    v_bfe_u32 v2, v0, 2, 3
    v_lshl_add_u32 v1, v2, 6, v1
    v_and_b32 v2, 3, v0
    v_lshl_add_u32 v1, v2, 3, v1
    v_bfe_u32 v2, v0, 4, 1
    v_lshl_add_u32 v14, v2, 5, v1
    v_xor_b32 v15, 32, v14
    v_mul_u32_u24 v2, 36864, v2
    v_add_u32 v10, v9, v2
    ds_read_b64_tr_b16 v[80:81], v14 offset:0
    ds_read_b64_tr_b16 v[82:83], v14 offset:2048
    ds_read_b64_tr_b16 v[84:85], v14 offset:4096
    ds_read_b64_tr_b16 v[86:87], v14 offset:6144
    ds_read_b64_tr_b16 v[88:89], v14 offset:24576
    ds_read_b64_tr_b16 v[90:91], v14 offset:26624
    ds_read_b64_tr_b16 v[92:93], v14 offset:28672
    ds_read_b64_tr_b16 v[94:95], v14 offset:30720
    ds_read_b64_tr_b16 v[96:97], v15 offset:0
    ds_read_b64_tr_b16 v[98:99], v15 offset:2048
    ds_read_b64_tr_b16 v[100:101], v15 offset:4096
    ds_read_b64_tr_b16 v[102:103], v15 offset:6144
    s_cmp_lg_u32 s24, 0
    s_cbranch_scc1 LM_p3
    s_mov_b64 exec, 1
    LM_ap3:
    v_mov_b32 v1, 0
    s_sub_u32 s60, s60, 1
    buffer_atomic_or v1, v8, s[12:15], s37 offen sc0 sc1
    s_cmp_lt_i32 s60, 1
    s_waitcnt vmcnt(0)
    v_cmp_gt_u32 vcc, 32, v1
    s_cbranch_scc1 LM_aq3
    s_cbranch_vccnz LM_ap3
    LM_aq3:
    s_mov_b64 exec, -1
    LM_p3:
    s_barrier
    buffer_load_dwordx4 v[112:115], v5, s[12:15], s53 offen offset:0 sc1
    buffer_load_dwordx4 v[116:119], v5, s[12:15], s53 offen offset:1024 sc1
    buffer_load_dwordx4 v[184:187], v5, s[12:15], s6 offen offset:0 sc1
    buffer_load_dwordx4 v[188:191], v5, s[12:15], s6 offen offset:1024 sc1
    s_lshr_b32 s48, s27, 3
    s_and_b32 s50, s27, 3
    s_mul_i32 s58, s48, 1327104
    s_add_u32 s58, s58, 46137344
    s_mul_i32 s54, s50, 331776
    s_add_u32 s54, s54, s58
    s_mul_i32 s55, s24, 4608
    s_lshl_b32 s59, s24, 9
    s_add_u32 s29, s64, s24
    s_mul_i32 s29, s29, 5184
    s_add_u32 s58, s58, s29
    s_lshl_b32 s49, s28, 1
    s_bfe_u32 s29, s27, 0x10002
    s_add_u32 s49, s49, s29
    s_lshl_b32 s49, s49, 2
    s_add_u32 s49, s49, s25
    s_lshl_b32 s49, s49, 1
    s_add_u32 s49, s49, s26
    s_lshl_b32 s36, s49, 10
    s_add_u32 s36, s36, 16515072
    s_mul_i32 s29, s48, 36
    s_lshl_b32 s30, s26, 1
    s_add_u32 s29, s29, s30
    s_lshl_b32 s29, s29, 10
    s_add_u32 s29, s29, 16777216
    s_mul_i32 s38, s49, 147456
    s_add_u32 s38, s38, s29
    s_xor_b32 s30, s49, 1
    s_mul_i32 s39, s30, 147456
    s_add_u32 s39, s39, s29
    s_mul_i32 s29, s49, 18
    s_lshl_b32 s30, s50, 2
    s_add_u32 s51, s29, s30
    s_add_u32 s51, s51, s48
    s_lshl_b32 s51, s51, 10
    s_add_u32 s51, s51, 14155776
    s_lshl_b32 s52, s29, 10
    s_lshl_b32 s30, s50, 9
    s_add_u32 s52, s52, s30
    s_add_u32 s52, s52, 14172160
    s_lshl_b32 s66, s48, 10
    s_add_u32 s66, s66, s3
    s_add_u32 s67, s66, 131072
    s_add_u32 s66, s66, 98304
    s_add_u32 s65, s3, 65536
    s_lshl_b32 s63, s28, 3
    s_and_b32 s29, s27, 7
    s_add_u32 s63, s63, s29
    s_mul_i32 s63, s63, 147456
    s_and_b32 s29, s49, 7
    s_mul_i32 s29, s29, 4608
    s_add_u32 s63, s63, s29
    s_add_u32 s63, s63, 35651584
    s_mul_i32 s43, s48, 36864
    s_add_u32 s43, s43, s63
    s_add_u32 s29, s48, 1
    s_and_b32 s29, s29, 3
    s_lshl_b32 s40, s29, 10
    s_lshl_b32 s4, s29, 12
    s_add_u32 s40, s40, s43
    s_add_u32 s29, s48, 2
    s_and_b32 s29, s29, 3
    s_lshl_b32 s41, s29, 10
    s_lshl_b32 s5, s29, 12
    s_add_u32 s41, s41, s43
    s_add_u32 s29, s48, 3
    s_and_b32 s29, s29, 3
    s_lshl_b32 s42, s29, 10
    s_lshl_b32 s9, s29, 12
    s_add_u32 s42, s42, s43
    s_add_u32 s43, s43, 4096
    s_mul_i32 s44, s24, 7168
    s_add_u32 s44, s44, 73728
    s_xor_b32 s45, s24, 4
    s_mul_i32 s45, s45, 7168
    s_add_u32 s45, s45, 73728
    s_waitcnt vmcnt(0)
    buffer_load_dwordx4 v[120:123], v5, s[12:15], s53 offen offset:2048 sc1
    buffer_load_dwordx4 v[124:127], v5, s[12:15], s53 offen offset:3072 sc1
    s_add_u32 s53, s53, 4096
    buffer_load_dwordx4 v[192:195], v5, s[12:15], s6 offen offset:2048 sc1
    buffer_load_dwordx4 v[196:199], v5, s[12:15], s6 offen offset:3072 sc1
    s_add_u32 s6, s6, 4096
    s_waitcnt vmcnt(4)
    s_waitcnt lgkmcnt(8)
    v_mfma_f32_16x16x32_bf16 v[16:19], v[80:83], v[112:115], 0
    s_setprio 3
    ds_read_b64_tr_b16 v[104:105], v15 offset:24576
    buffer_load_dwordx4 v[128:131], v5, s[12:15], s53 offen offset:0 sc1
    v_mfma_f32_16x16x32_bf16 v[16:19], v[84:87], v[116:119], v[16:19]
    ds_read_b64_tr_b16 v[106:107], v15 offset:26624
    v_mfma_f32_16x16x32_bf16 v[48:51], v[80:83], v[184:187], 0
    ds_read_b64_tr_b16 v[108:109], v15 offset:28672
    v_mfma_f32_16x16x32_bf16 v[48:51], v[84:87], v[188:191], v[48:51]
    ds_read_b64_tr_b16 v[110:111], v15 offset:30720
    s_waitcnt lgkmcnt(8)
    v_mfma_f32_16x16x32_bf16 v[20:23], v[88:91], v[112:115], 0
    ds_read_b64_tr_b16 v[80:81], v14 offset:512
    buffer_load_dwordx4 v[132:135], v5, s[12:15], s53 offen offset:1024 sc1
    v_mfma_f32_16x16x32_bf16 v[20:23], v[92:95], v[116:119], v[20:23]
    ds_read_b64_tr_b16 v[82:83], v14 offset:2560
    v_mfma_f32_16x16x32_bf16 v[52:55], v[88:91], v[184:187], 0
    ds_read_b64_tr_b16 v[84:85], v14 offset:4608
    v_mfma_f32_16x16x32_bf16 v[52:55], v[92:95], v[188:191], v[52:55]
    ds_read_b64_tr_b16 v[86:87], v14 offset:6656
    s_waitcnt lgkmcnt(8)
    v_mfma_f32_16x16x32_bf16 v[24:27], v[96:99], v[112:115], 0
    ds_read_b64_tr_b16 v[88:89], v14 offset:25088
    v_mfma_f32_16x16x32_bf16 v[24:27], v[100:103], v[116:119], v[24:27]
    ds_read_b64_tr_b16 v[90:91], v14 offset:27136
    v_mfma_f32_16x16x32_bf16 v[56:59], v[96:99], v[184:187], 0
    ds_read_b64_tr_b16 v[92:93], v14 offset:29184
    v_mfma_f32_16x16x32_bf16 v[56:59], v[100:103], v[188:191], v[56:59]
    ds_read_b64_tr_b16 v[94:95], v14 offset:31232
    s_waitcnt lgkmcnt(8)
    v_mfma_f32_16x16x32_bf16 v[28:31], v[104:107], v[112:115], 0
    ds_read_b64_tr_b16 v[96:97], v15 offset:512
    buffer_load_dwordx4 v[200:203], v5, s[12:15], s6 offen offset:0 sc1
    v_mfma_f32_16x16x32_bf16 v[28:31], v[108:111], v[116:119], v[28:31]
    ds_read_b64_tr_b16 v[98:99], v15 offset:2560
    v_mfma_f32_16x16x32_bf16 v[60:63], v[104:107], v[184:187], 0
    ds_read_b64_tr_b16 v[100:101], v15 offset:4608
    v_mfma_f32_16x16x32_bf16 v[60:63], v[108:111], v[188:191], v[60:63]
    ds_read_b64_tr_b16 v[102:103], v15 offset:6656
    s_waitcnt lgkmcnt(8)
    v_mfma_f32_16x16x32_bf16 v[32:35], v[80:83], v[112:115], 0
    ds_read_b64_tr_b16 v[104:105], v15 offset:25088
    v_mfma_f32_16x16x32_bf16 v[32:35], v[84:87], v[116:119], v[32:35]
    ds_read_b64_tr_b16 v[106:107], v15 offset:27136
    v_mfma_f32_16x16x32_bf16 v[64:67], v[80:83], v[184:187], 0
    ds_read_b64_tr_b16 v[108:109], v15 offset:29184
    v_mfma_f32_16x16x32_bf16 v[64:67], v[84:87], v[188:191], v[64:67]
    ds_read_b64_tr_b16 v[110:111], v15 offset:31232
    s_waitcnt lgkmcnt(8)
    v_mfma_f32_16x16x32_bf16 v[36:39], v[88:91], v[112:115], 0
    ds_read_b64_tr_b16 v[80:81], v14 offset:8192
    buffer_load_dwordx4 v[204:207], v5, s[12:15], s6 offen offset:1024 sc1
    v_mfma_f32_16x16x32_bf16 v[36:39], v[92:95], v[116:119], v[36:39]
    ds_read_b64_tr_b16 v[82:83], v14 offset:10240
    v_mfma_f32_16x16x32_bf16 v[68:71], v[88:91], v[184:187], 0
    ds_read_b64_tr_b16 v[84:85], v14 offset:12288
    v_mfma_f32_16x16x32_bf16 v[68:71], v[92:95], v[188:191], v[68:71]
    ds_read_b64_tr_b16 v[86:87], v14 offset:14336
    s_waitcnt lgkmcnt(8)
    v_mfma_f32_16x16x32_bf16 v[40:43], v[96:99], v[112:115], 0
    s_setprio 2
    ds_read_b64_tr_b16 v[88:89], v14 offset:32768
    v_mfma_f32_16x16x32_bf16 v[40:43], v[100:103], v[116:119], v[40:43]
    ds_read_b64_tr_b16 v[90:91], v14 offset:34816
    v_mfma_f32_16x16x32_bf16 v[72:75], v[96:99], v[184:187], 0
    ds_read_b64_tr_b16 v[92:93], v14 offset:36864
    v_mfma_f32_16x16x32_bf16 v[72:75], v[100:103], v[188:191], v[72:75]
    ds_read_b64_tr_b16 v[94:95], v14 offset:38912
    s_waitcnt lgkmcnt(8)
    v_mfma_f32_16x16x32_bf16 v[44:47], v[104:107], v[112:115], 0
    ds_read_b64_tr_b16 v[96:97], v15 offset:8192
    buffer_load_dwordx4 v[136:139], v5, s[12:15], s53 offen offset:2048 sc1
    v_mfma_f32_16x16x32_bf16 v[44:47], v[108:111], v[116:119], v[44:47]
    ds_read_b64_tr_b16 v[98:99], v15 offset:10240
    v_mfma_f32_16x16x32_bf16 v[76:79], v[104:107], v[184:187], 0
    ds_read_b64_tr_b16 v[100:101], v15 offset:12288
    v_mfma_f32_16x16x32_bf16 v[76:79], v[108:111], v[188:191], v[76:79]
    ds_read_b64_tr_b16 v[102:103], v15 offset:14336
    s_waitcnt vmcnt(5)
    s_waitcnt lgkmcnt(8)
    v_mfma_f32_16x16x32_bf16 v[16:19], v[80:83], v[120:123], v[16:19]
    ds_read_b64_tr_b16 v[104:105], v15 offset:32768
    v_mfma_f32_16x16x32_bf16 v[16:19], v[84:87], v[124:127], v[16:19]
    ds_read_b64_tr_b16 v[106:107], v15 offset:34816
    v_mfma_f32_16x16x32_bf16 v[48:51], v[80:83], v[192:195], v[48:51]
    ds_read_b64_tr_b16 v[108:109], v15 offset:36864
    v_mfma_f32_16x16x32_bf16 v[48:51], v[84:87], v[196:199], v[48:51]
    ds_read_b64_tr_b16 v[110:111], v15 offset:38912
    s_waitcnt lgkmcnt(8)
    v_mfma_f32_16x16x32_bf16 v[20:23], v[88:91], v[120:123], v[20:23]
    ds_read_b64_tr_b16 v[80:81], v14 offset:8704
    buffer_load_dwordx4 v[140:143], v5, s[12:15], s53 offen offset:3072 sc1
    s_add_u32 s53, s53, 4096
    v_mfma_f32_16x16x32_bf16 v[20:23], v[92:95], v[124:127], v[20:23]
    ds_read_b64_tr_b16 v[82:83], v14 offset:10752
    v_mfma_f32_16x16x32_bf16 v[52:55], v[88:91], v[192:195], v[52:55]
    ds_read_b64_tr_b16 v[84:85], v14 offset:12800
    v_mfma_f32_16x16x32_bf16 v[52:55], v[92:95], v[196:199], v[52:55]
    ds_read_b64_tr_b16 v[86:87], v14 offset:14848
    s_waitcnt lgkmcnt(8)
    v_mfma_f32_16x16x32_bf16 v[24:27], v[96:99], v[120:123], v[24:27]
    ds_read_b64_tr_b16 v[88:89], v14 offset:33280
    v_mfma_f32_16x16x32_bf16 v[24:27], v[100:103], v[124:127], v[24:27]
    ds_read_b64_tr_b16 v[90:91], v14 offset:35328
    v_mfma_f32_16x16x32_bf16 v[56:59], v[96:99], v[192:195], v[56:59]
    ds_read_b64_tr_b16 v[92:93], v14 offset:37376
    v_mfma_f32_16x16x32_bf16 v[56:59], v[100:103], v[196:199], v[56:59]
    ds_read_b64_tr_b16 v[94:95], v14 offset:39424
    s_waitcnt lgkmcnt(8)
    v_mfma_f32_16x16x32_bf16 v[28:31], v[104:107], v[120:123], v[28:31]
    s_setprio 1
    ds_read_b64_tr_b16 v[96:97], v15 offset:8704
    buffer_load_dwordx4 v[208:211], v5, s[12:15], s6 offen offset:2048 sc1
    v_mfma_f32_16x16x32_bf16 v[28:31], v[108:111], v[124:127], v[28:31]
    ds_read_b64_tr_b16 v[98:99], v15 offset:10752
    v_mfma_f32_16x16x32_bf16 v[60:63], v[104:107], v[192:195], v[60:63]
    ds_read_b64_tr_b16 v[100:101], v15 offset:12800
    v_mfma_f32_16x16x32_bf16 v[60:63], v[108:111], v[196:199], v[60:63]
    ds_read_b64_tr_b16 v[102:103], v15 offset:14848
    s_waitcnt lgkmcnt(8)
    v_mfma_f32_16x16x32_bf16 v[32:35], v[80:83], v[120:123], v[32:35]
    ds_read_b64_tr_b16 v[104:105], v15 offset:33280
    v_mfma_f32_16x16x32_bf16 v[32:35], v[84:87], v[124:127], v[32:35]
    ds_read_b64_tr_b16 v[106:107], v15 offset:35328
    v_mfma_f32_16x16x32_bf16 v[64:67], v[80:83], v[192:195], v[64:67]
    ds_read_b64_tr_b16 v[108:109], v15 offset:37376
    v_mfma_f32_16x16x32_bf16 v[64:67], v[84:87], v[196:199], v[64:67]
    ds_read_b64_tr_b16 v[110:111], v15 offset:39424
    s_waitcnt lgkmcnt(8)
    v_mfma_f32_16x16x32_bf16 v[36:39], v[88:91], v[120:123], v[36:39]
    ds_read_b64_tr_b16 v[80:81], v14 offset:16384
    buffer_load_dwordx4 v[212:215], v5, s[12:15], s6 offen offset:3072 sc1
    s_add_u32 s6, s6, 4096
    v_mfma_f32_16x16x32_bf16 v[36:39], v[92:95], v[124:127], v[36:39]
    ds_read_b64_tr_b16 v[82:83], v14 offset:18432
    v_mfma_f32_16x16x32_bf16 v[68:71], v[88:91], v[192:195], v[68:71]
    ds_read_b64_tr_b16 v[84:85], v14 offset:20480
    v_mfma_f32_16x16x32_bf16 v[68:71], v[92:95], v[196:199], v[68:71]
    ds_read_b64_tr_b16 v[86:87], v14 offset:22528
    s_waitcnt lgkmcnt(8)
    v_mfma_f32_16x16x32_bf16 v[40:43], v[96:99], v[120:123], v[40:43]
    ds_read_b64_tr_b16 v[88:89], v14 offset:40960
    v_mfma_f32_16x16x32_bf16 v[40:43], v[100:103], v[124:127], v[40:43]
    ds_read_b64_tr_b16 v[90:91], v14 offset:43008
    v_mfma_f32_16x16x32_bf16 v[72:75], v[96:99], v[192:195], v[72:75]
    ds_read_b64_tr_b16 v[92:93], v14 offset:45056
    v_mfma_f32_16x16x32_bf16 v[72:75], v[100:103], v[196:199], v[72:75]
    ds_read_b64_tr_b16 v[94:95], v14 offset:47104
    s_waitcnt lgkmcnt(8)
    v_mfma_f32_16x16x32_bf16 v[44:47], v[104:107], v[120:123], v[44:47]
    ds_read_b64_tr_b16 v[96:97], v15 offset:16384
    buffer_load_dwordx4 v[144:147], v5, s[12:15], s53 offen offset:0 sc1
    v_mfma_f32_16x16x32_bf16 v[44:47], v[108:111], v[124:127], v[44:47]
    ds_read_b64_tr_b16 v[98:99], v15 offset:18432
    v_mfma_f32_16x16x32_bf16 v[76:79], v[104:107], v[192:195], v[76:79]
    ds_read_b64_tr_b16 v[100:101], v15 offset:20480
    v_mfma_f32_16x16x32_bf16 v[76:79], v[108:111], v[196:199], v[76:79]
    ds_read_b64_tr_b16 v[102:103], v15 offset:22528
    s_waitcnt vmcnt(5)
    s_waitcnt lgkmcnt(8)
    v_mfma_f32_16x16x32_bf16 v[16:19], v[80:83], v[128:131], v[16:19]
    s_setprio 0
    ds_read_b64_tr_b16 v[104:105], v15 offset:40960
    buffer_load_dwordx4 v[148:151], v5, s[12:15], s53 offen offset:1024 sc1
    v_mfma_f32_16x16x32_bf16 v[16:19], v[84:87], v[132:135], v[16:19]
    ds_read_b64_tr_b16 v[106:107], v15 offset:43008
    v_mfma_f32_16x16x32_bf16 v[48:51], v[80:83], v[200:203], v[48:51]
    ds_read_b64_tr_b16 v[108:109], v15 offset:45056
    v_mfma_f32_16x16x32_bf16 v[48:51], v[84:87], v[204:207], v[48:51]
    ds_read_b64_tr_b16 v[110:111], v15 offset:47104
    s_waitcnt lgkmcnt(8)
    v_mfma_f32_16x16x32_bf16 v[20:23], v[88:91], v[128:131], v[20:23]
    ds_read_b64_tr_b16 v[80:81], v14 offset:16896
    v_mfma_f32_16x16x32_bf16 v[20:23], v[92:95], v[132:135], v[20:23]
    ds_read_b64_tr_b16 v[82:83], v14 offset:18944
    v_mfma_f32_16x16x32_bf16 v[52:55], v[88:91], v[200:203], v[52:55]
    ds_read_b64_tr_b16 v[84:85], v14 offset:20992
    v_mfma_f32_16x16x32_bf16 v[52:55], v[92:95], v[204:207], v[52:55]
    ds_read_b64_tr_b16 v[86:87], v14 offset:23040
    s_waitcnt lgkmcnt(8)
    v_mfma_f32_16x16x32_bf16 v[24:27], v[96:99], v[128:131], v[24:27]
    ds_read_b64_tr_b16 v[88:89], v14 offset:41472
    buffer_load_dwordx4 v[216:219], v5, s[12:15], s6 offen offset:0 sc1
    v_mfma_f32_16x16x32_bf16 v[24:27], v[100:103], v[132:135], v[24:27]
    ds_read_b64_tr_b16 v[90:91], v14 offset:43520
    v_mfma_f32_16x16x32_bf16 v[56:59], v[96:99], v[200:203], v[56:59]
    ds_read_b64_tr_b16 v[92:93], v14 offset:45568
    v_mfma_f32_16x16x32_bf16 v[56:59], v[100:103], v[204:207], v[56:59]
    ds_read_b64_tr_b16 v[94:95], v14 offset:47616
    s_waitcnt lgkmcnt(8)
    v_mfma_f32_16x16x32_bf16 v[28:31], v[104:107], v[128:131], v[28:31]
    ds_read_b64_tr_b16 v[96:97], v15 offset:16896
    v_mfma_f32_16x16x32_bf16 v[28:31], v[108:111], v[132:135], v[28:31]
    ds_read_b64_tr_b16 v[98:99], v15 offset:18944
    v_mfma_f32_16x16x32_bf16 v[60:63], v[104:107], v[200:203], v[60:63]
    ds_read_b64_tr_b16 v[100:101], v15 offset:20992
    v_mfma_f32_16x16x32_bf16 v[60:63], v[108:111], v[204:207], v[60:63]
    ds_read_b64_tr_b16 v[102:103], v15 offset:23040
    s_waitcnt lgkmcnt(8)
    v_mfma_f32_16x16x32_bf16 v[32:35], v[80:83], v[128:131], v[32:35]
    ds_read_b64_tr_b16 v[104:105], v15 offset:41472
    buffer_load_dwordx4 v[220:223], v5, s[12:15], s6 offen offset:1024 sc1
    v_mfma_f32_16x16x32_bf16 v[32:35], v[84:87], v[132:135], v[32:35]
    ds_read_b64_tr_b16 v[106:107], v15 offset:43520
    v_mfma_f32_16x16x32_bf16 v[64:67], v[80:83], v[200:203], v[64:67]
    ds_read_b64_tr_b16 v[108:109], v15 offset:45568
    v_mfma_f32_16x16x32_bf16 v[64:67], v[84:87], v[204:207], v[64:67]
    ds_read_b64_tr_b16 v[110:111], v15 offset:47616
    s_waitcnt lgkmcnt(8)
    v_mfma_f32_16x16x32_bf16 v[36:39], v[88:91], v[128:131], v[36:39]
    s_setprio 3
    s_waitcnt vmcnt(20)
    s_barrier
    v_add_u32 v14, 49152, v14
    v_add_u32 v15, 49152, v15
    ds_read_b64_tr_b16 v[80:81], v14 offset:0
    v_mfma_f32_16x16x32_bf16 v[36:39], v[92:95], v[132:135], v[36:39]
    ds_read_b64_tr_b16 v[82:83], v14 offset:2048
    v_mfma_f32_16x16x32_bf16 v[68:71], v[88:91], v[200:203], v[68:71]
    ds_read_b64_tr_b16 v[84:85], v14 offset:4096
    v_mfma_f32_16x16x32_bf16 v[68:71], v[92:95], v[204:207], v[68:71]
    ds_read_b64_tr_b16 v[86:87], v14 offset:6144
    s_waitcnt lgkmcnt(8)
    v_mfma_f32_16x16x32_bf16 v[40:43], v[96:99], v[128:131], v[40:43]
    ds_read_b64_tr_b16 v[88:89], v14 offset:24576
    buffer_load_dwordx4 v[152:155], v5, s[12:15], s53 offen offset:2048 sc1
    v_mfma_f32_16x16x32_bf16 v[40:43], v[100:103], v[132:135], v[40:43]
    ds_read_b64_tr_b16 v[90:91], v14 offset:26624
    s_add_u32 m0, s35, 114688
    s_add_u32 s29, s32, 3538944
    buffer_load_dwordx4 v9, s[16:19], s29 offen lds
    v_mfma_f32_16x16x32_bf16 v[72:75], v[96:99], v[200:203], v[72:75]
    ds_read_b64_tr_b16 v[92:93], v14 offset:28672
    v_mfma_f32_16x16x32_bf16 v[72:75], v[100:103], v[204:207], v[72:75]
    ds_read_b64_tr_b16 v[94:95], v14 offset:30720
    s_waitcnt lgkmcnt(8)
    v_mfma_f32_16x16x32_bf16 v[44:47], v[104:107], v[128:131], v[44:47]
    ds_read_b64_tr_b16 v[96:97], v15 offset:0
    v_mfma_f32_16x16x32_bf16 v[44:47], v[108:111], v[132:135], v[44:47]
    ds_read_b64_tr_b16 v[98:99], v15 offset:2048
    v_mfma_f32_16x16x32_bf16 v[76:79], v[104:107], v[200:203], v[76:79]
    ds_read_b64_tr_b16 v[100:101], v15 offset:4096
    v_mfma_f32_16x16x32_bf16 v[76:79], v[108:111], v[204:207], v[76:79]
    ds_read_b64_tr_b16 v[102:103], v15 offset:6144
    s_waitcnt vmcnt(6)
    s_waitcnt lgkmcnt(8)
    v_mfma_f32_16x16x32_bf16 v[16:19], v[80:83], v[136:139], v[16:19]
    ds_read_b64_tr_b16 v[104:105], v15 offset:24576
    buffer_load_dwordx4 v[156:159], v5, s[12:15], s53 offen offset:3072 sc1
    s_add_u32 s53, s53, 4096
    v_mfma_f32_16x16x32_bf16 v[16:19], v[84:87], v[140:143], v[16:19]
    ds_read_b64_tr_b16 v[106:107], v15 offset:26624
    s_add_u32 m0, s35, 118784
    s_add_u32 s29, s32, 3833856
    buffer_load_dwordx4 v9, s[16:19], s29 offen lds
    v_mfma_f32_16x16x32_bf16 v[48:51], v[80:83], v[208:211], v[48:51]
    ds_read_b64_tr_b16 v[108:109], v15 offset:28672
    v_mfma_f32_16x16x32_bf16 v[48:51], v[84:87], v[212:215], v[48:51]
    ds_read_b64_tr_b16 v[110:111], v15 offset:30720
    s_waitcnt lgkmcnt(8)
    v_mfma_f32_16x16x32_bf16 v[20:23], v[88:91], v[136:139], v[20:23]
    ds_read_b64_tr_b16 v[80:81], v14 offset:512
    v_mfma_f32_16x16x32_bf16 v[20:23], v[92:95], v[140:143], v[20:23]
    ds_read_b64_tr_b16 v[82:83], v14 offset:2560
    v_mfma_f32_16x16x32_bf16 v[52:55], v[88:91], v[208:211], v[52:55]
    ds_read_b64_tr_b16 v[84:85], v14 offset:4608
    v_mfma_f32_16x16x32_bf16 v[52:55], v[92:95], v[212:215], v[52:55]
    ds_read_b64_tr_b16 v[86:87], v14 offset:6656
    s_waitcnt lgkmcnt(8)
    v_mfma_f32_16x16x32_bf16 v[24:27], v[96:99], v[136:139], v[24:27]
    ds_read_b64_tr_b16 v[88:89], v14 offset:25088
    buffer_load_dwordx4 v[224:227], v5, s[12:15], s6 offen offset:2048 sc1
    v_mfma_f32_16x16x32_bf16 v[24:27], v[100:103], v[140:143], v[24:27]
    ds_read_b64_tr_b16 v[90:91], v14 offset:27136
    s_add_u32 m0, s35, 122880
    s_add_u32 s29, s32, 4128768
    buffer_load_dwordx4 v9, s[16:19], s29 offen lds
    v_mfma_f32_16x16x32_bf16 v[56:59], v[96:99], v[208:211], v[56:59]
    ds_read_b64_tr_b16 v[92:93], v14 offset:29184
    v_mfma_f32_16x16x32_bf16 v[56:59], v[100:103], v[212:215], v[56:59]
    ds_read_b64_tr_b16 v[94:95], v14 offset:31232
    s_waitcnt lgkmcnt(8)
    v_mfma_f32_16x16x32_bf16 v[28:31], v[104:107], v[136:139], v[28:31]
    s_setprio 2
    ds_read_b64_tr_b16 v[96:97], v15 offset:512
    v_mfma_f32_16x16x32_bf16 v[28:31], v[108:111], v[140:143], v[28:31]
    ds_read_b64_tr_b16 v[98:99], v15 offset:2560
    v_mfma_f32_16x16x32_bf16 v[60:63], v[104:107], v[208:211], v[60:63]
    ds_read_b64_tr_b16 v[100:101], v15 offset:4608
    v_mfma_f32_16x16x32_bf16 v[60:63], v[108:111], v[212:215], v[60:63]
    ds_read_b64_tr_b16 v[102:103], v15 offset:6656
    s_waitcnt lgkmcnt(8)
    v_mfma_f32_16x16x32_bf16 v[32:35], v[80:83], v[136:139], v[32:35]
    ds_read_b64_tr_b16 v[104:105], v15 offset:25088
    buffer_load_dwordx4 v[228:231], v5, s[12:15], s6 offen offset:3072 sc1
    s_add_u32 s6, s6, 4096
    v_mfma_f32_16x16x32_bf16 v[32:35], v[84:87], v[140:143], v[32:35]
    ds_read_b64_tr_b16 v[106:107], v15 offset:27136
    s_add_u32 m0, s35, 126976
    s_add_u32 s29, s32, 4423680
    buffer_load_dwordx4 v9, s[16:19], s29 offen lds
    v_mfma_f32_16x16x32_bf16 v[64:67], v[80:83], v[208:211], v[64:67]
    ds_read_b64_tr_b16 v[108:109], v15 offset:29184
    v_mfma_f32_16x16x32_bf16 v[64:67], v[84:87], v[212:215], v[64:67]
    ds_read_b64_tr_b16 v[110:111], v15 offset:31232
    s_waitcnt lgkmcnt(8)
    v_mfma_f32_16x16x32_bf16 v[36:39], v[88:91], v[136:139], v[36:39]
    ds_read_b64_tr_b16 v[80:81], v14 offset:8192
    v_mfma_f32_16x16x32_bf16 v[36:39], v[92:95], v[140:143], v[36:39]
    ds_read_b64_tr_b16 v[82:83], v14 offset:10240
    v_mfma_f32_16x16x32_bf16 v[68:71], v[88:91], v[208:211], v[68:71]
    ds_read_b64_tr_b16 v[84:85], v14 offset:12288
    v_mfma_f32_16x16x32_bf16 v[68:71], v[92:95], v[212:215], v[68:71]
    ds_read_b64_tr_b16 v[86:87], v14 offset:14336
    s_waitcnt lgkmcnt(8)
    v_mfma_f32_16x16x32_bf16 v[40:43], v[96:99], v[136:139], v[40:43]
    ds_read_b64_tr_b16 v[88:89], v14 offset:32768
    buffer_load_dwordx4 v[160:163], v5, s[12:15], s53 offen offset:0 sc1
    v_mfma_f32_16x16x32_bf16 v[40:43], v[100:103], v[140:143], v[40:43]
    ds_read_b64_tr_b16 v[90:91], v14 offset:34816
    s_add_u32 m0, s35, 131072
    s_add_u32 s29, s33, 4718592
    buffer_load_dwordx4 v10, s[16:19], s29 offen lds
    v_mfma_f32_16x16x32_bf16 v[72:75], v[96:99], v[208:211], v[72:75]
    ds_read_b64_tr_b16 v[92:93], v14 offset:36864
    v_mfma_f32_16x16x32_bf16 v[72:75], v[100:103], v[212:215], v[72:75]
    ds_read_b64_tr_b16 v[94:95], v14 offset:38912
    s_waitcnt lgkmcnt(8)
    v_mfma_f32_16x16x32_bf16 v[44:47], v[104:107], v[136:139], v[44:47]
    ds_read_b64_tr_b16 v[96:97], v15 offset:8192
    buffer_load_dwordx4 v[164:167], v5, s[12:15], s53 offen offset:1024 sc1
    v_mfma_f32_16x16x32_bf16 v[44:47], v[108:111], v[140:143], v[44:47]
    ds_read_b64_tr_b16 v[98:99], v15 offset:10240
    v_mfma_f32_16x16x32_bf16 v[76:79], v[104:107], v[208:211], v[76:79]
    ds_read_b64_tr_b16 v[100:101], v15 offset:12288
    v_mfma_f32_16x16x32_bf16 v[76:79], v[108:111], v[212:215], v[76:79]
    ds_read_b64_tr_b16 v[102:103], v15 offset:14336
    s_waitcnt vmcnt(11)
    s_waitcnt lgkmcnt(8)
    v_mfma_f32_16x16x32_bf16 v[16:19], v[80:83], v[144:147], v[16:19]
    ds_read_b64_tr_b16 v[104:105], v15 offset:32768
    s_add_u32 m0, s35, 135168
    s_add_u32 s29, s33, 5013504
    buffer_load_dwordx4 v10, s[16:19], s29 offen lds
    v_mfma_f32_16x16x32_bf16 v[16:19], v[84:87], v[148:151], v[16:19]
    ds_read_b64_tr_b16 v[106:107], v15 offset:34816
    v_mfma_f32_16x16x32_bf16 v[48:51], v[80:83], v[216:219], v[48:51]
    ds_read_b64_tr_b16 v[108:109], v15 offset:36864
    v_mfma_f32_16x16x32_bf16 v[48:51], v[84:87], v[220:223], v[48:51]
    ds_read_b64_tr_b16 v[110:111], v15 offset:38912
    s_waitcnt lgkmcnt(8)
    v_mfma_f32_16x16x32_bf16 v[20:23], v[88:91], v[144:147], v[20:23]
    s_setprio 1
    ds_read_b64_tr_b16 v[80:81], v14 offset:8704
    buffer_load_dwordx4 v[232:235], v5, s[12:15], s6 offen offset:0 sc1
    v_mfma_f32_16x16x32_bf16 v[20:23], v[92:95], v[148:151], v[20:23]
    ds_read_b64_tr_b16 v[82:83], v14 offset:10752
    v_mfma_f32_16x16x32_bf16 v[52:55], v[88:91], v[216:219], v[52:55]
    ds_read_b64_tr_b16 v[84:85], v14 offset:12800
    v_mfma_f32_16x16x32_bf16 v[52:55], v[92:95], v[220:223], v[52:55]
    ds_read_b64_tr_b16 v[86:87], v14 offset:14848
    s_waitcnt lgkmcnt(8)
    v_mfma_f32_16x16x32_bf16 v[24:27], v[96:99], v[144:147], v[24:27]
    ds_read_b64_tr_b16 v[88:89], v14 offset:33280
    v_mfma_f32_16x16x32_bf16 v[24:27], v[100:103], v[148:151], v[24:27]
    ds_read_b64_tr_b16 v[90:91], v14 offset:35328
    v_mfma_f32_16x16x32_bf16 v[56:59], v[96:99], v[216:219], v[56:59]
    ds_read_b64_tr_b16 v[92:93], v14 offset:37376
    v_mfma_f32_16x16x32_bf16 v[56:59], v[100:103], v[220:223], v[56:59]
    ds_read_b64_tr_b16 v[94:95], v14 offset:39424
    s_waitcnt lgkmcnt(8)
    v_mfma_f32_16x16x32_bf16 v[28:31], v[104:107], v[144:147], v[28:31]
    ds_read_b64_tr_b16 v[96:97], v15 offset:8704
    buffer_load_dwordx4 v[236:239], v5, s[12:15], s6 offen offset:1024 sc1
    v_mfma_f32_16x16x32_bf16 v[28:31], v[108:111], v[148:151], v[28:31]
    ds_read_b64_tr_b16 v[98:99], v15 offset:10752
    v_mfma_f32_16x16x32_bf16 v[60:63], v[104:107], v[216:219], v[60:63]
    ds_read_b64_tr_b16 v[100:101], v15 offset:12800
    v_mfma_f32_16x16x32_bf16 v[60:63], v[108:111], v[220:223], v[60:63]
    ds_read_b64_tr_b16 v[102:103], v15 offset:14848
    s_waitcnt lgkmcnt(8)
    v_mfma_f32_16x16x32_bf16 v[32:35], v[80:83], v[144:147], v[32:35]
    ds_read_b64_tr_b16 v[104:105], v15 offset:33280
    v_mfma_f32_16x16x32_bf16 v[32:35], v[84:87], v[148:151], v[32:35]
    ds_read_b64_tr_b16 v[106:107], v15 offset:35328
    v_mfma_f32_16x16x32_bf16 v[64:67], v[80:83], v[216:219], v[64:67]
    ds_read_b64_tr_b16 v[108:109], v15 offset:37376
    v_mfma_f32_16x16x32_bf16 v[64:67], v[84:87], v[220:223], v[64:67]
    ds_read_b64_tr_b16 v[110:111], v15 offset:39424
    s_waitcnt lgkmcnt(8)
    v_mfma_f32_16x16x32_bf16 v[36:39], v[88:91], v[144:147], v[36:39]
    ds_read_b64_tr_b16 v[80:81], v14 offset:16384
    buffer_load_dwordx4 v[168:171], v5, s[12:15], s53 offen offset:2048 sc1
    v_mfma_f32_16x16x32_bf16 v[36:39], v[92:95], v[148:151], v[36:39]
    ds_read_b64_tr_b16 v[82:83], v14 offset:18432
    v_mfma_f32_16x16x32_bf16 v[68:71], v[88:91], v[216:219], v[68:71]
    ds_read_b64_tr_b16 v[84:85], v14 offset:20480
    v_mfma_f32_16x16x32_bf16 v[68:71], v[92:95], v[220:223], v[68:71]
    ds_read_b64_tr_b16 v[86:87], v14 offset:22528
    s_waitcnt lgkmcnt(8)
    v_mfma_f32_16x16x32_bf16 v[40:43], v[96:99], v[144:147], v[40:43]
    ds_read_b64_tr_b16 v[88:89], v14 offset:40960
    v_mfma_f32_16x16x32_bf16 v[40:43], v[100:103], v[148:151], v[40:43]
    ds_read_b64_tr_b16 v[90:91], v14 offset:43008
    v_mfma_f32_16x16x32_bf16 v[72:75], v[96:99], v[216:219], v[72:75]
    ds_read_b64_tr_b16 v[92:93], v14 offset:45056
    v_mfma_f32_16x16x32_bf16 v[72:75], v[100:103], v[220:223], v[72:75]
    ds_read_b64_tr_b16 v[94:95], v14 offset:47104
    s_waitcnt lgkmcnt(8)
    v_mfma_f32_16x16x32_bf16 v[44:47], v[104:107], v[144:147], v[44:47]
    s_setprio 0
    ds_read_b64_tr_b16 v[96:97], v15 offset:16384
    buffer_load_dwordx4 v[172:175], v5, s[12:15], s53 offen offset:3072 sc1
    s_add_u32 s53, s53, 4096
    v_mfma_f32_16x16x32_bf16 v[44:47], v[108:111], v[148:151], v[44:47]
    ds_read_b64_tr_b16 v[98:99], v15 offset:18432
    v_mfma_f32_16x16x32_bf16 v[76:79], v[104:107], v[216:219], v[76:79]
    ds_read_b64_tr_b16 v[100:101], v15 offset:20480
    v_mfma_f32_16x16x32_bf16 v[76:79], v[108:111], v[220:223], v[76:79]
    ds_read_b64_tr_b16 v[102:103], v15 offset:22528
    s_waitcnt vmcnt(9)
    s_waitcnt lgkmcnt(8)
    v_mfma_f32_16x16x32_bf16 v[16:19], v[80:83], v[152:155], v[16:19]
    ds_read_b64_tr_b16 v[104:105], v15 offset:40960
    v_mfma_f32_16x16x32_bf16 v[16:19], v[84:87], v[156:159], v[16:19]
    ds_read_b64_tr_b16 v[106:107], v15 offset:43008
    v_mfma_f32_16x16x32_bf16 v[48:51], v[80:83], v[224:227], v[48:51]
    ds_read_b64_tr_b16 v[108:109], v15 offset:45056
    v_mfma_f32_16x16x32_bf16 v[48:51], v[84:87], v[228:231], v[48:51]
    ds_read_b64_tr_b16 v[110:111], v15 offset:47104
    s_waitcnt lgkmcnt(8)
    v_mfma_f32_16x16x32_bf16 v[20:23], v[88:91], v[152:155], v[20:23]
    ds_read_b64_tr_b16 v[80:81], v14 offset:16896
    buffer_load_dwordx4 v[240:243], v5, s[12:15], s6 offen offset:2048 sc1
    v_mfma_f32_16x16x32_bf16 v[20:23], v[92:95], v[156:159], v[20:23]
    ds_read_b64_tr_b16 v[82:83], v14 offset:18944
    v_mfma_f32_16x16x32_bf16 v[52:55], v[88:91], v[224:227], v[52:55]
    ds_read_b64_tr_b16 v[84:85], v14 offset:20992
    v_mfma_f32_16x16x32_bf16 v[52:55], v[92:95], v[228:231], v[52:55]
    ds_read_b64_tr_b16 v[86:87], v14 offset:23040
    s_waitcnt lgkmcnt(8)
    v_mfma_f32_16x16x32_bf16 v[24:27], v[96:99], v[152:155], v[24:27]
    ds_read_b64_tr_b16 v[88:89], v14 offset:41472
    v_mfma_f32_16x16x32_bf16 v[24:27], v[100:103], v[156:159], v[24:27]
    ds_read_b64_tr_b16 v[90:91], v14 offset:43520
    v_mfma_f32_16x16x32_bf16 v[56:59], v[96:99], v[224:227], v[56:59]
    ds_read_b64_tr_b16 v[92:93], v14 offset:45568
    v_mfma_f32_16x16x32_bf16 v[56:59], v[100:103], v[228:231], v[56:59]
    ds_read_b64_tr_b16 v[94:95], v14 offset:47616
    s_waitcnt lgkmcnt(8)
    v_mfma_f32_16x16x32_bf16 v[28:31], v[104:107], v[152:155], v[28:31]
    ds_read_b64_tr_b16 v[96:97], v15 offset:16896
    buffer_load_dwordx4 v[244:247], v5, s[12:15], s6 offen offset:3072 sc1
    s_add_u32 s6, s6, 4096
    v_mfma_f32_16x16x32_bf16 v[28:31], v[108:111], v[156:159], v[28:31]
    ds_read_b64_tr_b16 v[98:99], v15 offset:18944
    v_mfma_f32_16x16x32_bf16 v[60:63], v[104:107], v[224:227], v[60:63]
    ds_read_b64_tr_b16 v[100:101], v15 offset:20992
    v_mfma_f32_16x16x32_bf16 v[60:63], v[108:111], v[228:231], v[60:63]
    ds_read_b64_tr_b16 v[102:103], v15 offset:23040
    s_waitcnt lgkmcnt(8)
    v_mfma_f32_16x16x32_bf16 v[32:35], v[80:83], v[152:155], v[32:35]
    ds_read_b64_tr_b16 v[104:105], v15 offset:41472
    v_mfma_f32_16x16x32_bf16 v[32:35], v[84:87], v[156:159], v[32:35]
    ds_read_b64_tr_b16 v[106:107], v15 offset:43520
    v_mfma_f32_16x16x32_bf16 v[64:67], v[80:83], v[224:227], v[64:67]
    ds_read_b64_tr_b16 v[108:109], v15 offset:45568
    v_mfma_f32_16x16x32_bf16 v[64:67], v[84:87], v[228:231], v[64:67]
    ds_read_b64_tr_b16 v[110:111], v15 offset:47616
    s_waitcnt lgkmcnt(8)
    v_mfma_f32_16x16x32_bf16 v[36:39], v[88:91], v[152:155], v[36:39]
    s_setprio 3
    s_waitcnt vmcnt(6)
    s_barrier
    v_add_u32 v14, 65536, v14
    v_add_u32 v15, 65536, v15
    ds_read_b64_tr_b16 v[80:81], v14 offset:0
    buffer_load_dwordx4 v[176:179], v5, s[12:15], s53 offen offset:0 sc1
    v_mfma_f32_16x16x32_bf16 v[36:39], v[92:95], v[156:159], v[36:39]
    ds_read_b64_tr_b16 v[82:83], v14 offset:2048
    v_mfma_f32_16x16x32_bf16 v[68:71], v[88:91], v[224:227], v[68:71]
    ds_read_b64_tr_b16 v[84:85], v14 offset:4096
    v_mfma_f32_16x16x32_bf16 v[68:71], v[92:95], v[228:231], v[68:71]
    ds_read_b64_tr_b16 v[86:87], v14 offset:6144
    s_waitcnt lgkmcnt(8)
    v_mfma_f32_16x16x32_bf16 v[40:43], v[96:99], v[152:155], v[40:43]
    ds_read_b64_tr_b16 v[88:89], v14 offset:24576
    buffer_load_dwordx4 v[180:183], v5, s[12:15], s53 offen offset:1024 sc1
    v_mfma_f32_16x16x32_bf16 v[40:43], v[100:103], v[156:159], v[40:43]
    ds_read_b64_tr_b16 v[90:91], v14 offset:26624
    s_add_u32 s32, s32, 128
    s_add_u32 s33, s33, 128
    s_add_u32 m0, s35, 0
    s_add_u32 s29, s32, 0
    buffer_load_dwordx4 v9, s[16:19], s29 offen lds
    v_mfma_f32_16x16x32_bf16 v[72:75], v[96:99], v[224:227], v[72:75]
    ds_read_b64_tr_b16 v[92:93], v14 offset:28672
    v_mfma_f32_16x16x32_bf16 v[72:75], v[100:103], v[228:231], v[72:75]
    ds_read_b64_tr_b16 v[94:95], v14 offset:30720
    s_waitcnt lgkmcnt(8)
    v_mfma_f32_16x16x32_bf16 v[44:47], v[104:107], v[152:155], v[44:47]
    ds_read_b64_tr_b16 v[96:97], v15 offset:0
    v_mfma_f32_16x16x32_bf16 v[44:47], v[108:111], v[156:159], v[44:47]
    ds_read_b64_tr_b16 v[98:99], v15 offset:2048
    v_mfma_f32_16x16x32_bf16 v[76:79], v[104:107], v[224:227], v[76:79]
    ds_read_b64_tr_b16 v[100:101], v15 offset:4096
    v_mfma_f32_16x16x32_bf16 v[76:79], v[108:111], v[228:231], v[76:79]
    ds_read_b64_tr_b16 v[102:103], v15 offset:6144
    s_waitcnt vmcnt(7)
    s_waitcnt lgkmcnt(8)
    v_mfma_f32_16x16x32_bf16 v[16:19], v[80:83], v[160:163], v[16:19]
    ds_read_b64_tr_b16 v[104:105], v15 offset:24576
    buffer_load_dwordx4 v[248:251], v5, s[12:15], s6 offen offset:0 sc1
    v_mfma_f32_16x16x32_bf16 v[16:19], v[84:87], v[164:167], v[16:19]
    ds_read_b64_tr_b16 v[106:107], v15 offset:26624
    s_add_u32 m0, s35, 4096
    s_add_u32 s29, s32, 294912
    buffer_load_dwordx4 v9, s[16:19], s29 offen lds
    v_mfma_f32_16x16x32_bf16 v[48:51], v[80:83], v[232:235], v[48:51]
    ds_read_b64_tr_b16 v[108:109], v15 offset:28672
    v_mfma_f32_16x16x32_bf16 v[48:51], v[84:87], v[236:239], v[48:51]
    ds_read_b64_tr_b16 v[110:111], v15 offset:30720
    s_waitcnt lgkmcnt(8)
    v_mfma_f32_16x16x32_bf16 v[20:23], v[88:91], v[160:163], v[20:23]
    ds_read_b64_tr_b16 v[80:81], v14 offset:8192
    v_mfma_f32_16x16x32_bf16 v[20:23], v[92:95], v[164:167], v[20:23]
    ds_read_b64_tr_b16 v[82:83], v14 offset:10240
    v_mfma_f32_16x16x32_bf16 v[52:55], v[88:91], v[232:235], v[52:55]
    ds_read_b64_tr_b16 v[84:85], v14 offset:12288
    v_mfma_f32_16x16x32_bf16 v[52:55], v[92:95], v[236:239], v[52:55]
    ds_read_b64_tr_b16 v[86:87], v14 offset:14336
    s_waitcnt lgkmcnt(8)
    v_mfma_f32_16x16x32_bf16 v[24:27], v[96:99], v[160:163], v[24:27]
    ds_read_b64_tr_b16 v[88:89], v14 offset:32768
    buffer_load_dwordx4 v[252:255], v5, s[12:15], s6 offen offset:1024 sc1
    v_mfma_f32_16x16x32_bf16 v[24:27], v[100:103], v[164:167], v[24:27]
    ds_read_b64_tr_b16 v[90:91], v14 offset:34816
    s_add_u32 m0, s35, 8192
    s_add_u32 s29, s32, 589824
    buffer_load_dwordx4 v9, s[16:19], s29 offen lds
    v_mfma_f32_16x16x32_bf16 v[56:59], v[96:99], v[232:235], v[56:59]
    ds_read_b64_tr_b16 v[92:93], v14 offset:36864
    v_mfma_f32_16x16x32_bf16 v[56:59], v[100:103], v[236:239], v[56:59]
    ds_read_b64_tr_b16 v[94:95], v14 offset:38912
    s_waitcnt lgkmcnt(8)
    v_mfma_f32_16x16x32_bf16 v[28:31], v[104:107], v[160:163], v[28:31]
    s_setprio 2
    ds_read_b64_tr_b16 v[96:97], v15 offset:8192
    v_mfma_f32_16x16x32_bf16 v[28:31], v[108:111], v[164:167], v[28:31]
    ds_read_b64_tr_b16 v[98:99], v15 offset:10240
    v_mfma_f32_16x16x32_bf16 v[60:63], v[104:107], v[232:235], v[60:63]
    ds_read_b64_tr_b16 v[100:101], v15 offset:12288
    v_mfma_f32_16x16x32_bf16 v[60:63], v[108:111], v[236:239], v[60:63]
    ds_read_b64_tr_b16 v[102:103], v15 offset:14336
    s_waitcnt vmcnt(7)
    s_waitcnt lgkmcnt(8)
    v_mfma_f32_16x16x32_bf16 v[16:19], v[80:83], v[168:171], v[16:19]
    ds_read_b64_tr_b16 v[104:105], v15 offset:32768
    s_add_u32 m0, s35, 12288
    s_add_u32 s29, s32, 884736
    buffer_load_dwordx4 v9, s[16:19], s29 offen lds
    v_mfma_f32_16x16x32_bf16 v[16:19], v[84:87], v[172:175], v[16:19]
    ds_read_b64_tr_b16 v[106:107], v15 offset:34816
    v_mfma_f32_16x16x32_bf16 v[48:51], v[80:83], v[240:243], v[48:51]
    ds_read_b64_tr_b16 v[108:109], v15 offset:36864
    v_mfma_f32_16x16x32_bf16 v[48:51], v[84:87], v[244:247], v[48:51]
    ds_read_b64_tr_b16 v[110:111], v15 offset:38912
    s_waitcnt lgkmcnt(8)
    v_mfma_f32_16x16x32_bf16 v[20:23], v[88:91], v[168:171], v[20:23]
    ds_read_b64_tr_b16 v[80:81], v14 offset:16384
    v_mfma_f32_16x16x32_bf16 v[20:23], v[92:95], v[172:175], v[20:23]
    ds_read_b64_tr_b16 v[82:83], v14 offset:18432
    v_mfma_f32_16x16x32_bf16 v[52:55], v[88:91], v[240:243], v[52:55]
    ds_read_b64_tr_b16 v[84:85], v14 offset:20480
    v_mfma_f32_16x16x32_bf16 v[52:55], v[92:95], v[244:247], v[52:55]
    ds_read_b64_tr_b16 v[86:87], v14 offset:22528
    s_waitcnt lgkmcnt(8)
    v_mfma_f32_16x16x32_bf16 v[24:27], v[96:99], v[168:171], v[24:27]
    ds_read_b64_tr_b16 v[88:89], v14 offset:40960
    s_add_u32 m0, s35, 16384
    s_add_u32 s29, s32, 1179648
    buffer_load_dwordx4 v9, s[16:19], s29 offen lds
    v_mfma_f32_16x16x32_bf16 v[24:27], v[100:103], v[172:175], v[24:27]
    ds_read_b64_tr_b16 v[90:91], v14 offset:43008
    v_mfma_f32_16x16x32_bf16 v[56:59], v[96:99], v[240:243], v[56:59]
    ds_read_b64_tr_b16 v[92:93], v14 offset:45056
    v_mfma_f32_16x16x32_bf16 v[56:59], v[100:103], v[244:247], v[56:59]
    ds_read_b64_tr_b16 v[94:95], v14 offset:47104
    s_waitcnt lgkmcnt(8)
    v_mfma_f32_16x16x32_bf16 v[28:31], v[104:107], v[168:171], v[28:31]
    ds_read_b64_tr_b16 v[96:97], v15 offset:16384
    v_mfma_f32_16x16x32_bf16 v[28:31], v[108:111], v[172:175], v[28:31]
    ds_read_b64_tr_b16 v[98:99], v15 offset:18432
    v_mfma_f32_16x16x32_bf16 v[60:63], v[104:107], v[240:243], v[60:63]
    ds_read_b64_tr_b16 v[100:101], v15 offset:20480
    v_mfma_f32_16x16x32_bf16 v[60:63], v[108:111], v[244:247], v[60:63]
    ds_read_b64_tr_b16 v[102:103], v15 offset:22528
    s_waitcnt vmcnt(3)
    s_waitcnt lgkmcnt(8)
    v_mfma_f32_16x16x32_bf16 v[16:19], v[80:83], v[176:179], v[16:19]
    ds_read_b64_tr_b16 v[104:105], v15 offset:40960
    s_add_u32 m0, s35, 20480
    s_add_u32 s29, s32, 1474560
    buffer_load_dwordx4 v9, s[16:19], s29 offen lds
    v_mfma_f32_16x16x32_bf16 v[16:19], v[84:87], v[180:183], v[16:19]
    ds_read_b64_tr_b16 v[106:107], v15 offset:43008
    v_mfma_f32_16x16x32_bf16 v[48:51], v[80:83], v[248:251], v[48:51]
    ds_read_b64_tr_b16 v[108:109], v15 offset:45056
    v_mfma_f32_16x16x32_bf16 v[48:51], v[84:87], v[252:255], v[48:51]
    ds_read_b64_tr_b16 v[110:111], v15 offset:47104
    s_waitcnt lgkmcnt(8)
    v_mfma_f32_16x16x32_bf16 v[20:23], v[88:91], v[176:179], v[20:23]
    s_setprio 1
    ds_read_b64_tr_b16 v[80:81], v14 offset:512
    v_mfma_f32_16x16x32_bf16 v[20:23], v[92:95], v[180:183], v[20:23]
    ds_read_b64_tr_b16 v[82:83], v14 offset:2560
    v_mfma_f32_16x16x32_bf16 v[52:55], v[88:91], v[248:251], v[52:55]
    ds_read_b64_tr_b16 v[84:85], v14 offset:4608
    v_mfma_f32_16x16x32_bf16 v[52:55], v[92:95], v[252:255], v[52:55]
    ds_read_b64_tr_b16 v[86:87], v14 offset:6656
    s_waitcnt lgkmcnt(8)
    v_mfma_f32_16x16x32_bf16 v[24:27], v[96:99], v[176:179], v[24:27]
    ds_read_b64_tr_b16 v[88:89], v14 offset:25088
    v_mfma_f32_16x16x32_bf16 v[24:27], v[100:103], v[180:183], v[24:27]
    ds_read_b64_tr_b16 v[90:91], v14 offset:27136
    v_mfma_f32_16x16x32_bf16 v[56:59], v[96:99], v[248:251], v[56:59]
    ds_read_b64_tr_b16 v[92:93], v14 offset:29184
    v_mfma_f32_16x16x32_bf16 v[56:59], v[100:103], v[252:255], v[56:59]
    ds_read_b64_tr_b16 v[94:95], v14 offset:31232
    s_waitcnt lgkmcnt(8)
    v_mfma_f32_16x16x32_bf16 v[28:31], v[104:107], v[176:179], v[28:31]
    ds_read_b64_tr_b16 v[96:97], v15 offset:512
    v_mul_f32 v16, v16, v20
    v_mfma_f32_16x16x32_bf16 v[28:31], v[108:111], v[180:183], v[28:31]
    ds_read_b64_tr_b16 v[98:99], v15 offset:2560
    v_mul_f32 v17, v17, v21
    v_mfma_f32_16x16x32_bf16 v[60:63], v[104:107], v[248:251], v[60:63]
    ds_read_b64_tr_b16 v[100:101], v15 offset:4608
    v_mul_f32 v18, v18, v22
    v_mfma_f32_16x16x32_bf16 v[60:63], v[108:111], v[252:255], v[60:63]
    ds_read_b64_tr_b16 v[102:103], v15 offset:6656
    s_waitcnt lgkmcnt(8)
    v_mfma_f32_16x16x32_bf16 v[32:35], v[80:83], v[160:163], v[32:35]
    ds_read_b64_tr_b16 v[104:105], v15 offset:25088
    v_mul_f32 v19, v19, v23
    v_mfma_f32_16x16x32_bf16 v[32:35], v[84:87], v[164:167], v[32:35]
    ds_read_b64_tr_b16 v[106:107], v15 offset:27136
    v_cvt_pk_bf16_f32 v20, v16, v17
    v_mfma_f32_16x16x32_bf16 v[64:67], v[80:83], v[232:235], v[64:67]
    ds_read_b64_tr_b16 v[108:109], v15 offset:29184
    v_mfma_f32_16x16x32_bf16 v[64:67], v[84:87], v[236:239], v[64:67]
    ds_read_b64_tr_b16 v[110:111], v15 offset:31232
    s_waitcnt lgkmcnt(8)
    v_mfma_f32_16x16x32_bf16 v[36:39], v[88:91], v[160:163], v[36:39]
    ds_read_b64_tr_b16 v[80:81], v14 offset:8704
    v_cvt_pk_bf16_f32 v21, v18, v19
    v_mfma_f32_16x16x32_bf16 v[36:39], v[92:95], v[164:167], v[36:39]
    ds_read_b64_tr_b16 v[82:83], v14 offset:10752
    v_mul_f32 v48, v48, v52
    v_mfma_f32_16x16x32_bf16 v[68:71], v[88:91], v[232:235], v[68:71]
    ds_read_b64_tr_b16 v[84:85], v14 offset:12800
    v_mul_f32 v49, v49, v53
    v_mfma_f32_16x16x32_bf16 v[68:71], v[92:95], v[236:239], v[68:71]
    ds_read_b64_tr_b16 v[86:87], v14 offset:14848
    s_waitcnt lgkmcnt(8)
    v_mfma_f32_16x16x32_bf16 v[40:43], v[96:99], v[160:163], v[40:43]
    ds_read_b64_tr_b16 v[88:89], v14 offset:33280
    v_mul_f32 v50, v50, v54
    v_mfma_f32_16x16x32_bf16 v[40:43], v[100:103], v[164:167], v[40:43]
    ds_read_b64_tr_b16 v[90:91], v14 offset:35328
    v_mul_f32 v51, v51, v55
    v_mfma_f32_16x16x32_bf16 v[72:75], v[96:99], v[232:235], v[72:75]
    ds_read_b64_tr_b16 v[92:93], v14 offset:37376
    v_mfma_f32_16x16x32_bf16 v[72:75], v[100:103], v[236:239], v[72:75]
    ds_read_b64_tr_b16 v[94:95], v14 offset:39424
    s_waitcnt lgkmcnt(8)
    v_mfma_f32_16x16x32_bf16 v[44:47], v[104:107], v[160:163], v[44:47]
    s_setprio 0
    ds_read_b64_tr_b16 v[96:97], v15 offset:8704
    v_cvt_pk_bf16_f32 v52, v48, v49
    v_mfma_f32_16x16x32_bf16 v[44:47], v[108:111], v[164:167], v[44:47]
    ds_read_b64_tr_b16 v[98:99], v15 offset:10752
    v_cvt_pk_bf16_f32 v53, v50, v51
    v_mfma_f32_16x16x32_bf16 v[76:79], v[104:107], v[232:235], v[76:79]
    ds_read_b64_tr_b16 v[100:101], v15 offset:12800
    v_mfma_f32_16x16x32_bf16 v[76:79], v[108:111], v[236:239], v[76:79]
    ds_read_b64_tr_b16 v[102:103], v15 offset:14848
    s_waitcnt lgkmcnt(8)
    v_mfma_f32_16x16x32_bf16 v[32:35], v[80:83], v[168:171], v[32:35]
    ds_read_b64_tr_b16 v[104:105], v15 offset:33280
    v_mul_f32 v24, v24, v28
    v_mfma_f32_16x16x32_bf16 v[32:35], v[84:87], v[172:175], v[32:35]
    ds_read_b64_tr_b16 v[106:107], v15 offset:35328
    v_mul_f32 v25, v25, v29
    v_mfma_f32_16x16x32_bf16 v[64:67], v[80:83], v[240:243], v[64:67]
    ds_read_b64_tr_b16 v[108:109], v15 offset:37376
    v_mul_f32 v26, v26, v30
    v_mfma_f32_16x16x32_bf16 v[64:67], v[84:87], v[244:247], v[64:67]
    ds_read_b64_tr_b16 v[110:111], v15 offset:39424
    s_waitcnt lgkmcnt(8)
    v_mfma_f32_16x16x32_bf16 v[36:39], v[88:91], v[168:171], v[36:39]
    ds_read_b64_tr_b16 v[80:81], v14 offset:16896
    v_mul_f32 v27, v27, v31
    v_mfma_f32_16x16x32_bf16 v[36:39], v[92:95], v[172:175], v[36:39]
    ds_read_b64_tr_b16 v[82:83], v14 offset:18944
    v_cvt_pk_bf16_f32 v22, v24, v25
    v_mfma_f32_16x16x32_bf16 v[68:71], v[88:91], v[240:243], v[68:71]
    ds_read_b64_tr_b16 v[84:85], v14 offset:20992
    v_mfma_f32_16x16x32_bf16 v[68:71], v[92:95], v[244:247], v[68:71]
    ds_read_b64_tr_b16 v[86:87], v14 offset:23040
    s_waitcnt lgkmcnt(8)
    v_mfma_f32_16x16x32_bf16 v[40:43], v[96:99], v[168:171], v[40:43]
    ds_read_b64_tr_b16 v[88:89], v14 offset:41472
    v_cvt_pk_bf16_f32 v23, v26, v27
    v_mfma_f32_16x16x32_bf16 v[40:43], v[100:103], v[172:175], v[40:43]
    ds_read_b64_tr_b16 v[90:91], v14 offset:43520
    s_add_u32 s30, s61, 0
    buffer_store_dwordx4 v[20:23], v5, s[12:15], s30 offen offset:0 sc1
    v_mfma_f32_16x16x32_bf16 v[72:75], v[96:99], v[240:243], v[72:75]
    ds_read_b64_tr_b16 v[92:93], v14 offset:45568
    v_mfma_f32_16x16x32_bf16 v[72:75], v[100:103], v[244:247], v[72:75]
    ds_read_b64_tr_b16 v[94:95], v14 offset:47616
    s_waitcnt lgkmcnt(8)
    v_mfma_f32_16x16x32_bf16 v[44:47], v[104:107], v[168:171], v[44:47]
    ds_read_b64_tr_b16 v[96:97], v15 offset:16896
    v_mul_f32 v56, v56, v60
    v_mfma_f32_16x16x32_bf16 v[44:47], v[108:111], v[172:175], v[44:47]
    ds_read_b64_tr_b16 v[98:99], v15 offset:18944
    v_mul_f32 v57, v57, v61
    v_mfma_f32_16x16x32_bf16 v[76:79], v[104:107], v[240:243], v[76:79]
    ds_read_b64_tr_b16 v[100:101], v15 offset:20992
    v_mul_f32 v58, v58, v62
    v_mfma_f32_16x16x32_bf16 v[76:79], v[108:111], v[244:247], v[76:79]
    ds_read_b64_tr_b16 v[102:103], v15 offset:23040
    s_waitcnt lgkmcnt(8)
    v_mfma_f32_16x16x32_bf16 v[32:35], v[80:83], v[176:179], v[32:35]
    ds_read_b64_tr_b16 v[104:105], v15 offset:41472
    v_mul_f32 v59, v59, v63
    v_mfma_f32_16x16x32_bf16 v[32:35], v[84:87], v[180:183], v[32:35]
    ds_read_b64_tr_b16 v[106:107], v15 offset:43520
    v_cvt_pk_bf16_f32 v54, v56, v57
    v_mfma_f32_16x16x32_bf16 v[64:67], v[80:83], v[248:251], v[64:67]
    ds_read_b64_tr_b16 v[108:109], v15 offset:45568
    v_mov_b32 v4, 64
    s_cmp_lg_u32 s24, 0
    s_cbranch_scc1 LM_l04
    s_and_b32 s29, s27, 7
    s_lshl_b64 exec, 1, s29
    v_mov_b32 v4, 0
    buffer_atomic_or v4, v8, s[12:15], s8 offen sc0 sc1
    s_mov_b64 exec, -1
    LM_l04:
    v_mfma_f32_16x16x32_bf16 v[64:67], v[84:87], v[252:255], v[64:67]
    ds_read_b64_tr_b16 v[110:111], v15 offset:47616
    s_waitcnt lgkmcnt(8)
    v_mfma_f32_16x16x32_bf16 v[36:39], v[88:91], v[176:179], v[36:39]
    s_setprio 3
    s_waitcnt vmcnt(1)
    s_barrier
    v_add_u32 v14, 4294852608, v14
    v_add_u32 v15, 4294852608, v15
    ds_read_b64_tr_b16 v[80:81], v14 offset:0
    v_cvt_pk_bf16_f32 v55, v58, v59
    v_mfma_f32_16x16x32_bf16 v[36:39], v[92:95], v[180:183], v[36:39]
    ds_read_b64_tr_b16 v[82:83], v14 offset:2048
    s_add_u32 s30, s61, 147456
    buffer_store_dwordx4 v[52:55], v5, s[12:15], s30 offen offset:0 sc1
    v_mfma_f32_16x16x32_bf16 v[68:71], v[88:91], v[248:251], v[68:71]
    ds_read_b64_tr_b16 v[84:85], v14 offset:4096
    v_mfma_f32_16x16x32_bf16 v[68:71], v[92:95], v[252:255], v[68:71]
    ds_read_b64_tr_b16 v[86:87], v14 offset:6144
    s_waitcnt lgkmcnt(8)
    v_mfma_f32_16x16x32_bf16 v[40:43], v[96:99], v[176:179], v[40:43]
    ds_read_b64_tr_b16 v[88:89], v14 offset:8192
    s_add_u32 m0, s35, 49152
    s_add_u32 s29, s32, 1769472
    buffer_load_dwordx4 v9, s[16:19], s29 offen lds
    v_mfma_f32_16x16x32_bf16 v[40:43], v[100:103], v[180:183], v[40:43]
    ds_read_b64_tr_b16 v[90:91], v14 offset:10240
    v_mfma_f32_16x16x32_bf16 v[72:75], v[96:99], v[248:251], v[72:75]
    ds_read_b64_tr_b16 v[92:93], v14 offset:12288
    v_mfma_f32_16x16x32_bf16 v[72:75], v[100:103], v[252:255], v[72:75]
    ds_read_b64_tr_b16 v[94:95], v14 offset:14336
    s_waitcnt lgkmcnt(8)
    v_mfma_f32_16x16x32_bf16 v[44:47], v[104:107], v[176:179], v[44:47]
    ds_read_b64_tr_b16 v[96:97], v14 offset:16384
    v_mul_f32 v32, v32, v36
    v_mfma_f32_16x16x32_bf16 v[44:47], v[108:111], v[180:183], v[44:47]
    ds_read_b64_tr_b16 v[98:99], v14 offset:18432
    v_mul_f32 v33, v33, v37
    v_mfma_f32_16x16x32_bf16 v[76:79], v[104:107], v[248:251], v[76:79]
    ds_read_b64_tr_b16 v[100:101], v14 offset:20480
    v_mul_f32 v34, v34, v38
    v_mfma_f32_16x16x32_bf16 v[76:79], v[108:111], v[252:255], v[76:79]
    ds_read_b64_tr_b16 v[102:103], v14 offset:22528
    s_add_u32 m0, s35, 53248
    s_add_u32 s29, s32, 2064384
    buffer_load_dwordx4 v9, s[16:19], s29 offen lds
    s_waitcnt lgkmcnt(8)
    v_mfma_f32_16x16x32_bf16 v[16:19], v[80:83], v[112:115], 0
    ds_read_b64_tr_b16 v[104:105], v14 offset:24576
    v_mul_f32 v35, v35, v39
    v_mfma_f32_16x16x32_bf16 v[16:19], v[84:87], v[116:119], v[16:19]
    ds_read_b64_tr_b16 v[106:107], v14 offset:26624
    v_cvt_pk_bf16_f32 v36, v32, v33
    v_mfma_f32_16x16x32_bf16 v[48:51], v[80:83], v[184:187], 0
    ds_read_b64_tr_b16 v[108:109], v14 offset:28672
    s_add_u32 m0, s35, 57344
    s_add_u32 s29, s32, 2359296
    buffer_load_dwordx4 v9, s[16:19], s29 offen lds
    v_mfma_f32_16x16x32_bf16 v[48:51], v[84:87], v[188:191], v[48:51]
    ds_read_b64_tr_b16 v[110:111], v14 offset:30720
    s_waitcnt lgkmcnt(8)
    v_mfma_f32_16x16x32_bf16 v[48:51], v[88:91], v[192:195], v[48:51]
    ds_read_b64_tr_b16 v[80:81], v14 offset:32768
    v_cvt_pk_bf16_f32 v37, v34, v35
    v_mfma_f32_16x16x32_bf16 v[48:51], v[92:95], v[196:199], v[48:51]
    ds_read_b64_tr_b16 v[82:83], v14 offset:34816
    v_mul_f32 v64, v64, v68
    v_mfma_f32_16x16x32_bf16 v[16:19], v[88:91], v[120:123], v[16:19]
    ds_read_b64_tr_b16 v[84:85], v14 offset:36864
    v_mul_f32 v65, v65, v69
    v_mfma_f32_16x16x32_bf16 v[16:19], v[92:95], v[124:127], v[16:19]
    ds_read_b64_tr_b16 v[86:87], v14 offset:38912
    s_add_u32 m0, s35, 61440
    s_add_u32 s29, s32, 2654208
    buffer_load_dwordx4 v9, s[16:19], s29 offen lds
    s_waitcnt lgkmcnt(8)
    v_mfma_f32_16x16x32_bf16 v[16:19], v[96:99], v[128:131], v[16:19]
    ds_read_b64_tr_b16 v[88:89], v14 offset:40960
    v_mul_f32 v66, v66, v70
    v_mfma_f32_16x16x32_bf16 v[16:19], v[100:103], v[132:135], v[16:19]
    ds_read_b64_tr_b16 v[90:91], v14 offset:43008
    v_mul_f32 v67, v67, v71
    v_mfma_f32_16x16x32_bf16 v[48:51], v[96:99], v[200:203], v[48:51]
    ds_read_b64_tr_b16 v[92:93], v14 offset:45056
    s_add_u32 m0, s35, 65536
    s_add_u32 s29, s32, 2949120
    buffer_load_dwordx4 v9, s[16:19], s29 offen lds
    v_mfma_f32_16x16x32_bf16 v[48:51], v[100:103], v[204:207], v[48:51]
    ds_read_b64_tr_b16 v[94:95], v14 offset:47104
    s_waitcnt lgkmcnt(8)
    v_mfma_f32_16x16x32_bf16 v[20:23], v[104:107], v[112:115], 0
    s_setprio 2
    ds_read_b64_tr_b16 v[96:97], v15 offset:0
    v_cvt_pk_bf16_f32 v68, v64, v65
    v_mfma_f32_16x16x32_bf16 v[20:23], v[108:111], v[116:119], v[20:23]
    ds_read_b64_tr_b16 v[98:99], v15 offset:2048
    v_cvt_pk_bf16_f32 v69, v66, v67
    v_mfma_f32_16x16x32_bf16 v[52:55], v[104:107], v[184:187], 0
    ds_read_b64_tr_b16 v[100:101], v15 offset:4096
    s_add_u32 m0, s35, 69632
    s_add_u32 s29, s32, 3244032
    buffer_load_dwordx4 v9, s[16:19], s29 offen lds
    v_mfma_f32_16x16x32_bf16 v[52:55], v[108:111], v[188:191], v[52:55]
    ds_read_b64_tr_b16 v[102:103], v15 offset:6144
    s_waitcnt lgkmcnt(8)
    v_mfma_f32_16x16x32_bf16 v[52:55], v[80:83], v[192:195], v[52:55]
    ds_read_b64_tr_b16 v[104:105], v15 offset:8192
    v_mul_f32 v40, v40, v44
    v_mfma_f32_16x16x32_bf16 v[52:55], v[84:87], v[196:199], v[52:55]
    ds_read_b64_tr_b16 v[106:107], v15 offset:10240
    v_mul_f32 v41, v41, v45
    v_mfma_f32_16x16x32_bf16 v[20:23], v[80:83], v[120:123], v[20:23]
    ds_read_b64_tr_b16 v[108:109], v15 offset:12288
    v_mul_f32 v42, v42, v46
    v_mfma_f32_16x16x32_bf16 v[20:23], v[84:87], v[124:127], v[20:23]
    ds_read_b64_tr_b16 v[110:111], v15 offset:14336
    s_waitcnt lgkmcnt(8)
    v_mfma_f32_16x16x32_bf16 v[20:23], v[88:91], v[128:131], v[20:23]
    ds_read_b64_tr_b16 v[80:81], v15 offset:16384
    v_mul_f32 v43, v43, v47
    v_mfma_f32_16x16x32_bf16 v[20:23], v[92:95], v[132:135], v[20:23]
    ds_read_b64_tr_b16 v[82:83], v15 offset:18432
    v_cvt_pk_bf16_f32 v38, v40, v41
    v_mfma_f32_16x16x32_bf16 v[52:55], v[88:91], v[200:203], v[52:55]
    ds_read_b64_tr_b16 v[84:85], v15 offset:20480
    v_mfma_f32_16x16x32_bf16 v[52:55], v[92:95], v[204:207], v[52:55]
    ds_read_b64_tr_b16 v[86:87], v15 offset:22528
    s_waitcnt lgkmcnt(8)
    v_mfma_f32_16x16x32_bf16 v[24:27], v[96:99], v[112:115], 0
    ds_read_b64_tr_b16 v[88:89], v15 offset:24576
    v_cvt_pk_bf16_f32 v39, v42, v43
    v_mfma_f32_16x16x32_bf16 v[24:27], v[100:103], v[116:119], v[24:27]
    ds_read_b64_tr_b16 v[90:91], v15 offset:26624
    s_add_u32 s30, s61, 0
    buffer_store_dwordx4 v[36:39], v5, s[12:15], s30 offen offset:1024 sc1
    v_mfma_f32_16x16x32_bf16 v[56:59], v[96:99], v[184:187], 0
    ds_read_b64_tr_b16 v[92:93], v15 offset:28672
    v_mfma_f32_16x16x32_bf16 v[56:59], v[100:103], v[188:191], v[56:59]
    ds_read_b64_tr_b16 v[94:95], v15 offset:30720
    s_waitcnt lgkmcnt(8)
    v_mfma_f32_16x16x32_bf16 v[56:59], v[104:107], v[192:195], v[56:59]
    ds_read_b64_tr_b16 v[96:97], v15 offset:32768
    v_mul_f32 v72, v72, v76
    v_mfma_f32_16x16x32_bf16 v[56:59], v[108:111], v[196:199], v[56:59]
    ds_read_b64_tr_b16 v[98:99], v15 offset:34816
    v_mul_f32 v73, v73, v77
    v_mfma_f32_16x16x32_bf16 v[24:27], v[104:107], v[120:123], v[24:27]
    ds_read_b64_tr_b16 v[100:101], v15 offset:36864
    v_mul_f32 v74, v74, v78
    v_mfma_f32_16x16x32_bf16 v[24:27], v[108:111], v[124:127], v[24:27]
    ds_read_b64_tr_b16 v[102:103], v15 offset:38912
    s_waitcnt lgkmcnt(8)
    v_mfma_f32_16x16x32_bf16 v[24:27], v[80:83], v[128:131], v[24:27]
    ds_read_b64_tr_b16 v[104:105], v15 offset:40960
    v_mul_f32 v75, v75, v79
    v_mfma_f32_16x16x32_bf16 v[24:27], v[84:87], v[132:135], v[24:27]
    ds_read_b64_tr_b16 v[106:107], v15 offset:43008
    v_cvt_pk_bf16_f32 v70, v72, v73
    v_mfma_f32_16x16x32_bf16 v[56:59], v[80:83], v[200:203], v[56:59]
    ds_read_b64_tr_b16 v[108:109], v15 offset:45056
    v_mfma_f32_16x16x32_bf16 v[56:59], v[84:87], v[204:207], v[56:59]
    ds_read_b64_tr_b16 v[110:111], v15 offset:47104
    s_waitcnt lgkmcnt(8)
    v_mfma_f32_16x16x32_bf16 v[28:31], v[88:91], v[112:115], 0
    s_setprio 1
    ds_read_b64_tr_b16 v[80:81], v14 offset:512
    v_cvt_pk_bf16_f32 v71, v74, v75
    v_mfma_f32_16x16x32_bf16 v[28:31], v[92:95], v[116:119], v[28:31]
    ds_read_b64_tr_b16 v[82:83], v14 offset:2560
    s_add_u32 s30, s61, 147456
    buffer_store_dwordx4 v[68:71], v5, s[12:15], s30 offen offset:1024 sc1
    v_mfma_f32_16x16x32_bf16 v[60:63], v[88:91], v[184:187], 0
    ds_read_b64_tr_b16 v[84:85], v14 offset:4608
    v_mfma_f32_16x16x32_bf16 v[60:63], v[92:95], v[188:191], v[60:63]
    ds_read_b64_tr_b16 v[86:87], v14 offset:6656
    s_waitcnt lgkmcnt(8)
    v_mfma_f32_16x16x32_bf16 v[60:63], v[96:99], v[192:195], v[60:63]
    ds_read_b64_tr_b16 v[88:89], v14 offset:8704
    v_mfma_f32_16x16x32_bf16 v[60:63], v[100:103], v[196:199], v[60:63]
    ds_read_b64_tr_b16 v[90:91], v14 offset:10752
    v_mfma_f32_16x16x32_bf16 v[28:31], v[96:99], v[120:123], v[28:31]
    ds_read_b64_tr_b16 v[92:93], v14 offset:12800
    v_mfma_f32_16x16x32_bf16 v[28:31], v[100:103], v[124:127], v[28:31]
    ds_read_b64_tr_b16 v[94:95], v14 offset:14848
    s_waitcnt lgkmcnt(8)
    v_mfma_f32_16x16x32_bf16 v[28:31], v[104:107], v[128:131], v[28:31]
    ds_read_b64_tr_b16 v[96:97], v14 offset:16896
    v_mfma_f32_16x16x32_bf16 v[28:31], v[108:111], v[132:135], v[28:31]
    ds_read_b64_tr_b16 v[98:99], v14 offset:18944
    v_mfma_f32_16x16x32_bf16 v[60:63], v[104:107], v[200:203], v[60:63]
    ds_read_b64_tr_b16 v[100:101], v14 offset:20992
    v_mfma_f32_16x16x32_bf16 v[60:63], v[108:111], v[204:207], v[60:63]
    ds_read_b64_tr_b16 v[102:103], v14 offset:23040
    s_waitcnt lgkmcnt(8)
    v_mfma_f32_16x16x32_bf16 v[32:35], v[80:83], v[112:115], 0
    ds_read_b64_tr_b16 v[104:105], v14 offset:25088
    v_mfma_f32_16x16x32_bf16 v[32:35], v[84:87], v[116:119], v[32:35]
    ds_read_b64_tr_b16 v[106:107], v14 offset:27136
    v_mfma_f32_16x16x32_bf16 v[64:67], v[80:83], v[184:187], 0
    ds_read_b64_tr_b16 v[108:109], v14 offset:29184
    v_mfma_f32_16x16x32_bf16 v[64:67], v[84:87], v[188:191], v[64:67]
    ds_read_b64_tr_b16 v[110:111], v14 offset:31232
    s_waitcnt lgkmcnt(8)
    v_mfma_f32_16x16x32_bf16 v[64:67], v[88:91], v[192:195], v[64:67]
    ds_read_b64_tr_b16 v[80:81], v14 offset:33280
    v_mfma_f32_16x16x32_bf16 v[64:67], v[92:95], v[196:199], v[64:67]
    ds_read_b64_tr_b16 v[82:83], v14 offset:35328
    v_mfma_f32_16x16x32_bf16 v[32:35], v[88:91], v[120:123], v[32:35]
    ds_read_b64_tr_b16 v[84:85], v14 offset:37376
    v_mfma_f32_16x16x32_bf16 v[32:35], v[92:95], v[124:127], v[32:35]
    ds_read_b64_tr_b16 v[86:87], v14 offset:39424
    s_waitcnt lgkmcnt(8)
    v_mfma_f32_16x16x32_bf16 v[32:35], v[96:99], v[128:131], v[32:35]
    ds_read_b64_tr_b16 v[88:89], v14 offset:41472
    v_mfma_f32_16x16x32_bf16 v[32:35], v[100:103], v[132:135], v[32:35]
    ds_read_b64_tr_b16 v[90:91], v14 offset:43520
    v_mfma_f32_16x16x32_bf16 v[64:67], v[96:99], v[200:203], v[64:67]
    ds_read_b64_tr_b16 v[92:93], v14 offset:45568
    v_mfma_f32_16x16x32_bf16 v[64:67], v[100:103], v[204:207], v[64:67]
    ds_read_b64_tr_b16 v[94:95], v14 offset:47616
    s_waitcnt lgkmcnt(8)
    v_mfma_f32_16x16x32_bf16 v[36:39], v[104:107], v[112:115], 0
    s_setprio 0
    ds_read_b64_tr_b16 v[96:97], v15 offset:512
    v_mfma_f32_16x16x32_bf16 v[36:39], v[108:111], v[116:119], v[36:39]
    ds_read_b64_tr_b16 v[98:99], v15 offset:2560
    v_mfma_f32_16x16x32_bf16 v[68:71], v[104:107], v[184:187], 0
    ds_read_b64_tr_b16 v[100:101], v15 offset:4608
    v_mfma_f32_16x16x32_bf16 v[68:71], v[108:111], v[188:191], v[68:71]
    ds_read_b64_tr_b16 v[102:103], v15 offset:6656
    s_waitcnt lgkmcnt(8)
    v_mfma_f32_16x16x32_bf16 v[68:71], v[80:83], v[192:195], v[68:71]
    ds_read_b64_tr_b16 v[104:105], v15 offset:8704
    v_mfma_f32_16x16x32_bf16 v[68:71], v[84:87], v[196:199], v[68:71]
    ds_read_b64_tr_b16 v[106:107], v15 offset:10752
    v_mfma_f32_16x16x32_bf16 v[36:39], v[80:83], v[120:123], v[36:39]
    ds_read_b64_tr_b16 v[108:109], v15 offset:12800
    v_mfma_f32_16x16x32_bf16 v[36:39], v[84:87], v[124:127], v[36:39]
    ds_read_b64_tr_b16 v[110:111], v15 offset:14848
    s_waitcnt lgkmcnt(8)
    v_mfma_f32_16x16x32_bf16 v[36:39], v[88:91], v[128:131], v[36:39]
    ds_read_b64_tr_b16 v[80:81], v15 offset:16896
    v_mfma_f32_16x16x32_bf16 v[36:39], v[92:95], v[132:135], v[36:39]
    ds_read_b64_tr_b16 v[82:83], v15 offset:18944
    v_mfma_f32_16x16x32_bf16 v[68:71], v[88:91], v[200:203], v[68:71]
    ds_read_b64_tr_b16 v[84:85], v15 offset:20992
    v_mfma_f32_16x16x32_bf16 v[68:71], v[92:95], v[204:207], v[68:71]
    ds_read_b64_tr_b16 v[86:87], v15 offset:23040
    s_waitcnt lgkmcnt(8)
    v_mfma_f32_16x16x32_bf16 v[40:43], v[96:99], v[112:115], 0
    ds_read_b64_tr_b16 v[88:89], v15 offset:25088
    v_mfma_f32_16x16x32_bf16 v[40:43], v[100:103], v[116:119], v[40:43]
    ds_read_b64_tr_b16 v[90:91], v15 offset:27136
    v_mfma_f32_16x16x32_bf16 v[72:75], v[96:99], v[184:187], 0
    ds_read_b64_tr_b16 v[92:93], v15 offset:29184
    v_mfma_f32_16x16x32_bf16 v[72:75], v[100:103], v[188:191], v[72:75]
    ds_read_b64_tr_b16 v[94:95], v15 offset:31232
    s_waitcnt lgkmcnt(8)
    v_mfma_f32_16x16x32_bf16 v[72:75], v[104:107], v[192:195], v[72:75]
    ds_read_b64_tr_b16 v[96:97], v15 offset:33280
    v_mfma_f32_16x16x32_bf16 v[72:75], v[108:111], v[196:199], v[72:75]
    ds_read_b64_tr_b16 v[98:99], v15 offset:35328
    v_mfma_f32_16x16x32_bf16 v[40:43], v[104:107], v[120:123], v[40:43]
    ds_read_b64_tr_b16 v[100:101], v15 offset:37376
    v_mfma_f32_16x16x32_bf16 v[40:43], v[108:111], v[124:127], v[40:43]
    ds_read_b64_tr_b16 v[102:103], v15 offset:39424
    s_waitcnt lgkmcnt(8)
    v_mfma_f32_16x16x32_bf16 v[40:43], v[80:83], v[128:131], v[40:43]
    ds_read_b64_tr_b16 v[104:105], v15 offset:41472
    v_mfma_f32_16x16x32_bf16 v[40:43], v[84:87], v[132:135], v[40:43]
    ds_read_b64_tr_b16 v[106:107], v15 offset:43520
    v_mfma_f32_16x16x32_bf16 v[72:75], v[80:83], v[200:203], v[72:75]
    ds_read_b64_tr_b16 v[108:109], v15 offset:45568
    v_mfma_f32_16x16x32_bf16 v[72:75], v[84:87], v[204:207], v[72:75]
    ds_read_b64_tr_b16 v[110:111], v15 offset:47616
    s_waitcnt lgkmcnt(8)
    v_mfma_f32_16x16x32_bf16 v[44:47], v[88:91], v[112:115], 0
    s_setprio 3
    s_waitcnt vmcnt(2)
    LM_chk5:
    v_cmp_gt_u32 vcc, 64, v4
    s_cbranch_vccnz LM_retry5
    LM_ok5:
    s_barrier
    v_add_u32 v14, 49152, v14
    v_add_u32 v15, 49152, v15
    ds_read_b64_tr_b16 v[80:81], v14 offset:0
    v_mfma_f32_16x16x32_bf16 v[44:47], v[92:95], v[116:119], v[44:47]
    ds_read_b64_tr_b16 v[82:83], v14 offset:2048
    v_mfma_f32_16x16x32_bf16 v[76:79], v[88:91], v[184:187], 0
    ds_read_b64_tr_b16 v[84:85], v14 offset:4096
    v_mfma_f32_16x16x32_bf16 v[76:79], v[92:95], v[188:191], v[76:79]
    ds_read_b64_tr_b16 v[86:87], v14 offset:6144
    s_waitcnt lgkmcnt(8)
    v_mfma_f32_16x16x32_bf16 v[76:79], v[96:99], v[192:195], v[76:79]
    ds_read_b64_tr_b16 v[88:89], v14 offset:8192
    s_add_u32 m0, s35, 114688
    s_add_u32 s29, s32, 3538944
    buffer_load_dwordx4 v9, s[16:19], s29 offen lds
    v_mfma_f32_16x16x32_bf16 v[76:79], v[100:103], v[196:199], v[76:79]
    ds_read_b64_tr_b16 v[90:91], v14 offset:10240
    v_mfma_f32_16x16x32_bf16 v[44:47], v[96:99], v[120:123], v[44:47]
    ds_read_b64_tr_b16 v[92:93], v14 offset:12288
    v_mfma_f32_16x16x32_bf16 v[44:47], v[100:103], v[124:127], v[44:47]
    ds_read_b64_tr_b16 v[94:95], v14 offset:14336
    s_waitcnt lgkmcnt(8)
    v_mfma_f32_16x16x32_bf16 v[44:47], v[104:107], v[128:131], v[44:47]
    ds_read_b64_tr_b16 v[96:97], v14 offset:16384
    v_mfma_f32_16x16x32_bf16 v[44:47], v[108:111], v[132:135], v[44:47]
    ds_read_b64_tr_b16 v[98:99], v14 offset:18432
    v_mfma_f32_16x16x32_bf16 v[76:79], v[104:107], v[200:203], v[76:79]
    ds_read_b64_tr_b16 v[100:101], v14 offset:20480
    v_mfma_f32_16x16x32_bf16 v[76:79], v[108:111], v[204:207], v[76:79]
    ds_read_b64_tr_b16 v[102:103], v14 offset:22528
    s_waitcnt lgkmcnt(8)
    v_mfma_f32_16x16x32_bf16 v[16:19], v[80:83], v[136:139], v[16:19]
    ds_read_b64_tr_b16 v[104:105], v14 offset:24576
    s_add_u32 m0, s35, 118784
    s_add_u32 s29, s32, 3833856
    buffer_load_dwordx4 v9, s[16:19], s29 offen lds
    v_mfma_f32_16x16x32_bf16 v[16:19], v[84:87], v[140:143], v[16:19]
    ds_read_b64_tr_b16 v[106:107], v14 offset:26624
    v_mfma_f32_16x16x32_bf16 v[48:51], v[80:83], v[208:211], v[48:51]
    ds_read_b64_tr_b16 v[108:109], v14 offset:28672
    v_mfma_f32_16x16x32_bf16 v[48:51], v[84:87], v[212:215], v[48:51]
    ds_read_b64_tr_b16 v[110:111], v14 offset:30720
    s_waitcnt lgkmcnt(8)
    v_mfma_f32_16x16x32_bf16 v[48:51], v[88:91], v[216:219], v[48:51]
    ds_read_b64_tr_b16 v[80:81], v14 offset:32768
    v_mfma_f32_16x16x32_bf16 v[48:51], v[92:95], v[220:223], v[48:51]
    ds_read_b64_tr_b16 v[82:83], v14 offset:34816
    v_mfma_f32_16x16x32_bf16 v[16:19], v[88:91], v[144:147], v[16:19]
    ds_read_b64_tr_b16 v[84:85], v14 offset:36864
    v_mfma_f32_16x16x32_bf16 v[16:19], v[92:95], v[148:151], v[16:19]
    ds_read_b64_tr_b16 v[86:87], v14 offset:38912
    s_waitcnt lgkmcnt(8)
    v_mfma_f32_16x16x32_bf16 v[16:19], v[96:99], v[152:155], v[16:19]
    ds_read_b64_tr_b16 v[88:89], v14 offset:40960
    s_add_u32 m0, s35, 122880
    s_add_u32 s29, s32, 4128768
    buffer_load_dwordx4 v9, s[16:19], s29 offen lds
    v_mfma_f32_16x16x32_bf16 v[16:19], v[100:103], v[156:159], v[16:19]
    ds_read_b64_tr_b16 v[90:91], v14 offset:43008
    v_mfma_f32_16x16x32_bf16 v[48:51], v[96:99], v[224:227], v[48:51]
    ds_read_b64_tr_b16 v[92:93], v14 offset:45056
    v_mfma_f32_16x16x32_bf16 v[48:51], v[100:103], v[228:231], v[48:51]
    ds_read_b64_tr_b16 v[94:95], v14 offset:47104
    s_waitcnt lgkmcnt(8)
    v_mfma_f32_16x16x32_bf16 v[20:23], v[104:107], v[136:139], v[20:23]
    s_setprio 2
    ds_read_b64_tr_b16 v[96:97], v15 offset:0
    v_mfma_f32_16x16x32_bf16 v[20:23], v[108:111], v[140:143], v[20:23]
    ds_read_b64_tr_b16 v[98:99], v15 offset:2048
    v_mfma_f32_16x16x32_bf16 v[52:55], v[104:107], v[208:211], v[52:55]
    ds_read_b64_tr_b16 v[100:101], v15 offset:4096
    v_mfma_f32_16x16x32_bf16 v[52:55], v[108:111], v[212:215], v[52:55]
    ds_read_b64_tr_b16 v[102:103], v15 offset:6144
    s_waitcnt lgkmcnt(8)
    v_mfma_f32_16x16x32_bf16 v[52:55], v[80:83], v[216:219], v[52:55]
    ds_read_b64_tr_b16 v[104:105], v15 offset:8192
    s_add_u32 m0, s35, 126976
    s_add_u32 s29, s32, 4423680
    buffer_load_dwordx4 v9, s[16:19], s29 offen lds
    v_mfma_f32_16x16x32_bf16 v[52:55], v[84:87], v[220:223], v[52:55]
    ds_read_b64_tr_b16 v[106:107], v15 offset:10240
    v_mfma_f32_16x16x32_bf16 v[20:23], v[80:83], v[144:147], v[20:23]
    ds_read_b64_tr_b16 v[108:109], v15 offset:12288
    v_mfma_f32_16x16x32_bf16 v[20:23], v[84:87], v[148:151], v[20:23]
    ds_read_b64_tr_b16 v[110:111], v15 offset:14336
    s_waitcnt lgkmcnt(8)
    v_mfma_f32_16x16x32_bf16 v[20:23], v[88:91], v[152:155], v[20:23]
    ds_read_b64_tr_b16 v[80:81], v15 offset:16384
    v_mfma_f32_16x16x32_bf16 v[20:23], v[92:95], v[156:159], v[20:23]
    ds_read_b64_tr_b16 v[82:83], v15 offset:18432
    v_mfma_f32_16x16x32_bf16 v[52:55], v[88:91], v[224:227], v[52:55]
    ds_read_b64_tr_b16 v[84:85], v15 offset:20480
    v_mfma_f32_16x16x32_bf16 v[52:55], v[92:95], v[228:231], v[52:55]
    ds_read_b64_tr_b16 v[86:87], v15 offset:22528
    s_waitcnt lgkmcnt(8)
    v_mfma_f32_16x16x32_bf16 v[24:27], v[96:99], v[136:139], v[24:27]
    ds_read_b64_tr_b16 v[88:89], v15 offset:24576
    s_add_u32 m0, s35, 131072
    s_add_u32 s29, s33, 4718592
    buffer_load_dwordx4 v10, s[16:19], s29 offen lds
    v_mfma_f32_16x16x32_bf16 v[24:27], v[100:103], v[140:143], v[24:27]
    ds_read_b64_tr_b16 v[90:91], v15 offset:26624
    v_mfma_f32_16x16x32_bf16 v[56:59], v[96:99], v[208:211], v[56:59]
    ds_read_b64_tr_b16 v[92:93], v15 offset:28672
    v_mfma_f32_16x16x32_bf16 v[56:59], v[100:103], v[212:215], v[56:59]
    ds_read_b64_tr_b16 v[94:95], v15 offset:30720
    s_waitcnt lgkmcnt(8)
    v_mfma_f32_16x16x32_bf16 v[56:59], v[104:107], v[216:219], v[56:59]
    ds_read_b64_tr_b16 v[96:97], v15 offset:32768
    v_mfma_f32_16x16x32_bf16 v[56:59], v[108:111], v[220:223], v[56:59]
    ds_read_b64_tr_b16 v[98:99], v15 offset:34816
    v_mfma_f32_16x16x32_bf16 v[24:27], v[104:107], v[144:147], v[24:27]
    ds_read_b64_tr_b16 v[100:101], v15 offset:36864
    v_mfma_f32_16x16x32_bf16 v[24:27], v[108:111], v[148:151], v[24:27]
    ds_read_b64_tr_b16 v[102:103], v15 offset:38912
    s_waitcnt lgkmcnt(8)
    v_mfma_f32_16x16x32_bf16 v[24:27], v[80:83], v[152:155], v[24:27]
    ds_read_b64_tr_b16 v[104:105], v15 offset:40960
    s_add_u32 m0, s35, 135168
    s_add_u32 s29, s33, 5013504
    buffer_load_dwordx4 v10, s[16:19], s29 offen lds
    v_mfma_f32_16x16x32_bf16 v[24:27], v[84:87], v[156:159], v[24:27]
    ds_read_b64_tr_b16 v[106:107], v15 offset:43008
    v_mfma_f32_16x16x32_bf16 v[56:59], v[80:83], v[224:227], v[56:59]
    ds_read_b64_tr_b16 v[108:109], v15 offset:45056
    v_mfma_f32_16x16x32_bf16 v[56:59], v[84:87], v[228:231], v[56:59]
    ds_read_b64_tr_b16 v[110:111], v15 offset:47104
    s_waitcnt lgkmcnt(8)
    v_mfma_f32_16x16x32_bf16 v[28:31], v[88:91], v[136:139], v[28:31]
    s_setprio 1
    ds_read_b64_tr_b16 v[80:81], v14 offset:512
    v_mfma_f32_16x16x32_bf16 v[28:31], v[92:95], v[140:143], v[28:31]
    ds_read_b64_tr_b16 v[82:83], v14 offset:2560
    v_mfma_f32_16x16x32_bf16 v[60:63], v[88:91], v[208:211], v[60:63]
    ds_read_b64_tr_b16 v[84:85], v14 offset:4608
    v_mfma_f32_16x16x32_bf16 v[60:63], v[92:95], v[212:215], v[60:63]
    ds_read_b64_tr_b16 v[86:87], v14 offset:6656
    s_waitcnt lgkmcnt(8)
    v_mfma_f32_16x16x32_bf16 v[60:63], v[96:99], v[216:219], v[60:63]
    ds_read_b64_tr_b16 v[88:89], v14 offset:8704
    s_mov_b64 exec, 0x3fff
    buffer_load_dword v3, v8, s[12:15], s58 offen offset:0 sc1
    s_mov_b64 exec, -1
    v_mfma_f32_16x16x32_bf16 v[60:63], v[100:103], v[220:223], v[60:63]
    ds_read_b64_tr_b16 v[90:91], v14 offset:10752
    v_mfma_f32_16x16x32_bf16 v[28:31], v[96:99], v[144:147], v[28:31]
    ds_read_b64_tr_b16 v[92:93], v14 offset:12800
    v_mfma_f32_16x16x32_bf16 v[28:31], v[100:103], v[148:151], v[28:31]
    ds_read_b64_tr_b16 v[94:95], v14 offset:14848
    s_waitcnt lgkmcnt(8)
    v_mfma_f32_16x16x32_bf16 v[28:31], v[104:107], v[152:155], v[28:31]
    ds_read_b64_tr_b16 v[96:97], v14 offset:16896
    v_mfma_f32_16x16x32_bf16 v[28:31], v[108:111], v[156:159], v[28:31]
    ds_read_b64_tr_b16 v[98:99], v14 offset:18944
    v_mfma_f32_16x16x32_bf16 v[60:63], v[104:107], v[224:227], v[60:63]
    ds_read_b64_tr_b16 v[100:101], v14 offset:20992
    v_mfma_f32_16x16x32_bf16 v[60:63], v[108:111], v[228:231], v[60:63]
    ds_read_b64_tr_b16 v[102:103], v14 offset:23040
    s_waitcnt lgkmcnt(8)
    v_mfma_f32_16x16x32_bf16 v[32:35], v[80:83], v[136:139], v[32:35]
    ds_read_b64_tr_b16 v[104:105], v14 offset:25088
    v_mfma_f32_16x16x32_bf16 v[32:35], v[84:87], v[140:143], v[32:35]
    ds_read_b64_tr_b16 v[106:107], v14 offset:27136
    v_mfma_f32_16x16x32_bf16 v[64:67], v[80:83], v[208:211], v[64:67]
    ds_read_b64_tr_b16 v[108:109], v14 offset:29184
    v_mfma_f32_16x16x32_bf16 v[64:67], v[84:87], v[212:215], v[64:67]
    ds_read_b64_tr_b16 v[110:111], v14 offset:31232
    s_waitcnt lgkmcnt(8)
    v_mfma_f32_16x16x32_bf16 v[64:67], v[88:91], v[216:219], v[64:67]
    ds_read_b64_tr_b16 v[80:81], v14 offset:33280
    v_mfma_f32_16x16x32_bf16 v[64:67], v[92:95], v[220:223], v[64:67]
    ds_read_b64_tr_b16 v[82:83], v14 offset:35328
    v_mfma_f32_16x16x32_bf16 v[32:35], v[88:91], v[144:147], v[32:35]
    ds_read_b64_tr_b16 v[84:85], v14 offset:37376
    v_mfma_f32_16x16x32_bf16 v[32:35], v[92:95], v[148:151], v[32:35]
    ds_read_b64_tr_b16 v[86:87], v14 offset:39424
    s_waitcnt lgkmcnt(8)
    v_mfma_f32_16x16x32_bf16 v[32:35], v[96:99], v[152:155], v[32:35]
    ds_read_b64_tr_b16 v[88:89], v14 offset:41472
    s_mov_b64 exec, 0x3fff
    buffer_load_dword v3, v8, s[12:15], s58 offen offset:1792 sc1
    s_mov_b64 exec, -1
    v_mfma_f32_16x16x32_bf16 v[32:35], v[100:103], v[156:159], v[32:35]
    ds_read_b64_tr_b16 v[90:91], v14 offset:43520
    v_mfma_f32_16x16x32_bf16 v[64:67], v[96:99], v[224:227], v[64:67]
    ds_read_b64_tr_b16 v[92:93], v14 offset:45568
    v_mfma_f32_16x16x32_bf16 v[64:67], v[100:103], v[228:231], v[64:67]
    ds_read_b64_tr_b16 v[94:95], v14 offset:47616
    s_waitcnt lgkmcnt(8)
    v_mfma_f32_16x16x32_bf16 v[36:39], v[104:107], v[136:139], v[36:39]
    s_setprio 0
    ds_read_b64_tr_b16 v[96:97], v15 offset:512
    v_mfma_f32_16x16x32_bf16 v[36:39], v[108:111], v[140:143], v[36:39]
    ds_read_b64_tr_b16 v[98:99], v15 offset:2560
    v_mfma_f32_16x16x32_bf16 v[68:71], v[104:107], v[208:211], v[68:71]
    ds_read_b64_tr_b16 v[100:101], v15 offset:4608
    v_mfma_f32_16x16x32_bf16 v[68:71], v[108:111], v[212:215], v[68:71]
    ds_read_b64_tr_b16 v[102:103], v15 offset:6656
    s_waitcnt lgkmcnt(8)
    v_mfma_f32_16x16x32_bf16 v[68:71], v[80:83], v[216:219], v[68:71]
    ds_read_b64_tr_b16 v[104:105], v15 offset:8704
    v_mfma_f32_16x16x32_bf16 v[68:71], v[84:87], v[220:223], v[68:71]
    ds_read_b64_tr_b16 v[106:107], v15 offset:10752
    v_mfma_f32_16x16x32_bf16 v[36:39], v[80:83], v[144:147], v[36:39]
    ds_read_b64_tr_b16 v[108:109], v15 offset:12800
    v_mfma_f32_16x16x32_bf16 v[36:39], v[84:87], v[148:151], v[36:39]
    ds_read_b64_tr_b16 v[110:111], v15 offset:14848
    s_waitcnt lgkmcnt(8)
    v_mfma_f32_16x16x32_bf16 v[36:39], v[88:91], v[152:155], v[36:39]
    ds_read_b64_tr_b16 v[80:81], v15 offset:16896
    v_mfma_f32_16x16x32_bf16 v[36:39], v[92:95], v[156:159], v[36:39]
    ds_read_b64_tr_b16 v[82:83], v15 offset:18944
    v_mfma_f32_16x16x32_bf16 v[68:71], v[88:91], v[224:227], v[68:71]
    ds_read_b64_tr_b16 v[84:85], v15 offset:20992
    v_mfma_f32_16x16x32_bf16 v[68:71], v[92:95], v[228:231], v[68:71]
    ds_read_b64_tr_b16 v[86:87], v15 offset:23040
    s_waitcnt lgkmcnt(8)
    v_mfma_f32_16x16x32_bf16 v[40:43], v[96:99], v[136:139], v[40:43]
    ds_read_b64_tr_b16 v[88:89], v15 offset:25088
    s_mov_b64 exec, 0x3fff
    buffer_load_dword v3, v8, s[12:15], s58 offen offset:3584 sc1
    s_mov_b64 exec, -1
    v_mfma_f32_16x16x32_bf16 v[40:43], v[100:103], v[140:143], v[40:43]
    ds_read_b64_tr_b16 v[90:91], v15 offset:27136
    v_mfma_f32_16x16x32_bf16 v[72:75], v[96:99], v[208:211], v[72:75]
    ds_read_b64_tr_b16 v[92:93], v15 offset:29184
    v_mfma_f32_16x16x32_bf16 v[72:75], v[100:103], v[212:215], v[72:75]
    ds_read_b64_tr_b16 v[94:95], v15 offset:31232
    s_waitcnt lgkmcnt(8)
    v_mfma_f32_16x16x32_bf16 v[72:75], v[104:107], v[216:219], v[72:75]
    ds_read_b64_tr_b16 v[96:97], v15 offset:33280
    v_mfma_f32_16x16x32_bf16 v[72:75], v[108:111], v[220:223], v[72:75]
    ds_read_b64_tr_b16 v[98:99], v15 offset:35328
    v_mfma_f32_16x16x32_bf16 v[40:43], v[104:107], v[144:147], v[40:43]
    ds_read_b64_tr_b16 v[100:101], v15 offset:37376
    v_mfma_f32_16x16x32_bf16 v[40:43], v[108:111], v[148:151], v[40:43]
    ds_read_b64_tr_b16 v[102:103], v15 offset:39424
    s_waitcnt lgkmcnt(8)
    v_mfma_f32_16x16x32_bf16 v[40:43], v[80:83], v[152:155], v[40:43]
    ds_read_b64_tr_b16 v[104:105], v15 offset:41472
    v_mfma_f32_16x16x32_bf16 v[40:43], v[84:87], v[156:159], v[40:43]
    ds_read_b64_tr_b16 v[106:107], v15 offset:43520
    v_mfma_f32_16x16x32_bf16 v[72:75], v[80:83], v[224:227], v[72:75]
    ds_read_b64_tr_b16 v[108:109], v15 offset:45568
    v_mfma_f32_16x16x32_bf16 v[72:75], v[84:87], v[228:231], v[72:75]
    ds_read_b64_tr_b16 v[110:111], v15 offset:47616
    s_waitcnt lgkmcnt(8)
    v_mfma_f32_16x16x32_bf16 v[44:47], v[88:91], v[136:139], v[44:47]
    s_setprio 3
    s_waitcnt vmcnt(3)
    s_barrier
    s_cmp_lg_u32 s24, 0
    s_cbranch_scc1 LM_ps6
    v_mov_b32 v1, 1
    s_mov_b64 exec, 0xff
    buffer_atomic_add v1, v8, s[12:15], s65 offen sc1
    s_mov_b64 exec, -1
    LM_ps6:
    v_add_u32 v14, 65536, v14
    v_add_u32 v15, 65536, v15
    ds_read_b64_tr_b16 v[80:81], v14 offset:0
    v_mfma_f32_16x16x32_bf16 v[44:47], v[92:95], v[140:143], v[44:47]
    ds_read_b64_tr_b16 v[82:83], v14 offset:2048
    v_mfma_f32_16x16x32_bf16 v[76:79], v[88:91], v[208:211], v[76:79]
    ds_read_b64_tr_b16 v[84:85], v14 offset:4096
    v_mfma_f32_16x16x32_bf16 v[76:79], v[92:95], v[212:215], v[76:79]
    ds_read_b64_tr_b16 v[86:87], v14 offset:6144
    s_waitcnt lgkmcnt(8)
    v_mfma_f32_16x16x32_bf16 v[76:79], v[96:99], v[216:219], v[76:79]
    ds_read_b64_tr_b16 v[88:89], v14 offset:8192
    s_mov_b32 m0, s55
    s_nop 0
    buffer_load_dwordx4 v5, s[12:15], s34 offen offset:0 sc1 lds
    v_mfma_f32_16x16x32_bf16 v[76:79], v[100:103], v[220:223], v[76:79]
    ds_read_b64_tr_b16 v[90:91], v14 offset:10240
    v_mfma_f32_16x16x32_bf16 v[44:47], v[96:99], v[144:147], v[44:47]
    ds_read_b64_tr_b16 v[92:93], v14 offset:12288
    v_mfma_f32_16x16x32_bf16 v[44:47], v[100:103], v[148:151], v[44:47]
    ds_read_b64_tr_b16 v[94:95], v14 offset:14336
    s_waitcnt lgkmcnt(8)
    v_mfma_f32_16x16x32_bf16 v[44:47], v[104:107], v[152:155], v[44:47]
    ds_read_b64_tr_b16 v[96:97], v14 offset:16384
    s_mov_b32 m0, s55
    s_nop 0
    buffer_load_dwordx4 v5, s[12:15], s34 offen offset:1024 sc1 lds
    v_mfma_f32_16x16x32_bf16 v[44:47], v[108:111], v[156:159], v[44:47]
    ds_read_b64_tr_b16 v[98:99], v14 offset:18432
    v_mfma_f32_16x16x32_bf16 v[76:79], v[104:107], v[224:227], v[76:79]
    ds_read_b64_tr_b16 v[100:101], v14 offset:20480
    v_mfma_f32_16x16x32_bf16 v[76:79], v[108:111], v[228:231], v[76:79]
    ds_read_b64_tr_b16 v[102:103], v14 offset:22528
    s_waitcnt lgkmcnt(8)
    v_mfma_f32_16x16x32_bf16 v[16:19], v[80:83], v[160:163], v[16:19]
    ds_read_b64_tr_b16 v[104:105], v14 offset:24576
    s_mov_b32 m0, s55
    s_nop 0
    buffer_load_dwordx4 v5, s[12:15], s34 offen offset:2048 sc1 lds
    v_mfma_f32_16x16x32_bf16 v[16:19], v[84:87], v[164:167], v[16:19]
    ds_read_b64_tr_b16 v[106:107], v14 offset:26624
    v_mfma_f32_16x16x32_bf16 v[48:51], v[80:83], v[232:235], v[48:51]
    ds_read_b64_tr_b16 v[108:109], v14 offset:28672
    v_mfma_f32_16x16x32_bf16 v[48:51], v[84:87], v[236:239], v[48:51]
    ds_read_b64_tr_b16 v[110:111], v14 offset:30720
    s_waitcnt lgkmcnt(8)
    v_mfma_f32_16x16x32_bf16 v[48:51], v[88:91], v[240:243], v[48:51]
    ds_read_b64_tr_b16 v[80:81], v14 offset:32768
    s_mov_b32 m0, s55
    s_nop 0
    buffer_load_dwordx4 v5, s[12:15], s34 offen offset:3072 sc1 lds
    v_mfma_f32_16x16x32_bf16 v[48:51], v[92:95], v[244:247], v[48:51]
    ds_read_b64_tr_b16 v[82:83], v14 offset:34816
    v_mfma_f32_16x16x32_bf16 v[16:19], v[88:91], v[168:171], v[16:19]
    ds_read_b64_tr_b16 v[84:85], v14 offset:36864
    v_mfma_f32_16x16x32_bf16 v[16:19], v[92:95], v[172:175], v[16:19]
    ds_read_b64_tr_b16 v[86:87], v14 offset:38912
    s_waitcnt lgkmcnt(8)
    v_mfma_f32_16x16x32_bf16 v[16:19], v[96:99], v[176:179], v[16:19]
    ds_read_b64_tr_b16 v[88:89], v14 offset:40960
    s_add_u32 m0, s55, 4096
    s_add_u32 s29, s34, 4096
    s_mov_b32 exec_hi, 0
    buffer_load_dwordx4 v5, s[12:15], s29 offen sc1 lds
    s_mov_b32 exec_hi, -1
    v_mfma_f32_16x16x32_bf16 v[16:19], v[100:103], v[180:183], v[16:19]
    ds_read_b64_tr_b16 v[90:91], v14 offset:43008
    v_mfma_f32_16x16x32_bf16 v[48:51], v[96:99], v[248:251], v[48:51]
    ds_read_b64_tr_b16 v[92:93], v14 offset:45056
    v_mfma_f32_16x16x32_bf16 v[48:51], v[100:103], v[252:255], v[48:51]
    ds_read_b64_tr_b16 v[94:95], v14 offset:47104
    s_waitcnt lgkmcnt(8)
    v_mfma_f32_16x16x32_bf16 v[20:23], v[104:107], v[160:163], v[20:23]
    s_setprio 2
    ds_read_b64_tr_b16 v[96:97], v15 offset:0
    s_barrier
    v_mfma_f32_16x16x32_bf16 v[20:23], v[108:111], v[164:167], v[20:23]
    ds_read_b64_tr_b16 v[98:99], v15 offset:2048
    v_mfma_f32_16x16x32_bf16 v[52:55], v[104:107], v[232:235], v[52:55]
    ds_read_b64_tr_b16 v[100:101], v15 offset:4096
    v_mfma_f32_16x16x32_bf16 v[52:55], v[108:111], v[236:239], v[52:55]
    ds_read_b64_tr_b16 v[102:103], v15 offset:6144
    s_waitcnt lgkmcnt(8)
    v_mfma_f32_16x16x32_bf16 v[52:55], v[80:83], v[240:243], v[52:55]
    ds_read_b64_tr_b16 v[104:105], v15 offset:8192
    s_mul_i32 s7, s59, 7
    s_add_u32 m0, s7, 36864
    s_add_u32 s7, s7, s54
    s_add_u32 s7, s7, 0
    s_mov_b32 exec_hi, 0
    buffer_load_dwordx4 v5, s[12:15], s7 offen offset:0 sc1 lds
    s_mov_b32 exec_hi, -1
    v_mfma_f32_16x16x32_bf16 v[52:55], v[84:87], v[244:247], v[52:55]
    ds_read_b64_tr_b16 v[106:107], v15 offset:10240
    v_mfma_f32_16x16x32_bf16 v[20:23], v[80:83], v[168:171], v[20:23]
    ds_read_b64_tr_b16 v[108:109], v15 offset:12288
    v_mfma_f32_16x16x32_bf16 v[20:23], v[84:87], v[172:175], v[20:23]
    ds_read_b64_tr_b16 v[110:111], v15 offset:14336
    s_waitcnt lgkmcnt(8)
    v_mfma_f32_16x16x32_bf16 v[20:23], v[88:91], v[176:179], v[20:23]
    ds_read_b64_tr_b16 v[80:81], v15 offset:16384
    v_mfma_f32_16x16x32_bf16 v[20:23], v[92:95], v[180:183], v[20:23]
    ds_read_b64_tr_b16 v[82:83], v15 offset:18432
    v_mfma_f32_16x16x32_bf16 v[52:55], v[88:91], v[248:251], v[52:55]
    ds_read_b64_tr_b16 v[84:85], v15 offset:20480
    v_mfma_f32_16x16x32_bf16 v[52:55], v[92:95], v[252:255], v[52:55]
    ds_read_b64_tr_b16 v[86:87], v15 offset:22528
    s_waitcnt lgkmcnt(8)
    v_mfma_f32_16x16x32_bf16 v[24:27], v[96:99], v[160:163], v[24:27]
    ds_read_b64_tr_b16 v[88:89], v15 offset:24576
    buffer_load_dwordx4 v5, s[12:15], s7 offen offset:512 sc1 lds
    v_mfma_f32_16x16x32_bf16 v[24:27], v[100:103], v[164:167], v[24:27]
    ds_read_b64_tr_b16 v[90:91], v15 offset:26624
    v_mfma_f32_16x16x32_bf16 v[56:59], v[96:99], v[232:235], v[56:59]
    ds_read_b64_tr_b16 v[92:93], v15 offset:28672
    v_mfma_f32_16x16x32_bf16 v[56:59], v[100:103], v[236:239], v[56:59]
    ds_read_b64_tr_b16 v[94:95], v15 offset:30720
    s_waitcnt lgkmcnt(8)
    v_mfma_f32_16x16x32_bf16 v[56:59], v[104:107], v[240:243], v[56:59]
    ds_read_b64_tr_b16 v[96:97], v15 offset:32768
    v_mul_f32 v16, v16, v20
    v_mfma_f32_16x16x32_bf16 v[56:59], v[108:111], v[244:247], v[56:59]
    ds_read_b64_tr_b16 v[98:99], v15 offset:34816
    v_mul_f32 v17, v17, v21
    v_mfma_f32_16x16x32_bf16 v[24:27], v[104:107], v[168:171], v[24:27]
    ds_read_b64_tr_b16 v[100:101], v15 offset:36864
    v_mfma_f32_16x16x32_bf16 v[24:27], v[108:111], v[172:175], v[24:27]
    ds_read_b64_tr_b16 v[102:103], v15 offset:38912
    s_waitcnt lgkmcnt(8)
    v_mfma_f32_16x16x32_bf16 v[24:27], v[80:83], v[176:179], v[24:27]
    ds_read_b64_tr_b16 v[104:105], v15 offset:40960
    v_mul_f32 v18, v18, v22
    v_mfma_f32_16x16x32_bf16 v[24:27], v[84:87], v[180:183], v[24:27]
    ds_read_b64_tr_b16 v[106:107], v15 offset:43008
    v_mul_f32 v19, v19, v23
    v_mfma_f32_16x16x32_bf16 v[56:59], v[80:83], v[248:251], v[56:59]
    ds_read_b64_tr_b16 v[108:109], v15 offset:45056
    buffer_load_dwordx4 v5, s[12:15], s7 offen offset:1536 sc1 lds
    v_mfma_f32_16x16x32_bf16 v[56:59], v[84:87], v[252:255], v[56:59]
    ds_read_b64_tr_b16 v[110:111], v15 offset:47104
    s_waitcnt lgkmcnt(8)
    v_mfma_f32_16x16x32_bf16 v[28:31], v[88:91], v[160:163], v[28:31]
    s_setprio 1
    ds_read_b64_tr_b16 v[80:81], v14 offset:512
    v_cvt_pk_bf16_f32 v20, v16, v17
    v_mfma_f32_16x16x32_bf16 v[28:31], v[92:95], v[164:167], v[28:31]
    ds_read_b64_tr_b16 v[82:83], v14 offset:2560
    v_cvt_pk_bf16_f32 v21, v18, v19
    v_mfma_f32_16x16x32_bf16 v[60:63], v[88:91], v[232:235], v[60:63]
    ds_read_b64_tr_b16 v[84:85], v14 offset:4608
    v_mfma_f32_16x16x32_bf16 v[60:63], v[92:95], v[236:239], v[60:63]
    ds_read_b64_tr_b16 v[86:87], v14 offset:6656
    s_waitcnt lgkmcnt(8)
    v_mfma_f32_16x16x32_bf16 v[60:63], v[96:99], v[240:243], v[60:63]
    ds_read_b64_tr_b16 v[88:89], v14 offset:8704
    v_mul_f32 v48, v48, v52
    v_mfma_f32_16x16x32_bf16 v[60:63], v[100:103], v[244:247], v[60:63]
    ds_read_b64_tr_b16 v[90:91], v14 offset:10752
    v_mul_f32 v49, v49, v53
    v_mfma_f32_16x16x32_bf16 v[28:31], v[96:99], v[168:171], v[28:31]
    ds_read_b64_tr_b16 v[92:93], v14 offset:12800
    buffer_load_dwordx4 v5, s[12:15], s7 offen offset:2560 sc1 lds
    v_mfma_f32_16x16x32_bf16 v[28:31], v[100:103], v[172:175], v[28:31]
    ds_read_b64_tr_b16 v[94:95], v14 offset:14848
    s_waitcnt lgkmcnt(8)
    v_mfma_f32_16x16x32_bf16 v[28:31], v[104:107], v[176:179], v[28:31]
    ds_read_b64_tr_b16 v[96:97], v14 offset:16896
    v_mul_f32 v50, v50, v54
    v_mfma_f32_16x16x32_bf16 v[28:31], v[108:111], v[180:183], v[28:31]
    ds_read_b64_tr_b16 v[98:99], v14 offset:18944
    v_mul_f32 v51, v51, v55
    v_mfma_f32_16x16x32_bf16 v[60:63], v[104:107], v[248:251], v[60:63]
    ds_read_b64_tr_b16 v[100:101], v14 offset:20992
    v_mfma_f32_16x16x32_bf16 v[60:63], v[108:111], v[252:255], v[60:63]
    ds_read_b64_tr_b16 v[102:103], v14 offset:23040
    s_waitcnt lgkmcnt(8)
    v_mfma_f32_16x16x32_bf16 v[32:35], v[80:83], v[160:163], v[32:35]
    ds_read_b64_tr_b16 v[104:105], v14 offset:25088
    v_cvt_pk_bf16_f32 v52, v48, v49
    v_mfma_f32_16x16x32_bf16 v[32:35], v[84:87], v[164:167], v[32:35]
    ds_read_b64_tr_b16 v[106:107], v14 offset:27136
    v_cvt_pk_bf16_f32 v53, v50, v51
    v_mfma_f32_16x16x32_bf16 v[64:67], v[80:83], v[232:235], v[64:67]
    ds_read_b64_tr_b16 v[108:109], v14 offset:29184
    s_mul_i32 s7, s59, 7
    s_add_u32 m0, s7, 65536
    s_add_u32 s7, s7, s54
    s_add_u32 s7, s7, 28672
    s_mov_b32 exec_hi, 0
    buffer_load_dwordx4 v5, s[12:15], s7 offen offset:0 sc1 lds
    s_mov_b32 exec_hi, -1
    v_mfma_f32_16x16x32_bf16 v[64:67], v[84:87], v[236:239], v[64:67]
    ds_read_b64_tr_b16 v[110:111], v14 offset:31232
    s_waitcnt lgkmcnt(8)
    v_mfma_f32_16x16x32_bf16 v[64:67], v[88:91], v[240:243], v[64:67]
    ds_read_b64_tr_b16 v[80:81], v14 offset:33280
    v_mul_f32 v24, v24, v28
    v_mfma_f32_16x16x32_bf16 v[64:67], v[92:95], v[244:247], v[64:67]
    ds_read_b64_tr_b16 v[82:83], v14 offset:35328
    v_mul_f32 v25, v25, v29
    v_mfma_f32_16x16x32_bf16 v[32:35], v[88:91], v[168:171], v[32:35]
    ds_read_b64_tr_b16 v[84:85], v14 offset:37376
    v_mul_f32 v26, v26, v30
    v_mfma_f32_16x16x32_bf16 v[32:35], v[92:95], v[172:175], v[32:35]
    ds_read_b64_tr_b16 v[86:87], v14 offset:39424
    s_waitcnt lgkmcnt(8)
    v_mfma_f32_16x16x32_bf16 v[32:35], v[96:99], v[176:179], v[32:35]
    ds_read_b64_tr_b16 v[88:89], v14 offset:41472
    v_mul_f32 v27, v27, v31
    v_mfma_f32_16x16x32_bf16 v[32:35], v[100:103], v[180:183], v[32:35]
    ds_read_b64_tr_b16 v[90:91], v14 offset:43520
    v_cvt_pk_bf16_f32 v22, v24, v25
    v_mfma_f32_16x16x32_bf16 v[64:67], v[96:99], v[248:251], v[64:67]
    ds_read_b64_tr_b16 v[92:93], v14 offset:45568
    buffer_load_dwordx4 v5, s[12:15], s7 offen offset:512 sc1 lds
    v_mfma_f32_16x16x32_bf16 v[64:67], v[100:103], v[252:255], v[64:67]
    ds_read_b64_tr_b16 v[94:95], v14 offset:47616
    s_waitcnt lgkmcnt(8)
    v_mfma_f32_16x16x32_bf16 v[36:39], v[104:107], v[160:163], v[36:39]
    s_setprio 0
    ds_read_b64_tr_b16 v[96:97], v15 offset:512
    v_cvt_pk_bf16_f32 v23, v26, v27
    v_mfma_f32_16x16x32_bf16 v[36:39], v[108:111], v[164:167], v[36:39]
    ds_read_b64_tr_b16 v[98:99], v15 offset:2560
    s_add_u32 s30, s61, 16384
    buffer_store_dwordx4 v[20:23], v5, s[12:15], s30 offen offset:0 sc1
    v_mfma_f32_16x16x32_bf16 v[68:71], v[104:107], v[232:235], v[68:71]
    ds_read_b64_tr_b16 v[100:101], v15 offset:4608
    v_mov_b32 v4, 64
    s_cmp_lg_u32 s24, 0
    s_cbranch_scc1 LM_l07
    s_and_b32 s29, s27, 7
    s_lshl_b64 exec, 1, s29
    v_mov_b32 v4, 0
    buffer_atomic_or v4, v8, s[12:15], s65 offen sc0 sc1
    s_mov_b64 exec, -1
    LM_l07:
    v_mfma_f32_16x16x32_bf16 v[68:71], v[108:111], v[236:239], v[68:71]
    ds_read_b64_tr_b16 v[102:103], v15 offset:6656
    s_waitcnt lgkmcnt(8)
    v_mfma_f32_16x16x32_bf16 v[68:71], v[80:83], v[240:243], v[68:71]
    ds_read_b64_tr_b16 v[104:105], v15 offset:8704
    v_mul_f32 v56, v56, v60
    v_mfma_f32_16x16x32_bf16 v[68:71], v[84:87], v[244:247], v[68:71]
    ds_read_b64_tr_b16 v[106:107], v15 offset:10752
    v_mul_f32 v57, v57, v61
    v_mfma_f32_16x16x32_bf16 v[36:39], v[80:83], v[168:171], v[36:39]
    ds_read_b64_tr_b16 v[108:109], v15 offset:12800
    v_mul_f32 v58, v58, v62
    v_mfma_f32_16x16x32_bf16 v[36:39], v[84:87], v[172:175], v[36:39]
    ds_read_b64_tr_b16 v[110:111], v15 offset:14848
    buffer_load_dwordx4 v5, s[12:15], s7 offen offset:1536 sc1 lds
    s_waitcnt lgkmcnt(8)
    v_mfma_f32_16x16x32_bf16 v[36:39], v[88:91], v[176:179], v[36:39]
    ds_read_b64_tr_b16 v[80:81], v15 offset:16896
    v_mul_f32 v59, v59, v63
    v_mfma_f32_16x16x32_bf16 v[36:39], v[92:95], v[180:183], v[36:39]
    ds_read_b64_tr_b16 v[82:83], v15 offset:18944
    v_cvt_pk_bf16_f32 v54, v56, v57
    v_mfma_f32_16x16x32_bf16 v[68:71], v[88:91], v[248:251], v[68:71]
    ds_read_b64_tr_b16 v[84:85], v15 offset:20992
    v_mfma_f32_16x16x32_bf16 v[68:71], v[92:95], v[252:255], v[68:71]
    ds_read_b64_tr_b16 v[86:87], v15 offset:23040
    s_waitcnt lgkmcnt(8)
    v_mfma_f32_16x16x32_bf16 v[40:43], v[96:99], v[160:163], v[40:43]
    ds_read_b64_tr_b16 v[88:89], v15 offset:25088
    v_cvt_pk_bf16_f32 v55, v58, v59
    v_mfma_f32_16x16x32_bf16 v[40:43], v[100:103], v[164:167], v[40:43]
    ds_read_b64_tr_b16 v[90:91], v15 offset:27136
    s_add_u32 s30, s61, 163840
    buffer_store_dwordx4 v[52:55], v5, s[12:15], s30 offen offset:0 sc1
    v_mfma_f32_16x16x32_bf16 v[72:75], v[96:99], v[232:235], v[72:75]
    ds_read_b64_tr_b16 v[92:93], v15 offset:29184
    buffer_load_dwordx4 v5, s[12:15], s7 offen offset:2560 sc1 lds
    v_mfma_f32_16x16x32_bf16 v[72:75], v[100:103], v[236:239], v[72:75]
    ds_read_b64_tr_b16 v[94:95], v15 offset:31232
    s_waitcnt lgkmcnt(8)
    v_mfma_f32_16x16x32_bf16 v[72:75], v[104:107], v[240:243], v[72:75]
    ds_read_b64_tr_b16 v[96:97], v15 offset:33280
    v_mul_f32 v32, v32, v36
    v_mfma_f32_16x16x32_bf16 v[72:75], v[108:111], v[244:247], v[72:75]
    ds_read_b64_tr_b16 v[98:99], v15 offset:35328
    v_mul_f32 v33, v33, v37
    v_mfma_f32_16x16x32_bf16 v[40:43], v[104:107], v[168:171], v[40:43]
    ds_read_b64_tr_b16 v[100:101], v15 offset:37376
    v_mfma_f32_16x16x32_bf16 v[40:43], v[108:111], v[172:175], v[40:43]
    ds_read_b64_tr_b16 v[102:103], v15 offset:39424
    s_waitcnt lgkmcnt(8)
    v_mfma_f32_16x16x32_bf16 v[40:43], v[80:83], v[176:179], v[40:43]
    ds_read_b64_tr_b16 v[104:105], v15 offset:41472
    v_mul_f32 v34, v34, v38
    v_mfma_f32_16x16x32_bf16 v[40:43], v[84:87], v[180:183], v[40:43]
    ds_read_b64_tr_b16 v[106:107], v15 offset:43520
    v_mul_f32 v35, v35, v39
    v_mfma_f32_16x16x32_bf16 v[72:75], v[80:83], v[248:251], v[72:75]
    ds_read_b64_tr_b16 v[108:109], v15 offset:45568
    v_mfma_f32_16x16x32_bf16 v[72:75], v[84:87], v[252:255], v[72:75]
    ds_read_b64_tr_b16 v[110:111], v15 offset:47616
    s_waitcnt lgkmcnt(8)
    v_mfma_f32_16x16x32_bf16 v[44:47], v[88:91], v[160:163], v[44:47]
    s_setprio 3
    s_waitcnt vmcnt(10)
    s_barrier
    ds_read_b128 v[80:83], v5 offset:0
    v_mfma_f32_16x16x32_bf16 v[44:47], v[92:95], v[164:167], v[44:47]
    v_cvt_pk_bf16_f32 v36, v32, v33
    v_mfma_f32_16x16x32_bf16 v[76:79], v[88:91], v[232:235], v[76:79]
    ds_read_b128 v[84:87], v5 offset:1024
    v_mfma_f32_16x16x32_bf16 v[76:79], v[92:95], v[236:239], v[76:79]
    v_cvt_pk_bf16_f32 v37, v34, v35
    s_waitcnt lgkmcnt(6)
    v_mfma_f32_16x16x32_bf16 v[76:79], v[96:99], v[240:243], v[76:79]
    ds_read_b128 v[88:91], v5 offset:2048
    v_mfma_f32_16x16x32_bf16 v[76:79], v[100:103], v[244:247], v[76:79]
    v_mul_f32 v64, v64, v68
    v_mfma_f32_16x16x32_bf16 v[44:47], v[96:99], v[168:171], v[44:47]
    ds_read_b128 v[92:95], v5 offset:3072
    v_mfma_f32_16x16x32_bf16 v[44:47], v[100:103], v[172:175], v[44:47]
    v_mul_f32 v65, v65, v69
    s_waitcnt lgkmcnt(4)
    v_mfma_f32_16x16x32_bf16 v[44:47], v[104:107], v[176:179], v[44:47]
    ds_read_b128 v[96:99], v5 offset:4096
    v_mfma_f32_16x16x32_bf16 v[44:47], v[108:111], v[180:183], v[44:47]
    v_mul_f32 v66, v66, v70
    v_mfma_f32_16x16x32_bf16 v[76:79], v[104:107], v[248:251], v[76:79]
    ds_read_b128 v[100:103], v5 offset:5120
    v_mfma_f32_16x16x32_bf16 v[76:79], v[108:111], v[252:255], v[76:79]
    v_mul_f32 v67, v67, v71
    s_waitcnt lgkmcnt(4)
    v_mfma_f32_16x16x32_bf16 v[16:19], v[80:83], v[112:115], 0
    ds_read_b128 v[104:107], v5 offset:6144
    v_mfma_f32_16x16x32_bf16 v[16:19], v[84:87], v[116:119], v[16:19]
    v_cvt_pk_bf16_f32 v68, v64, v65
    v_mfma_f32_16x16x32_bf16 v[48:51], v[80:83], v[184:187], 0
    ds_read_b128 v[108:111], v5 offset:7168
    v_mfma_f32_16x16x32_bf16 v[48:51], v[84:87], v[188:191], v[48:51]
    v_cvt_pk_bf16_f32 v69, v66, v67
    s_waitcnt lgkmcnt(4)
    v_mfma_f32_16x16x32_bf16 v[48:51], v[88:91], v[192:195], v[48:51]
    ds_read_b128 v[80:83], v5 offset:8192
    v_mul_f32 v40, v40, v44
    v_mul_f32 v41, v41, v45
    v_mfma_f32_16x16x32_bf16 v[48:51], v[92:95], v[196:199], v[48:51]
    v_mul_f32 v42, v42, v46
    v_mul_f32 v43, v43, v47
    v_mfma_f32_16x16x32_bf16 v[16:19], v[88:91], v[120:123], v[16:19]
    ds_read_b128 v[84:87], v5 offset:9216
    v_cvt_pk_bf16_f32 v38, v40, v41
    v_cvt_pk_bf16_f32 v39, v42, v43
    v_mfma_f32_16x16x32_bf16 v[16:19], v[92:95], v[124:127], v[16:19]
    s_add_u32 s30, s61, 16384
    buffer_store_dwordx4 v[36:39], v5, s[12:15], s30 offen offset:1024 sc1
    s_waitcnt lgkmcnt(4)
    v_mfma_f32_16x16x32_bf16 v[16:19], v[96:99], v[128:131], v[16:19]
    ds_read_b128 v[88:91], v5 offset:10240
    v_mul_f32 v72, v72, v76
    v_mul_f32 v73, v73, v77
    v_mfma_f32_16x16x32_bf16 v[16:19], v[100:103], v[132:135], v[16:19]
    v_mul_f32 v74, v74, v78
    v_mul_f32 v75, v75, v79
    v_mfma_f32_16x16x32_bf16 v[48:51], v[96:99], v[200:203], v[48:51]
    ds_read_b128 v[92:95], v5 offset:11264
    v_cvt_pk_bf16_f32 v70, v72, v73
    v_cvt_pk_bf16_f32 v71, v74, v75
    v_mfma_f32_16x16x32_bf16 v[48:51], v[100:103], v[204:207], v[48:51]
    s_add_u32 s30, s61, 163840
    buffer_store_dwordx4 v[68:71], v5, s[12:15], s30 offen offset:1024 sc1
    s_waitcnt lgkmcnt(4)
    v_mfma_f32_16x16x32_bf16 v[48:51], v[104:107], v[208:211], v[48:51]
    s_setprio 2
    ds_read_b128 v[96:99], v5 offset:12288
    v_mfma_f32_16x16x32_bf16 v[48:51], v[108:111], v[212:215], v[48:51]
    s_waitcnt vmcnt(5)
    LM_chk8:
    v_cmp_gt_u32 vcc, 32, v4
    s_cbranch_vccnz LM_retry8
    LM_ok8:
    s_barrier
    v_mfma_f32_16x16x32_bf16 v[16:19], v[104:107], v[136:139], v[16:19]
    ds_read_b128 v[100:103], v5 offset:13312
    v_mfma_f32_16x16x32_bf16 v[16:19], v[108:111], v[140:143], v[16:19]
    s_waitcnt lgkmcnt(4)
    v_mfma_f32_16x16x32_bf16 v[16:19], v[80:83], v[144:147], v[16:19]
    ds_read_b128 v[104:107], v5 offset:14336
    v_mfma_f32_16x16x32_bf16 v[16:19], v[84:87], v[148:151], v[16:19]
    buffer_load_dwordx4 v[24:27], v5, s[12:15], s38 offen offset:0 sc1
    v_mfma_f32_16x16x32_bf16 v[48:51], v[80:83], v[216:219], v[48:51]
    ds_read_b128 v[108:111], v5 offset:15360
    v_mfma_f32_16x16x32_bf16 v[48:51], v[84:87], v[220:223], v[48:51]
    s_waitcnt lgkmcnt(4)
    v_mfma_f32_16x16x32_bf16 v[48:51], v[88:91], v[224:227], v[48:51]
    ds_read_b128 v[80:83], v5 offset:16384
    v_mfma_f32_16x16x32_bf16 v[48:51], v[92:95], v[228:231], v[48:51]
    buffer_load_dwordx4 v[28:31], v5, s[12:15], s38 offen offset:1024 sc1
    s_add_u32 s38, s38, 4096
    v_mfma_f32_16x16x32_bf16 v[16:19], v[88:91], v[152:155], v[16:19]
    ds_read_b128 v[84:87], v5 offset:17408
    v_mfma_f32_16x16x32_bf16 v[16:19], v[92:95], v[156:159], v[16:19]
    s_waitcnt lgkmcnt(4)
    v_mfma_f32_16x16x32_bf16 v[16:19], v[96:99], v[160:163], v[16:19]
    ds_read_b128 v[88:91], v5 offset:18432
    v_mfma_f32_16x16x32_bf16 v[16:19], v[100:103], v[164:167], v[16:19]
    buffer_load_dwordx4 v[32:35], v5, s[12:15], s39 offen offset:0 sc1
    v_mfma_f32_16x16x32_bf16 v[48:51], v[96:99], v[232:235], v[48:51]
    ds_read_b128 v[92:95], v5 offset:19456
    v_mfma_f32_16x16x32_bf16 v[48:51], v[100:103], v[236:239], v[48:51]
    v_and_b32 v2, 1, v7
    v_mul_u32_u24 v2, 147328, v2
    v_lshl_add_u32 v2, v7, 7, v2
    v_lshl_add_u32 v2, v6, 4, v2
    s_waitcnt lgkmcnt(4)
    v_mfma_f32_16x16x32_bf16 v[48:51], v[104:107], v[240:243], v[48:51]
    ds_read_b128 v[96:99], v5 offset:20480
    v_mfma_f32_16x16x32_bf16 v[48:51], v[108:111], v[244:247], v[48:51]
    buffer_load_dwordx4 v[36:39], v5, s[12:15], s39 offen offset:1024 sc1
    s_add_u32 s39, s39, 4096
    v_mfma_f32_16x16x32_bf16 v[16:19], v[104:107], v[168:171], v[16:19]
    ds_read_b128 v[100:103], v5 offset:21504
    v_mfma_f32_16x16x32_bf16 v[16:19], v[108:111], v[172:175], v[16:19]
    s_waitcnt lgkmcnt(4)
    v_mfma_f32_16x16x32_bf16 v[16:19], v[80:83], v[176:179], v[16:19]
    s_setprio 1
    ds_read_b128 v[104:107], v5 offset:22528
    v_mfma_f32_16x16x32_bf16 v[16:19], v[84:87], v[180:183], v[16:19]
    s_mul_i32 s7, s59, 7
    s_add_u32 m0, s7, 94208
    s_add_u32 s7, s7, s54
    s_add_u32 s7, s7, 57344
    s_mov_b32 exec_hi, 0
    buffer_load_dwordx4 v5, s[12:15], s7 offen offset:0 sc1 lds
    s_mov_b32 exec_hi, -1
    v_mfma_f32_16x16x32_bf16 v[48:51], v[80:83], v[248:251], v[48:51]
    ds_read_b128 v[108:111], v5 offset:23552
    v_mfma_f32_16x16x32_bf16 v[48:51], v[84:87], v[252:255], v[48:51]
    s_waitcnt lgkmcnt(4)
    v_mfma_f32_16x16x32_bf16 v[20:23], v[88:91], v[112:115], 0
    ds_read_b128 v[80:83], v5 offset:24576
    v_mfma_f32_16x16x32_bf16 v[20:23], v[92:95], v[116:119], v[20:23]
    buffer_load_dwordx4 v5, s[12:15], s7 offen offset:512 sc1 lds
    v_mfma_f32_16x16x32_bf16 v[52:55], v[88:91], v[184:187], 0
    ds_read_b128 v[84:87], v5 offset:25600
    v_mfma_f32_16x16x32_bf16 v[52:55], v[92:95], v[188:191], v[52:55]
    s_waitcnt lgkmcnt(4)
    v_mfma_f32_16x16x32_bf16 v[52:55], v[96:99], v[192:195], v[52:55]
    ds_read_b128 v[88:91], v5 offset:26624
    v_mfma_f32_16x16x32_bf16 v[52:55], v[100:103], v[196:199], v[52:55]
    buffer_load_dwordx4 v5, s[12:15], s7 offen offset:1536 sc1 lds
    v_mfma_f32_16x16x32_bf16 v[20:23], v[96:99], v[120:123], v[20:23]
    ds_read_b128 v[92:95], v5 offset:27648
    v_mfma_f32_16x16x32_bf16 v[20:23], v[100:103], v[124:127], v[20:23]
    s_waitcnt lgkmcnt(4)
    v_mfma_f32_16x16x32_bf16 v[20:23], v[104:107], v[128:131], v[20:23]
    ds_read_b128 v[96:99], v5 offset:28672
    v_mfma_f32_16x16x32_bf16 v[20:23], v[108:111], v[132:135], v[20:23]
    buffer_load_dwordx4 v5, s[12:15], s7 offen offset:2560 sc1 lds
    v_mfma_f32_16x16x32_bf16 v[52:55], v[104:107], v[200:203], v[52:55]
    ds_read_b128 v[100:103], v5 offset:29696
    v_mfma_f32_16x16x32_bf16 v[52:55], v[108:111], v[204:207], v[52:55]
    s_waitcnt lgkmcnt(4)
    v_mfma_f32_16x16x32_bf16 v[52:55], v[80:83], v[208:211], v[52:55]
    ds_read_b128 v[104:107], v5 offset:30720
    v_mfma_f32_16x16x32_bf16 v[52:55], v[84:87], v[212:215], v[52:55]
    buffer_load_dwordx4 v[40:43], v5, s[12:15], s38 offen offset:0 sc1
    v_mfma_f32_16x16x32_bf16 v[20:23], v[80:83], v[136:139], v[20:23]
    ds_read_b128 v[108:111], v5 offset:31744
    v_mfma_f32_16x16x32_bf16 v[20:23], v[84:87], v[140:143], v[20:23]
    s_waitcnt lgkmcnt(4)
    v_mfma_f32_16x16x32_bf16 v[20:23], v[88:91], v[144:147], v[20:23]
    s_setprio 0
    ds_read_b128 v[80:83], v5 offset:32768
    v_mfma_f32_16x16x32_bf16 v[20:23], v[92:95], v[148:151], v[20:23]
    buffer_load_dwordx4 v[44:47], v5, s[12:15], s38 offen offset:1024 sc1
    s_add_u32 s38, s38, 4096
    v_mfma_f32_16x16x32_bf16 v[52:55], v[88:91], v[216:219], v[52:55]
    ds_read_b128 v[84:87], v5 offset:33792
    v_mfma_f32_16x16x32_bf16 v[52:55], v[92:95], v[220:223], v[52:55]
    s_waitcnt lgkmcnt(4)
    v_mfma_f32_16x16x32_bf16 v[52:55], v[96:99], v[224:227], v[52:55]
    ds_read_b128 v[88:91], v5 offset:34816
    v_mfma_f32_16x16x32_bf16 v[52:55], v[100:103], v[228:231], v[52:55]
    buffer_load_dwordx4 v[56:59], v5, s[12:15], s39 offen offset:0 sc1
    v_mfma_f32_16x16x32_bf16 v[20:23], v[96:99], v[152:155], v[20:23]
    ds_read_b128 v[92:95], v5 offset:35840
    v_mfma_f32_16x16x32_bf16 v[20:23], v[100:103], v[156:159], v[20:23]
    s_waitcnt lgkmcnt(4)
    v_mfma_f32_16x16x32_bf16 v[20:23], v[104:107], v[160:163], v[20:23]
    buffer_load_dwordx4 v[60:63], v5, s[12:15], s39 offen offset:1024 sc1
    s_add_u32 s39, s39, 4096
    v_mfma_f32_16x16x32_bf16 v[20:23], v[108:111], v[164:167], v[20:23]
    v_mfma_f32_16x16x32_bf16 v[52:55], v[104:107], v[232:235], v[52:55]
    v_mfma_f32_16x16x32_bf16 v[52:55], v[108:111], v[236:239], v[52:55]
    s_waitcnt lgkmcnt(2)
    v_mfma_f32_16x16x32_bf16 v[52:55], v[80:83], v[240:243], v[52:55]
    s_mul_i32 s29, s26, 14336
    s_add_u32 s29, s29, 36864
    v_add_u32 v14, s29, v5
    v_mfma_f32_16x16x32_bf16 v[52:55], v[84:87], v[244:247], v[52:55]
    v_add_u32 v9, s44, v5
    v_add_u32 v10, s45, v5
    v_mfma_f32_16x16x32_bf16 v[20:23], v[80:83], v[168:171], v[20:23]
    v_mfma_f32_16x16x32_bf16 v[20:23], v[84:87], v[172:175], v[20:23]
    s_waitcnt lgkmcnt(0)
    v_mfma_f32_16x16x32_bf16 v[20:23], v[88:91], v[176:179], v[20:23]
    s_waitcnt vmcnt(12)
    s_barrier
    s_cmp_lg_u32 s24, 0
    s_cbranch_scc1 LM_ps9
    v_mov_b32 v1, 1
    s_mov_b64 exec, 0xff
    buffer_atomic_add v1, v8, s[12:15], s66 offen sc1
    s_mov_b64 exec, -1
    LM_ps9:
    v_mfma_f32_16x16x32_bf16 v[20:23], v[92:95], v[180:183], v[20:23]
    v_mfma_f32_16x16x32_bf16 v[52:55], v[88:91], v[248:251], v[52:55]
    v_mfma_f32_16x16x32_bf16 v[52:55], v[92:95], v[252:255], v[52:55]
    s_nop 5
    v_mul_f32 v16, v16, v20
    v_mul_f32 v17, v17, v21
    v_mul_f32 v18, v18, v22
    v_mul_f32 v19, v19, v23
    v_cvt_pk_bf16_f32 v20, v16, v17
    v_cvt_pk_bf16_f32 v21, v18, v19
    v_mul_f32 v48, v48, v52
    v_mul_f32 v49, v49, v53
    v_mul_f32 v50, v50, v54
    v_mul_f32 v51, v51, v55
    v_cvt_pk_bf16_f32 v22, v48, v49
    v_cvt_pk_bf16_f32 v23, v50, v51
    s_nop 1
    v_permlane16_swap_b32 v20, v22
    v_permlane16_swap_b32 v21, v23
    buffer_store_dwordx4 v[20:23], v2, s[12:15], s62 offen sc1
    ds_read_b128 v[80:83], v14 offset:0
    ds_read_b128 v[84:87], v14 offset:1024
    ds_read_b128 v[88:91], v14 offset:2048
    ds_read_b128 v[92:95], v14 offset:3072
    ds_read_b128 v[96:99], v14 offset:4096
    ds_read_b128 v[100:103], v14 offset:5120
    ds_read_b128 v[104:107], v14 offset:6144
    ds_read_b128 v[108:111], v14 offset:7168
    s_waitcnt vmcnt(9)
    s_waitcnt lgkmcnt(6)
    v_mfma_f32_16x16x32_bf16 v[112:115], v[80:83], v[24:27], 0
    s_setprio 3
    ds_read_b128 v[48:51], v14 offset:8192
    v_mfma_f32_16x16x32_bf16 v[112:115], v[84:87], v[28:31], v[112:115]
    buffer_load_dwordx4 v[64:67], v5, s[12:15], s38 offen offset:0 sc1
    v_mfma_f32_16x16x32_bf16 v[116:119], v[80:83], v[32:35], 0
    ds_read_b128 v[52:55], v14 offset:9216
    v_mfma_f32_16x16x32_bf16 v[116:119], v[84:87], v[36:39], v[116:119]
    buffer_load_dwordx4 v[68:71], v5, s[12:15], s38 offen offset:1024 sc1
    s_add_u32 s38, s38, 4096
    s_waitcnt lgkmcnt(6)
    v_mfma_f32_16x16x32_bf16 v[120:123], v[88:91], v[24:27], 0
    s_setprio 2
    ds_read_b128 v[80:83], v14 offset:10240
    v_mfma_f32_16x16x32_bf16 v[120:123], v[92:95], v[28:31], v[120:123]
    buffer_load_dwordx4 v[72:75], v5, s[12:15], s39 offen offset:0 sc1
    v_mfma_f32_16x16x32_bf16 v[124:127], v[88:91], v[32:35], 0
    ds_read_b128 v[84:87], v14 offset:11264
    v_mfma_f32_16x16x32_bf16 v[124:127], v[92:95], v[36:39], v[124:127]
    s_waitcnt lgkmcnt(6)
    v_mfma_f32_16x16x32_bf16 v[128:131], v[96:99], v[24:27], 0
    s_setprio 1
    ds_read_b128 v[88:91], v14 offset:12288
    v_mfma_f32_16x16x32_bf16 v[128:131], v[100:103], v[28:31], v[128:131]
    buffer_load_dwordx4 v[76:79], v5, s[12:15], s39 offen offset:1024 sc1
    s_add_u32 s39, s39, 4096
    v_mfma_f32_16x16x32_bf16 v[132:135], v[96:99], v[32:35], 0
    ds_read_b128 v[92:95], v14 offset:13312
    v_mfma_f32_16x16x32_bf16 v[132:135], v[100:103], v[36:39], v[132:135]
    s_waitcnt lgkmcnt(6)
    v_mfma_f32_16x16x32_bf16 v[136:139], v[104:107], v[24:27], 0
    s_setprio 3
    v_add_u32 v14, 28672, v14
    ds_read_b128 v[96:99], v14 offset:0
    v_mfma_f32_16x16x32_bf16 v[136:139], v[108:111], v[28:31], v[136:139]
    s_mul_i32 s7, s59, 7
    s_add_u32 m0, s7, 135168
    s_add_u32 s7, s7, s54
    s_add_u32 s7, s7, 86016
    s_mov_b32 exec_hi, 0
    buffer_load_dwordx4 v5, s[12:15], s7 offen offset:0 sc1 lds
    s_mov_b32 exec_hi, -1
    v_mfma_f32_16x16x32_bf16 v[140:143], v[104:107], v[32:35], 0
    ds_read_b128 v[100:103], v14 offset:1024
    v_mfma_f32_16x16x32_bf16 v[140:143], v[108:111], v[36:39], v[140:143]
    s_waitcnt lgkmcnt(6)
    v_mfma_f32_16x16x32_bf16 v[144:147], v[48:51], v[24:27], 0
    ds_read_b128 v[104:107], v14 offset:2048
    v_mfma_f32_16x16x32_bf16 v[144:147], v[52:55], v[28:31], v[144:147]
    buffer_load_dwordx4 v5, s[12:15], s7 offen offset:512 sc1 lds
    v_mfma_f32_16x16x32_bf16 v[148:151], v[48:51], v[32:35], 0
    ds_read_b128 v[108:111], v14 offset:3072
    v_mfma_f32_16x16x32_bf16 v[148:151], v[52:55], v[36:39], v[148:151]
    s_waitcnt lgkmcnt(6)
    v_mfma_f32_16x16x32_bf16 v[152:155], v[80:83], v[24:27], 0
    s_setprio 2
    ds_read_b128 v[48:51], v14 offset:4096
    v_mfma_f32_16x16x32_bf16 v[152:155], v[84:87], v[28:31], v[152:155]
    buffer_load_dwordx4 v5, s[12:15], s7 offen offset:1536 sc1 lds
    v_mfma_f32_16x16x32_bf16 v[156:159], v[80:83], v[32:35], 0
    ds_read_b128 v[52:55], v14 offset:5120
    v_mfma_f32_16x16x32_bf16 v[156:159], v[84:87], v[36:39], v[156:159]
    v_mov_b32 v13, 64
    s_cmp_lg_u32 s24, 0
    s_cbranch_scc1 LM_l010
    s_and_b32 s29, s27, 7
    s_lshl_b64 exec, 1, s29
    v_mov_b32 v13, 0
    buffer_atomic_or v13, v8, s[12:15], s66 offen sc0 sc1
    s_mov_b64 exec, -1
    LM_l010:
    s_waitcnt lgkmcnt(6)
    v_mfma_f32_16x16x32_bf16 v[16:19], v[88:91], v[24:27], 0
    ds_read_b128 v[80:83], v14 offset:6144
    v_mfma_f32_16x16x32_bf16 v[16:19], v[92:95], v[28:31], v[16:19]
    buffer_load_dwordx4 v5, s[12:15], s7 offen offset:2560 sc1 lds
    v_mfma_f32_16x16x32_bf16 v[20:23], v[88:91], v[32:35], 0
    ds_read_b128 v[84:87], v14 offset:7168
    v_mfma_f32_16x16x32_bf16 v[20:23], v[92:95], v[36:39], v[20:23]
    s_waitcnt vmcnt(9)
    s_waitcnt lgkmcnt(6)
    v_mfma_f32_16x16x32_bf16 v[112:115], v[96:99], v[40:43], v[112:115]
    s_setprio 1
    ds_read_b128 v[88:91], v14 offset:8192
    v_mfma_f32_16x16x32_bf16 v[112:115], v[100:103], v[44:47], v[112:115]
    buffer_load_dwordx4 v[160:163], v5, s[12:15], s38 offen offset:0 sc1
    v_mfma_f32_16x16x32_bf16 v[116:119], v[96:99], v[56:59], v[116:119]
    ds_read_b128 v[92:95], v14 offset:9216
    v_mfma_f32_16x16x32_bf16 v[116:119], v[100:103], v[60:63], v[116:119]
    buffer_load_dwordx4 v[164:167], v5, s[12:15], s38 offen offset:1024 sc1
    s_add_u32 s38, s38, 4096
    s_waitcnt lgkmcnt(6)
    v_mfma_f32_16x16x32_bf16 v[120:123], v[104:107], v[40:43], v[120:123]
    ds_read_b128 v[96:99], v14 offset:10240
    v_mfma_f32_16x16x32_bf16 v[120:123], v[108:111], v[44:47], v[120:123]
    buffer_load_dwordx4 v[168:171], v5, s[12:15], s39 offen offset:0 sc1
    v_mfma_f32_16x16x32_bf16 v[124:127], v[104:107], v[56:59], v[124:127]
    ds_read_b128 v[100:103], v14 offset:11264
    v_mfma_f32_16x16x32_bf16 v[124:127], v[108:111], v[60:63], v[124:127]
    s_waitcnt lgkmcnt(6)
    v_mfma_f32_16x16x32_bf16 v[128:131], v[48:51], v[40:43], v[128:131]
    s_setprio 0
    ds_read_b128 v[104:107], v14 offset:12288
    v_mfma_f32_16x16x32_bf16 v[128:131], v[52:55], v[44:47], v[128:131]
    buffer_load_dwordx4 v[172:175], v5, s[12:15], s39 offen offset:1024 sc1
    s_add_u32 s39, s39, 4096
    v_mfma_f32_16x16x32_bf16 v[132:135], v[48:51], v[56:59], v[132:135]
    ds_read_b128 v[108:111], v14 offset:13312
    v_mfma_f32_16x16x32_bf16 v[132:135], v[52:55], v[60:63], v[132:135]
    s_waitcnt lgkmcnt(6)
    v_mfma_f32_16x16x32_bf16 v[136:139], v[80:83], v[40:43], v[136:139]
    s_setprio 3
    s_waitcnt vmcnt(17)
    s_waitcnt vmcnt(5)
    LM_chk11:
    v_cmp_gt_u32 vcc, 8, v13
    s_cbranch_vccnz LM_retry11
    LM_ok11:
    s_barrier
    v_add_u32 v14, 28672, v14
    ds_read_b128 v[48:51], v14 offset:0
    v_mfma_f32_16x16x32_bf16 v[136:139], v[84:87], v[44:47], v[136:139]
    s_mul_i32 s7, s59, 7
    s_add_u32 m0, s7, 0
    s_add_u32 s7, s7, s54
    s_add_u32 s7, s7, 114688
    s_mov_b32 exec_hi, 0
    buffer_load_dwordx4 v5, s[12:15], s7 offen offset:0 sc1 lds
    s_mov_b32 exec_hi, -1
    v_mfma_f32_16x16x32_bf16 v[140:143], v[80:83], v[56:59], v[140:143]
    ds_read_b128 v[52:55], v14 offset:1024
    v_mfma_f32_16x16x32_bf16 v[140:143], v[84:87], v[60:63], v[140:143]
    s_waitcnt lgkmcnt(6)
    v_mfma_f32_16x16x32_bf16 v[144:147], v[88:91], v[40:43], v[144:147]
    ds_read_b128 v[80:83], v14 offset:2048
    v_mfma_f32_16x16x32_bf16 v[144:147], v[92:95], v[44:47], v[144:147]
    buffer_load_dwordx4 v5, s[12:15], s7 offen offset:512 sc1 lds
    v_mfma_f32_16x16x32_bf16 v[148:151], v[88:91], v[56:59], v[148:151]
    ds_read_b128 v[84:87], v14 offset:3072
    v_mfma_f32_16x16x32_bf16 v[148:151], v[92:95], v[60:63], v[148:151]
    s_waitcnt lgkmcnt(6)
    v_mfma_f32_16x16x32_bf16 v[152:155], v[96:99], v[40:43], v[152:155]
    s_setprio 2
    ds_read_b128 v[88:91], v14 offset:4096
    v_mfma_f32_16x16x32_bf16 v[152:155], v[100:103], v[44:47], v[152:155]
    buffer_load_dwordx4 v5, s[12:15], s7 offen offset:1536 sc1 lds
    v_mfma_f32_16x16x32_bf16 v[156:159], v[96:99], v[56:59], v[156:159]
    ds_read_b128 v[92:95], v14 offset:5120
    v_mfma_f32_16x16x32_bf16 v[156:159], v[100:103], v[60:63], v[156:159]
    s_waitcnt lgkmcnt(6)
    v_mfma_f32_16x16x32_bf16 v[16:19], v[104:107], v[40:43], v[16:19]
    ds_read_b128 v[96:99], v14 offset:6144
    v_mfma_f32_16x16x32_bf16 v[16:19], v[108:111], v[44:47], v[16:19]
    buffer_load_dwordx4 v5, s[12:15], s7 offen offset:2560 sc1 lds
    v_mfma_f32_16x16x32_bf16 v[20:23], v[104:107], v[56:59], v[20:23]
    ds_read_b128 v[100:103], v14 offset:7168
    v_mfma_f32_16x16x32_bf16 v[20:23], v[108:111], v[60:63], v[20:23]
    s_waitcnt vmcnt(12)
    s_waitcnt lgkmcnt(6)
    v_mfma_f32_16x16x32_bf16 v[112:115], v[48:51], v[64:67], v[112:115]
    s_setprio 1
    ds_read_b128 v[104:107], v14 offset:8192
    v_mfma_f32_16x16x32_bf16 v[112:115], v[52:55], v[68:71], v[112:115]
    buffer_load_dwordx4 v[176:179], v5, s[12:15], s38 offen offset:0 sc1
    v_mfma_f32_16x16x32_bf16 v[116:119], v[48:51], v[72:75], v[116:119]
    ds_read_b128 v[108:111], v14 offset:9216
    v_mfma_f32_16x16x32_bf16 v[116:119], v[52:55], v[76:79], v[116:119]
    buffer_load_dwordx4 v[180:183], v5, s[12:15], s38 offen offset:1024 sc1
    s_add_u32 s38, s38, 4096
    s_waitcnt lgkmcnt(6)
    v_mfma_f32_16x16x32_bf16 v[120:123], v[80:83], v[64:67], v[120:123]
    ds_read_b128 v[48:51], v14 offset:10240
    v_mfma_f32_16x16x32_bf16 v[120:123], v[84:87], v[68:71], v[120:123]
    buffer_load_dwordx4 v[184:187], v5, s[12:15], s39 offen offset:0 sc1
    v_mfma_f32_16x16x32_bf16 v[124:127], v[80:83], v[72:75], v[124:127]
    ds_read_b128 v[52:55], v14 offset:11264
    v_mfma_f32_16x16x32_bf16 v[124:127], v[84:87], v[76:79], v[124:127]
    s_waitcnt lgkmcnt(6)
    v_mfma_f32_16x16x32_bf16 v[128:131], v[88:91], v[64:67], v[128:131]
    s_setprio 0
    ds_read_b128 v[80:83], v14 offset:12288
    v_mfma_f32_16x16x32_bf16 v[128:131], v[92:95], v[68:71], v[128:131]
    buffer_load_dwordx4 v[188:191], v5, s[12:15], s39 offen offset:1024 sc1
    s_add_u32 s39, s39, 4096
    v_mfma_f32_16x16x32_bf16 v[132:135], v[88:91], v[72:75], v[132:135]
    ds_read_b128 v[84:87], v14 offset:13312
    v_mfma_f32_16x16x32_bf16 v[132:135], v[92:95], v[76:79], v[132:135]
    s_waitcnt lgkmcnt(6)
    v_mfma_f32_16x16x32_bf16 v[136:139], v[96:99], v[64:67], v[136:139]
    s_setprio 3
    s_waitcnt vmcnt(12)
    s_barrier
    s_cmp_lg_u32 s24, 0
    s_cbranch_scc1 LM_ps12
    v_mov_b32 v1, 1
    s_mov_b64 exec, 0xff
    buffer_atomic_add v1, v8, s[12:15], s67 offen sc1
    s_mov_b64 exec, -1
    LM_ps12:
    v_add_u32 v14, 40960, v14
    ds_read_b128 v[88:91], v14 offset:0
    v_mfma_f32_16x16x32_bf16 v[136:139], v[100:103], v[68:71], v[136:139]
    s_mul_i32 s7, s59, 7
    s_add_u32 m0, s7, 36864
    s_add_u32 s7, s7, s54
    s_add_u32 s7, s7, 143360
    s_mov_b32 exec_hi, 0
    buffer_load_dwordx4 v5, s[12:15], s7 offen offset:0 sc1 lds
    s_mov_b32 exec_hi, -1
    v_mfma_f32_16x16x32_bf16 v[140:143], v[96:99], v[72:75], v[140:143]
    ds_read_b128 v[92:95], v14 offset:1024
    v_mfma_f32_16x16x32_bf16 v[140:143], v[100:103], v[76:79], v[140:143]
    s_waitcnt lgkmcnt(6)
    v_mfma_f32_16x16x32_bf16 v[144:147], v[104:107], v[64:67], v[144:147]
    ds_read_b128 v[96:99], v14 offset:2048
    v_mfma_f32_16x16x32_bf16 v[144:147], v[108:111], v[68:71], v[144:147]
    buffer_load_dwordx4 v5, s[12:15], s7 offen offset:512 sc1 lds
    v_mfma_f32_16x16x32_bf16 v[148:151], v[104:107], v[72:75], v[148:151]
    ds_read_b128 v[100:103], v14 offset:3072
    v_mfma_f32_16x16x32_bf16 v[148:151], v[108:111], v[76:79], v[148:151]
    s_waitcnt lgkmcnt(6)
    v_mfma_f32_16x16x32_bf16 v[152:155], v[48:51], v[64:67], v[152:155]
    s_setprio 2
    ds_read_b128 v[104:107], v14 offset:4096
    v_mfma_f32_16x16x32_bf16 v[152:155], v[52:55], v[68:71], v[152:155]
    buffer_load_dwordx4 v5, s[12:15], s7 offen offset:1536 sc1 lds
    v_mfma_f32_16x16x32_bf16 v[156:159], v[48:51], v[72:75], v[156:159]
    ds_read_b128 v[108:111], v14 offset:5120
    v_mfma_f32_16x16x32_bf16 v[156:159], v[52:55], v[76:79], v[156:159]
    s_waitcnt lgkmcnt(6)
    v_mfma_f32_16x16x32_bf16 v[16:19], v[80:83], v[64:67], v[16:19]
    ds_read_b128 v[48:51], v14 offset:6144
    v_mfma_f32_16x16x32_bf16 v[16:19], v[84:87], v[68:71], v[16:19]
    buffer_load_dwordx4 v5, s[12:15], s7 offen offset:2560 sc1 lds
    v_mfma_f32_16x16x32_bf16 v[20:23], v[80:83], v[72:75], v[20:23]
    ds_read_b128 v[52:55], v14 offset:7168
    v_mfma_f32_16x16x32_bf16 v[20:23], v[84:87], v[76:79], v[20:23]
    s_waitcnt vmcnt(12)
    s_waitcnt lgkmcnt(6)
    v_mfma_f32_16x16x32_bf16 v[112:115], v[88:91], v[160:163], v[112:115]
    s_setprio 1
    ds_read_b128 v[80:83], v14 offset:8192
    v_mfma_f32_16x16x32_bf16 v[112:115], v[92:95], v[164:167], v[112:115]
    buffer_load_dwordx4 v[192:195], v5, s[12:15], s38 offen offset:0 sc1
    v_mfma_f32_16x16x32_bf16 v[116:119], v[88:91], v[168:171], v[116:119]
    ds_read_b128 v[84:87], v14 offset:9216
    v_mfma_f32_16x16x32_bf16 v[116:119], v[92:95], v[172:175], v[116:119]
    buffer_load_dwordx4 v[196:199], v5, s[12:15], s38 offen offset:1024 sc1
    s_add_u32 s38, s38, 4096
    s_waitcnt lgkmcnt(6)
    v_mfma_f32_16x16x32_bf16 v[120:123], v[96:99], v[160:163], v[120:123]
    ds_read_b128 v[88:91], v14 offset:10240
    v_mfma_f32_16x16x32_bf16 v[120:123], v[100:103], v[164:167], v[120:123]
    buffer_load_dwordx4 v[200:203], v5, s[12:15], s39 offen offset:0 sc1
    v_mfma_f32_16x16x32_bf16 v[124:127], v[96:99], v[168:171], v[124:127]
    ds_read_b128 v[92:95], v14 offset:11264
    v_mfma_f32_16x16x32_bf16 v[124:127], v[100:103], v[172:175], v[124:127]
    s_waitcnt lgkmcnt(6)
    v_mfma_f32_16x16x32_bf16 v[128:131], v[104:107], v[160:163], v[128:131]
    s_setprio 0
    ds_read_b128 v[96:99], v14 offset:12288
    v_mfma_f32_16x16x32_bf16 v[128:131], v[108:111], v[164:167], v[128:131]
    buffer_load_dwordx4 v[204:207], v5, s[12:15], s39 offen offset:1024 sc1
    s_add_u32 s39, s39, 4096
    v_mfma_f32_16x16x32_bf16 v[132:135], v[104:107], v[168:171], v[132:135]
    ds_read_b128 v[100:103], v14 offset:13312
    v_mfma_f32_16x16x32_bf16 v[132:135], v[108:111], v[172:175], v[132:135]
    s_waitcnt lgkmcnt(6)
    v_mfma_f32_16x16x32_bf16 v[136:139], v[48:51], v[160:163], v[136:139]
    s_setprio 3
    s_waitcnt vmcnt(12)
    s_barrier
    v_add_u32 v14, 4294832128, v14
    ds_read_b128 v[104:107], v14 offset:0
    v_mfma_f32_16x16x32_bf16 v[136:139], v[52:55], v[164:167], v[136:139]
    s_mul_i32 s7, s59, 7
    s_add_u32 m0, s7, 65536
    s_add_u32 s7, s7, s54
    s_add_u32 s7, s7, 172032
    s_mov_b32 exec_hi, 0
    buffer_load_dwordx4 v5, s[12:15], s7 offen offset:0 sc1 lds
    s_mov_b32 exec_hi, -1
    v_mfma_f32_16x16x32_bf16 v[140:143], v[48:51], v[168:171], v[140:143]
    ds_read_b128 v[108:111], v14 offset:1024
    v_mfma_f32_16x16x32_bf16 v[140:143], v[52:55], v[172:175], v[140:143]
    s_waitcnt lgkmcnt(6)
    v_mfma_f32_16x16x32_bf16 v[144:147], v[80:83], v[160:163], v[144:147]
    ds_read_b128 v[48:51], v14 offset:2048
    v_mfma_f32_16x16x32_bf16 v[144:147], v[84:87], v[164:167], v[144:147]
    buffer_load_dwordx4 v5, s[12:15], s7 offen offset:512 sc1 lds
    v_mfma_f32_16x16x32_bf16 v[148:151], v[80:83], v[168:171], v[148:151]
    ds_read_b128 v[52:55], v14 offset:3072
    v_mfma_f32_16x16x32_bf16 v[148:151], v[84:87], v[172:175], v[148:151]
    s_waitcnt lgkmcnt(6)
    v_mfma_f32_16x16x32_bf16 v[152:155], v[88:91], v[160:163], v[152:155]
    s_setprio 2
    ds_read_b128 v[80:83], v14 offset:4096
    v_mfma_f32_16x16x32_bf16 v[152:155], v[92:95], v[164:167], v[152:155]
    buffer_load_dwordx4 v5, s[12:15], s7 offen offset:1536 sc1 lds
    v_mfma_f32_16x16x32_bf16 v[156:159], v[88:91], v[168:171], v[156:159]
    ds_read_b128 v[84:87], v14 offset:5120
    v_mfma_f32_16x16x32_bf16 v[156:159], v[92:95], v[172:175], v[156:159]
    s_waitcnt lgkmcnt(6)
    v_mfma_f32_16x16x32_bf16 v[16:19], v[96:99], v[160:163], v[16:19]
    ds_read_b128 v[88:91], v14 offset:6144
    v_mfma_f32_16x16x32_bf16 v[16:19], v[100:103], v[164:167], v[16:19]
    buffer_load_dwordx4 v5, s[12:15], s7 offen offset:2560 sc1 lds
    v_mfma_f32_16x16x32_bf16 v[20:23], v[96:99], v[168:171], v[20:23]
    ds_read_b128 v[92:95], v14 offset:7168
    v_mfma_f32_16x16x32_bf16 v[20:23], v[100:103], v[172:175], v[20:23]
    s_waitcnt vmcnt(12)
    s_waitcnt lgkmcnt(6)
    v_mfma_f32_16x16x32_bf16 v[112:115], v[104:107], v[176:179], v[112:115]
    s_setprio 1
    ds_read_b128 v[96:99], v14 offset:8192
    v_mfma_f32_16x16x32_bf16 v[112:115], v[108:111], v[180:183], v[112:115]
    buffer_load_dwordx4 v[208:211], v5, s[12:15], s38 offen offset:0 sc1
    v_mfma_f32_16x16x32_bf16 v[116:119], v[104:107], v[184:187], v[116:119]
    ds_read_b128 v[100:103], v14 offset:9216
    v_mfma_f32_16x16x32_bf16 v[116:119], v[108:111], v[188:191], v[116:119]
    buffer_load_dwordx4 v[212:215], v5, s[12:15], s38 offen offset:1024 sc1
    s_add_u32 s38, s38, 4096
    s_waitcnt lgkmcnt(6)
    v_mfma_f32_16x16x32_bf16 v[120:123], v[48:51], v[176:179], v[120:123]
    ds_read_b128 v[104:107], v14 offset:10240
    v_mfma_f32_16x16x32_bf16 v[120:123], v[52:55], v[180:183], v[120:123]
    buffer_load_dwordx4 v[216:219], v5, s[12:15], s39 offen offset:0 sc1
    v_mfma_f32_16x16x32_bf16 v[124:127], v[48:51], v[184:187], v[124:127]
    ds_read_b128 v[108:111], v14 offset:11264
    v_mfma_f32_16x16x32_bf16 v[124:127], v[52:55], v[188:191], v[124:127]
    s_waitcnt lgkmcnt(6)
    v_mfma_f32_16x16x32_bf16 v[128:131], v[80:83], v[176:179], v[128:131]
    s_setprio 0
    ds_read_b128 v[48:51], v14 offset:12288
    v_mfma_f32_16x16x32_bf16 v[128:131], v[84:87], v[180:183], v[128:131]
    buffer_load_dwordx4 v[220:223], v5, s[12:15], s39 offen offset:1024 sc1
    s_add_u32 s39, s39, 4096
    v_mfma_f32_16x16x32_bf16 v[132:135], v[80:83], v[184:187], v[132:135]
    ds_read_b128 v[52:55], v14 offset:13312
    v_mfma_f32_16x16x32_bf16 v[132:135], v[84:87], v[188:191], v[132:135]
    s_waitcnt lgkmcnt(6)
    v_mfma_f32_16x16x32_bf16 v[136:139], v[88:91], v[176:179], v[136:139]
    s_setprio 3
    s_waitcnt vmcnt(12)
    s_barrier
    v_add_u32 v14, 36864, v14
    ds_read_b128 v[80:83], v14 offset:0
    v_mfma_f32_16x16x32_bf16 v[136:139], v[92:95], v[180:183], v[136:139]
    s_mul_i32 s7, s59, 7
    s_add_u32 m0, s7, 94208
    s_add_u32 s7, s7, s54
    s_add_u32 s7, s7, 200704
    s_mov_b32 exec_hi, 0
    buffer_load_dwordx4 v5, s[12:15], s7 offen offset:0 sc1 lds
    s_mov_b32 exec_hi, -1
    v_mfma_f32_16x16x32_bf16 v[140:143], v[88:91], v[184:187], v[140:143]
    ds_read_b128 v[84:87], v14 offset:1024
    v_mfma_f32_16x16x32_bf16 v[140:143], v[92:95], v[188:191], v[140:143]
    s_waitcnt lgkmcnt(6)
    v_mfma_f32_16x16x32_bf16 v[144:147], v[96:99], v[176:179], v[144:147]
    ds_read_b128 v[88:91], v14 offset:2048
    v_mfma_f32_16x16x32_bf16 v[144:147], v[100:103], v[180:183], v[144:147]
    buffer_load_dwordx4 v5, s[12:15], s7 offen offset:512 sc1 lds
    v_mfma_f32_16x16x32_bf16 v[148:151], v[96:99], v[184:187], v[148:151]
    ds_read_b128 v[92:95], v14 offset:3072
    v_mfma_f32_16x16x32_bf16 v[148:151], v[100:103], v[188:191], v[148:151]
    s_waitcnt lgkmcnt(6)
    v_mfma_f32_16x16x32_bf16 v[152:155], v[104:107], v[176:179], v[152:155]
    s_setprio 2
    ds_read_b128 v[96:99], v14 offset:4096
    v_mfma_f32_16x16x32_bf16 v[152:155], v[108:111], v[180:183], v[152:155]
    buffer_load_dwordx4 v5, s[12:15], s7 offen offset:1536 sc1 lds
    v_mfma_f32_16x16x32_bf16 v[156:159], v[104:107], v[184:187], v[156:159]
    ds_read_b128 v[100:103], v14 offset:5120
    v_mfma_f32_16x16x32_bf16 v[156:159], v[108:111], v[188:191], v[156:159]
    v_mov_b32 v13, 64
    s_cmp_lg_u32 s24, 0
    s_cbranch_scc1 LM_l013
    s_and_b32 s29, s27, 7
    s_lshl_b64 exec, 1, s29
    v_mov_b32 v13, 0
    buffer_atomic_or v13, v8, s[12:15], s67 offen sc0 sc1
    s_mov_b64 exec, -1
    LM_l013:
    s_waitcnt lgkmcnt(6)
    v_mfma_f32_16x16x32_bf16 v[16:19], v[48:51], v[176:179], v[16:19]
    ds_read_b128 v[104:107], v14 offset:6144
    v_mfma_f32_16x16x32_bf16 v[16:19], v[52:55], v[180:183], v[16:19]
    buffer_load_dwordx4 v5, s[12:15], s7 offen offset:2560 sc1 lds
    v_mfma_f32_16x16x32_bf16 v[20:23], v[48:51], v[184:187], v[20:23]
    ds_read_b128 v[108:111], v14 offset:7168
    v_mfma_f32_16x16x32_bf16 v[20:23], v[52:55], v[188:191], v[20:23]
    s_waitcnt vmcnt(12)
    s_waitcnt lgkmcnt(6)
    v_mfma_f32_16x16x32_bf16 v[112:115], v[80:83], v[192:195], v[112:115]
    s_setprio 1
    ds_read_b128 v[48:51], v14 offset:8192
    v_mfma_f32_16x16x32_bf16 v[112:115], v[84:87], v[196:199], v[112:115]
    buffer_load_dwordx4 v[224:227], v5, s[12:15], s38 offen offset:0 sc1
    v_mfma_f32_16x16x32_bf16 v[116:119], v[80:83], v[200:203], v[116:119]
    ds_read_b128 v[52:55], v14 offset:9216
    v_mfma_f32_16x16x32_bf16 v[116:119], v[84:87], v[204:207], v[116:119]
    buffer_load_dwordx4 v[228:231], v5, s[12:15], s38 offen offset:1024 sc1
    s_add_u32 s38, s38, 4096
    s_waitcnt lgkmcnt(6)
    v_mfma_f32_16x16x32_bf16 v[120:123], v[88:91], v[192:195], v[120:123]
    ds_read_b128 v[80:83], v14 offset:10240
    v_mfma_f32_16x16x32_bf16 v[120:123], v[92:95], v[196:199], v[120:123]
    buffer_load_dwordx4 v[232:235], v5, s[12:15], s39 offen offset:0 sc1
    v_mfma_f32_16x16x32_bf16 v[124:127], v[88:91], v[200:203], v[124:127]
    ds_read_b128 v[84:87], v14 offset:11264
    v_mfma_f32_16x16x32_bf16 v[124:127], v[92:95], v[204:207], v[124:127]
    s_waitcnt lgkmcnt(6)
    v_mfma_f32_16x16x32_bf16 v[128:131], v[96:99], v[192:195], v[128:131]
    s_setprio 0
    ds_read_b128 v[88:91], v14 offset:12288
    v_mfma_f32_16x16x32_bf16 v[128:131], v[100:103], v[196:199], v[128:131]
    buffer_load_dwordx4 v[236:239], v5, s[12:15], s39 offen offset:1024 sc1
    s_add_u32 s39, s39, 4096
    v_mfma_f32_16x16x32_bf16 v[132:135], v[96:99], v[200:203], v[132:135]
    ds_read_b128 v[92:95], v14 offset:13312
    v_mfma_f32_16x16x32_bf16 v[132:135], v[100:103], v[204:207], v[132:135]
    s_waitcnt lgkmcnt(6)
    v_mfma_f32_16x16x32_bf16 v[136:139], v[104:107], v[192:195], v[136:139]
    s_setprio 3
    s_waitcnt vmcnt(12)
    s_waitcnt vmcnt(5)
    LM_chk14:
    v_cmp_gt_u32 vcc, 8, v13
    s_cbranch_vccnz LM_retry14
    LM_ok14:
    s_barrier
    v_add_u32 v14, 28672, v14
    ds_read_b128 v[96:99], v14 offset:0
    v_mfma_f32_16x16x32_bf16 v[136:139], v[108:111], v[196:199], v[136:139]
    s_mul_i32 s7, s59, 7
    s_add_u32 m0, s7, 135168
    s_add_u32 s7, s7, s54
    s_add_u32 s7, s7, 229376
    s_mov_b32 exec_hi, 0
    buffer_load_dwordx4 v5, s[12:15], s7 offen offset:0 sc1 lds
    s_mov_b32 exec_hi, -1
    v_mfma_f32_16x16x32_bf16 v[140:143], v[104:107], v[200:203], v[140:143]
    ds_read_b128 v[100:103], v14 offset:1024
    v_mfma_f32_16x16x32_bf16 v[140:143], v[108:111], v[204:207], v[140:143]
    s_waitcnt lgkmcnt(6)
    v_mfma_f32_16x16x32_bf16 v[144:147], v[48:51], v[192:195], v[144:147]
    ds_read_b128 v[104:107], v14 offset:2048
    v_mfma_f32_16x16x32_bf16 v[144:147], v[52:55], v[196:199], v[144:147]
    buffer_load_dwordx4 v5, s[12:15], s7 offen offset:512 sc1 lds
    v_mfma_f32_16x16x32_bf16 v[148:151], v[48:51], v[200:203], v[148:151]
    ds_read_b128 v[108:111], v14 offset:3072
    v_mfma_f32_16x16x32_bf16 v[148:151], v[52:55], v[204:207], v[148:151]
    s_waitcnt lgkmcnt(6)
    v_mfma_f32_16x16x32_bf16 v[152:155], v[80:83], v[192:195], v[152:155]
    s_setprio 2
    ds_read_b128 v[48:51], v14 offset:4096
    v_mfma_f32_16x16x32_bf16 v[152:155], v[84:87], v[196:199], v[152:155]
    buffer_load_dwordx4 v5, s[12:15], s7 offen offset:1536 sc1 lds
    v_mfma_f32_16x16x32_bf16 v[156:159], v[80:83], v[200:203], v[156:159]
    ds_read_b128 v[52:55], v14 offset:5120
    v_mfma_f32_16x16x32_bf16 v[156:159], v[84:87], v[204:207], v[156:159]
    s_waitcnt lgkmcnt(6)
    v_mfma_f32_16x16x32_bf16 v[16:19], v[88:91], v[192:195], v[16:19]
    ds_read_b128 v[80:83], v14 offset:6144
    v_mfma_f32_16x16x32_bf16 v[16:19], v[92:95], v[196:199], v[16:19]
    buffer_load_dwordx4 v5, s[12:15], s7 offen offset:2560 sc1 lds
    v_mfma_f32_16x16x32_bf16 v[20:23], v[88:91], v[200:203], v[20:23]
    ds_read_b128 v[84:87], v14 offset:7168
    v_mfma_f32_16x16x32_bf16 v[20:23], v[92:95], v[204:207], v[20:23]
    s_waitcnt vmcnt(12)
    s_waitcnt lgkmcnt(6)
    v_mfma_f32_16x16x32_bf16 v[112:115], v[96:99], v[208:211], v[112:115]
    s_setprio 1
    ds_read_b128 v[88:91], v14 offset:8192
    v_mfma_f32_16x16x32_bf16 v[112:115], v[100:103], v[212:215], v[112:115]
    buffer_load_dwordx4 v[240:243], v5, s[12:15], s38 offen offset:0 sc1
    v_mfma_f32_16x16x32_bf16 v[116:119], v[96:99], v[216:219], v[116:119]
    ds_read_b128 v[92:95], v14 offset:9216
    v_mfma_f32_16x16x32_bf16 v[116:119], v[100:103], v[220:223], v[116:119]
    buffer_load_dwordx4 v[244:247], v5, s[12:15], s38 offen offset:1024 sc1
    s_add_u32 s38, s38, 4096
    s_waitcnt lgkmcnt(6)
    v_mfma_f32_16x16x32_bf16 v[120:123], v[104:107], v[208:211], v[120:123]
    ds_read_b128 v[96:99], v14 offset:10240
    v_mfma_f32_16x16x32_bf16 v[120:123], v[108:111], v[212:215], v[120:123]
    buffer_load_dwordx4 v[248:251], v5, s[12:15], s39 offen offset:0 sc1
    v_mfma_f32_16x16x32_bf16 v[124:127], v[104:107], v[216:219], v[124:127]
    ds_read_b128 v[100:103], v14 offset:11264
    v_mfma_f32_16x16x32_bf16 v[124:127], v[108:111], v[220:223], v[124:127]
    s_waitcnt lgkmcnt(6)
    v_mfma_f32_16x16x32_bf16 v[128:131], v[48:51], v[208:211], v[128:131]
    s_setprio 0
    ds_read_b128 v[104:107], v14 offset:12288
    v_mfma_f32_16x16x32_bf16 v[128:131], v[52:55], v[212:215], v[128:131]
    buffer_load_dwordx4 v[252:255], v5, s[12:15], s39 offen offset:1024 sc1
    s_add_u32 s39, s39, 4096
    v_mfma_f32_16x16x32_bf16 v[132:135], v[48:51], v[216:219], v[132:135]
    ds_read_b128 v[108:111], v14 offset:13312
    v_mfma_f32_16x16x32_bf16 v[132:135], v[52:55], v[220:223], v[132:135]
    s_waitcnt lgkmcnt(6)
    v_mfma_f32_16x16x32_bf16 v[136:139], v[80:83], v[208:211], v[136:139]
    s_setprio 3
    s_waitcnt vmcnt(12)
    s_barrier
    v_add_u32 v14, 28672, v14
    ds_read_b128 v[48:51], v14 offset:0
    v_mfma_f32_16x16x32_bf16 v[136:139], v[84:87], v[212:215], v[136:139]
    s_mul_i32 s7, s59, 8
    s_add_u32 m0, s7, 0
    s_add_u32 s7, s7, s54
    s_add_u32 s7, s7, 258048
    buffer_load_dwordx4 v5, s[12:15], s7 offen offset:0 sc1 lds
    v_mfma_f32_16x16x32_bf16 v[140:143], v[80:83], v[216:219], v[140:143]
    ds_read_b128 v[52:55], v14 offset:1024
    v_mfma_f32_16x16x32_bf16 v[140:143], v[84:87], v[220:223], v[140:143]
    s_waitcnt lgkmcnt(6)
    v_mfma_f32_16x16x32_bf16 v[144:147], v[88:91], v[208:211], v[144:147]
    ds_read_b128 v[80:83], v14 offset:2048
    v_mfma_f32_16x16x32_bf16 v[144:147], v[92:95], v[212:215], v[144:147]
    buffer_load_dwordx4 v5, s[12:15], s7 offen offset:1024 sc1 lds
    v_mfma_f32_16x16x32_bf16 v[148:151], v[88:91], v[216:219], v[148:151]
    ds_read_b128 v[84:87], v14 offset:3072
    v_mfma_f32_16x16x32_bf16 v[148:151], v[92:95], v[220:223], v[148:151]
    s_waitcnt lgkmcnt(6)
    v_mfma_f32_16x16x32_bf16 v[152:155], v[96:99], v[208:211], v[152:155]
    s_setprio 2
    ds_read_b128 v[88:91], v14 offset:4096
    v_mfma_f32_16x16x32_bf16 v[152:155], v[100:103], v[212:215], v[152:155]
    buffer_load_dwordx4 v5, s[12:15], s7 offen offset:2048 sc1 lds
    v_mfma_f32_16x16x32_bf16 v[156:159], v[96:99], v[216:219], v[156:159]
    ds_read_b128 v[92:95], v14 offset:5120
    v_mfma_f32_16x16x32_bf16 v[156:159], v[100:103], v[220:223], v[156:159]
    s_waitcnt lgkmcnt(6)
    v_mfma_f32_16x16x32_bf16 v[16:19], v[104:107], v[208:211], v[16:19]
    ds_read_b128 v[96:99], v14 offset:6144
    v_mfma_f32_16x16x32_bf16 v[16:19], v[108:111], v[212:215], v[16:19]
    buffer_load_dwordx4 v5, s[12:15], s7 offen offset:3072 sc1 lds
    v_mfma_f32_16x16x32_bf16 v[20:23], v[104:107], v[216:219], v[20:23]
    ds_read_b128 v[100:103], v14 offset:7168
    v_mfma_f32_16x16x32_bf16 v[20:23], v[108:111], v[220:223], v[20:23]
    s_waitcnt vmcnt(12)
    s_waitcnt lgkmcnt(6)
    v_mfma_f32_16x16x32_bf16 v[112:115], v[48:51], v[224:227], v[112:115]
    s_setprio 1
    ds_read_b128 v[104:107], v14 offset:8192
    v_mfma_f32_16x16x32_bf16 v[112:115], v[52:55], v[228:231], v[112:115]
    v_mfma_f32_16x16x32_bf16 v[116:119], v[48:51], v[232:235], v[116:119]
    ds_read_b128 v[108:111], v14 offset:9216
    v_mfma_f32_16x16x32_bf16 v[116:119], v[52:55], v[236:239], v[116:119]
    s_waitcnt lgkmcnt(6)
    v_mfma_f32_16x16x32_bf16 v[120:123], v[80:83], v[224:227], v[120:123]
    ds_read_b128 v[48:51], v14 offset:10240
    v_mfma_f32_16x16x32_bf16 v[120:123], v[84:87], v[228:231], v[120:123]
    v_mfma_f32_16x16x32_bf16 v[124:127], v[80:83], v[232:235], v[124:127]
    ds_read_b128 v[52:55], v14 offset:11264
    v_mfma_f32_16x16x32_bf16 v[124:127], v[84:87], v[236:239], v[124:127]
    s_waitcnt lgkmcnt(6)
    v_mfma_f32_16x16x32_bf16 v[128:131], v[88:91], v[224:227], v[128:131]
    s_setprio 0
    ds_read_b128 v[80:83], v14 offset:12288
    v_mfma_f32_16x16x32_bf16 v[128:131], v[92:95], v[228:231], v[128:131]
    v_mfma_f32_16x16x32_bf16 v[132:135], v[88:91], v[232:235], v[132:135]
    ds_read_b128 v[84:87], v14 offset:13312
    v_mfma_f32_16x16x32_bf16 v[132:135], v[92:95], v[236:239], v[132:135]
    s_waitcnt lgkmcnt(6)
    v_mfma_f32_16x16x32_bf16 v[136:139], v[96:99], v[224:227], v[136:139]
    s_setprio 3
    s_waitcnt vmcnt(8)
    s_waitcnt lgkmcnt(0)
    s_barrier
    v_add_u32 v14, 40960, v14
    ds_read_b128 v[88:91], v14 offset:0
    v_mfma_f32_16x16x32_bf16 v[136:139], v[100:103], v[228:231], v[136:139]
    v_mfma_f32_16x16x32_bf16 v[140:143], v[96:99], v[232:235], v[140:143]
    ds_read_b128 v[92:95], v14 offset:1024
    v_mfma_f32_16x16x32_bf16 v[140:143], v[100:103], v[236:239], v[140:143]
    s_waitcnt lgkmcnt(6)
    v_mfma_f32_16x16x32_bf16 v[144:147], v[104:107], v[224:227], v[144:147]
    ds_read_b128 v[96:99], v14 offset:2048
    v_mfma_f32_16x16x32_bf16 v[144:147], v[108:111], v[228:231], v[144:147]
    s_mul_i32 s7, s59, 10
    s_add_u32 m0, s7, 32768
    s_add_u32 s7, s7, s54
    s_add_u32 s7, s7, 290816
    buffer_load_dwordx4 v5, s[12:15], s7 offen offset:0 sc1 lds
    v_mfma_f32_16x16x32_bf16 v[148:151], v[104:107], v[232:235], v[148:151]
    ds_read_b128 v[100:103], v14 offset:3072
    v_mfma_f32_16x16x32_bf16 v[148:151], v[108:111], v[236:239], v[148:151]
    s_waitcnt lgkmcnt(6)
    v_mfma_f32_16x16x32_bf16 v[152:155], v[48:51], v[224:227], v[152:155]
    s_setprio 2
    ds_read_b128 v[104:107], v14 offset:4096
    v_mfma_f32_16x16x32_bf16 v[152:155], v[52:55], v[228:231], v[152:155]
    buffer_load_dwordx4 v5, s[12:15], s7 offen offset:1024 sc1 lds
    v_mfma_f32_16x16x32_bf16 v[156:159], v[48:51], v[232:235], v[156:159]
    ds_read_b128 v[108:111], v14 offset:5120
    v_mfma_f32_16x16x32_bf16 v[156:159], v[52:55], v[236:239], v[156:159]
    s_waitcnt lgkmcnt(6)
    v_mfma_f32_16x16x32_bf16 v[16:19], v[80:83], v[224:227], v[16:19]
    ds_read_b128 v[48:51], v14 offset:6144
    v_mfma_f32_16x16x32_bf16 v[16:19], v[84:87], v[228:231], v[16:19]
    buffer_load_dwordx4 v5, s[12:15], s7 offen offset:2048 sc1 lds
    v_mfma_f32_16x16x32_bf16 v[20:23], v[80:83], v[232:235], v[20:23]
    ds_read_b128 v[52:55], v14 offset:7168
    v_mfma_f32_16x16x32_bf16 v[20:23], v[84:87], v[236:239], v[20:23]
    s_waitcnt vmcnt(7)
    s_waitcnt lgkmcnt(6)
    v_mfma_f32_16x16x32_bf16 v[116:119], v[88:91], v[248:251], v[116:119]
    s_setprio 1
    ds_read_b128 v[80:83], v14 offset:8192
    v_mfma_f32_16x16x32_bf16 v[116:119], v[92:95], v[252:255], v[116:119]
    buffer_load_dwordx4 v5, s[12:15], s7 offen offset:3072 sc1 lds
    v_mfma_f32_16x16x32_bf16 v[112:115], v[88:91], v[240:243], v[112:115]
    ds_read_b128 v[84:87], v14 offset:9216
    v_mfma_f32_16x16x32_bf16 v[112:115], v[92:95], v[244:247], v[112:115]
    s_waitcnt lgkmcnt(6)
    v_mfma_f32_16x16x32_bf16 v[124:127], v[96:99], v[248:251], v[124:127]
    ds_read_b128 v[88:91], v14 offset:10240
    v_mfma_f32_16x16x32_bf16 v[124:127], v[100:103], v[252:255], v[124:127]
    s_add_u32 m0, m0, 4096
    s_add_u32 s7, s7, 4096
    buffer_load_dwordx4 v5, s[12:15], s7 offen offset:0 sc1 lds
    v_mfma_f32_16x16x32_bf16 v[120:123], v[96:99], v[240:243], v[120:123]
    ds_read_b128 v[92:95], v14 offset:11264
    v_mfma_f32_16x16x32_bf16 v[120:123], v[100:103], v[244:247], v[120:123]
    s_waitcnt lgkmcnt(6)
    v_mfma_f32_16x16x32_bf16 v[132:135], v[104:107], v[248:251], v[132:135]
    s_setprio 0
    ds_read_b128 v[96:99], v14 offset:12288
    v_mfma_f32_16x16x32_bf16 v[132:135], v[108:111], v[252:255], v[132:135]
    ds_write_b128 v9, v[116:119] offset:0
    v_mfma_f32_16x16x32_bf16 v[128:131], v[104:107], v[240:243], v[128:131]
    ds_read_b128 v[100:103], v14 offset:13312
    v_mfma_f32_16x16x32_bf16 v[128:131], v[108:111], v[244:247], v[128:131]
    s_waitcnt lgkmcnt(6)
    v_mfma_f32_16x16x32_bf16 v[140:143], v[48:51], v[248:251], v[140:143]
    s_setprio 3
    s_waitcnt vmcnt(5)
    s_barrier
    s_lshl_b32 s29, s26, 12
    v_add_u32 v14, s29, v5
    ds_read_b128 v[104:107], v14 offset:0
    v_mfma_f32_16x16x32_bf16 v[140:143], v[52:55], v[252:255], v[140:143]
    ds_write_b128 v9, v[124:127] offset:1024
    v_mfma_f32_16x16x32_bf16 v[136:139], v[48:51], v[240:243], v[136:139]
    ds_read_b128 v[108:111], v14 offset:1024
    v_mfma_f32_16x16x32_bf16 v[136:139], v[52:55], v[244:247], v[136:139]
    s_waitcnt lgkmcnt(6)
    v_mfma_f32_16x16x32_bf16 v[148:151], v[80:83], v[248:251], v[148:151]
    ds_read_b128 v[48:51], v14 offset:2048
    v_mfma_f32_16x16x32_bf16 v[148:151], v[84:87], v[252:255], v[148:151]
    ds_write_b128 v9, v[132:135] offset:2048
    v_mfma_f32_16x16x32_bf16 v[144:147], v[80:83], v[240:243], v[144:147]
    ds_read_b128 v[52:55], v14 offset:3072
    v_mfma_f32_16x16x32_bf16 v[144:147], v[84:87], v[244:247], v[144:147]
    s_waitcnt lgkmcnt(6)
    v_mfma_f32_16x16x32_bf16 v[156:159], v[88:91], v[248:251], v[156:159]
    s_setprio 2
    ds_read_b128 v[80:83], v14 offset:8192
    v_mfma_f32_16x16x32_bf16 v[156:159], v[92:95], v[252:255], v[156:159]
    ds_write_b128 v9, v[140:143] offset:3072
    v_mfma_f32_16x16x32_bf16 v[152:155], v[88:91], v[240:243], v[152:155]
    ds_read_b128 v[84:87], v14 offset:9216
    v_mfma_f32_16x16x32_bf16 v[152:155], v[92:95], v[244:247], v[152:155]
    s_waitcnt lgkmcnt(6)
    v_mfma_f32_16x16x32_bf16 v[20:23], v[96:99], v[248:251], v[20:23]
    ds_read_b128 v[88:91], v14 offset:10240
    v_mfma_f32_16x16x32_bf16 v[20:23], v[100:103], v[252:255], v[20:23]
    ds_write_b128 v9, v[148:151] offset:4096
    v_mfma_f32_16x16x32_bf16 v[16:19], v[96:99], v[240:243], v[16:19]
    ds_read_b128 v[92:95], v14 offset:11264
    v_mfma_f32_16x16x32_bf16 v[16:19], v[100:103], v[244:247], v[16:19]
    s_waitcnt lgkmcnt(6)
    v_mfma_f32_16x16x32_bf16 v[116:119], v[104:107], v[24:27], 0
    s_setprio 1
    ds_read_b128 v[96:99], v14 offset:16384
    v_mfma_f32_16x16x32_bf16 v[116:119], v[108:111], v[28:31], v[116:119]
    ds_write_b128 v9, v[156:159] offset:5120
    v_mfma_f32_16x16x32_bf16 v[132:135], v[104:107], v[32:35], 0
    ds_read_b128 v[100:103], v14 offset:17408
    v_mfma_f32_16x16x32_bf16 v[132:135], v[108:111], v[36:39], v[132:135]
    ds_write_b128 v9, v[20:23] offset:6144
    s_waitcnt lgkmcnt(0)
    s_barrier
    ds_read_b128 v[148:151], v10 offset:0
    ds_read_b128 v[156:159], v10 offset:1024
    ds_read_b128 v[20:23], v10 offset:2048
    s_waitcnt lgkmcnt(6)
    v_mfma_f32_16x16x32_bf16 v[124:127], v[48:51], v[24:27], 0
    ds_read_b128 v[104:107], v14 offset:18432
    v_mfma_f32_16x16x32_bf16 v[124:127], v[52:55], v[28:31], v[124:127]
    v_mfma_f32_16x16x32_bf16 v[140:143], v[48:51], v[32:35], 0
    ds_read_b128 v[108:111], v14 offset:19456
    v_mfma_f32_16x16x32_bf16 v[140:143], v[52:55], v[36:39], v[140:143]
    s_waitcnt lgkmcnt(2)
    s_waitcnt lgkmcnt(6)
    v_mfma_f32_16x16x32_bf16 v[116:119], v[80:83], v[40:43], v[116:119]
    s_setprio 0
    ds_read_b128 v[48:51], v14 offset:24576
    v_add_f32 v112, v112, v148
    v_add_f32 v113, v113, v149
    v_add_f32 v114, v114, v150
    v_add_f32 v115, v115, v151
    ds_read_b128 v[148:151], v10 offset:3072
    v_cvt_pk_bf16_f32 v112, v112, v113
    v_mfma_f32_16x16x32_bf16 v[116:119], v[84:87], v[44:47], v[116:119]
    v_cvt_pk_bf16_f32 v113, v114, v115
    v_add_f32 v120, v120, v156
    v_add_f32 v121, v121, v157
    v_add_f32 v122, v122, v158
    v_add_f32 v123, v123, v159
    ds_read_b128 v[156:159], v10 offset:4096
    v_mfma_f32_16x16x32_bf16 v[132:135], v[80:83], v[56:59], v[132:135]
    ds_read_b128 v[52:55], v14 offset:25600
    v_cvt_pk_bf16_f32 v114, v120, v121
    v_cvt_pk_bf16_f32 v115, v122, v123
    buffer_store_dwordx4 v[112:115], v5, s[12:15], s40 offen sc1
    v_add_f32 v128, v128, v20
    v_add_f32 v129, v129, v21
    v_add_f32 v130, v130, v22
    v_mfma_f32_16x16x32_bf16 v[132:135], v[84:87], v[60:63], v[132:135]
    v_add_f32 v131, v131, v23
    ds_read_b128 v[20:23], v10 offset:5120
    v_cvt_pk_bf16_f32 v128, v128, v129
    v_cvt_pk_bf16_f32 v129, v130, v131
    s_waitcnt lgkmcnt(0)
    s_waitcnt lgkmcnt(6)
    v_mfma_f32_16x16x32_bf16 v[124:127], v[88:91], v[40:43], v[124:127]
    ds_read_b128 v[80:83], v14 offset:26624
    v_add_f32 v136, v136, v148
    v_add_f32 v137, v137, v149
    v_add_f32 v138, v138, v150
    v_add_f32 v139, v139, v151
    ds_read_b128 v[148:151], v10 offset:6144
    v_cvt_pk_bf16_f32 v130, v136, v137
    v_mfma_f32_16x16x32_bf16 v[124:127], v[92:95], v[44:47], v[124:127]
    v_cvt_pk_bf16_f32 v131, v138, v139
    buffer_store_dwordx4 v[128:131], v5, s[12:15], s41 offen sc1
    v_add_f32 v144, v144, v156
    v_add_f32 v145, v145, v157
    v_add_f32 v146, v146, v158
    v_add_f32 v147, v147, v159
    v_mfma_f32_16x16x32_bf16 v[140:143], v[88:91], v[56:59], v[140:143]
    ds_read_b128 v[84:87], v14 offset:27648
    v_cvt_pk_bf16_f32 v144, v144, v145
    v_cvt_pk_bf16_f32 v145, v146, v147
    v_add_f32 v152, v152, v20
    v_add_f32 v153, v153, v21
    v_add_f32 v154, v154, v22
    v_add_f32 v155, v155, v23
    v_mfma_f32_16x16x32_bf16 v[140:143], v[92:95], v[60:63], v[140:143]
    v_cvt_pk_bf16_f32 v146, v152, v153
    v_cvt_pk_bf16_f32 v147, v154, v155
    buffer_store_dwordx4 v[144:147], v5, s[12:15], s42 offen sc1
    s_waitcnt lgkmcnt(0)
    s_waitcnt lgkmcnt(6)
    v_mfma_f32_16x16x32_bf16 v[116:119], v[96:99], v[64:67], v[116:119]
    s_setprio 3
    s_waitcnt vmcnt(3)
    s_barrier
    v_add_u32 v14, 32768, v14
    ds_read_b128 v[88:91], v14 offset:0
    v_add_f32 v16, v16, v148
    v_add_f32 v17, v17, v149
    v_mfma_f32_16x16x32_bf16 v[116:119], v[100:103], v[68:71], v[116:119]
    v_add_f32 v18, v18, v150
    v_add_f32 v19, v19, v151
    v_mfma_f32_16x16x32_bf16 v[132:135], v[96:99], v[72:75], v[132:135]
    ds_read_b128 v[92:95], v14 offset:1024
    v_cvt_pk_bf16_f32 v148, v16, v17
    v_cvt_pk_bf16_f32 v149, v18, v19
    v_mfma_f32_16x16x32_bf16 v[132:135], v[100:103], v[76:79], v[132:135]
    buffer_store_dwordx2 v[148:149], v11, s[12:15], s43 offen sc1
    s_waitcnt lgkmcnt(6)
    v_mfma_f32_16x16x32_bf16 v[124:127], v[104:107], v[64:67], v[124:127]
    ds_read_b128 v[96:99], v14 offset:2048
    v_mfma_f32_16x16x32_bf16 v[124:127], v[108:111], v[68:71], v[124:127]
    v_mfma_f32_16x16x32_bf16 v[140:143], v[104:107], v[72:75], v[140:143]
    ds_read_b128 v[100:103], v14 offset:3072
    v_mfma_f32_16x16x32_bf16 v[140:143], v[108:111], v[76:79], v[140:143]
    s_waitcnt lgkmcnt(6)
    v_mfma_f32_16x16x32_bf16 v[116:119], v[48:51], v[160:163], v[116:119]
    ds_read_b128 v[104:107], v14 offset:8192
    v_mfma_f32_16x16x32_bf16 v[116:119], v[52:55], v[164:167], v[116:119]
    v_mfma_f32_16x16x32_bf16 v[132:135], v[48:51], v[168:171], v[132:135]
    ds_read_b128 v[108:111], v14 offset:9216
    v_mfma_f32_16x16x32_bf16 v[132:135], v[52:55], v[172:175], v[132:135]
    s_waitcnt lgkmcnt(6)
    v_mfma_f32_16x16x32_bf16 v[124:127], v[80:83], v[160:163], v[124:127]
    ds_read_b128 v[48:51], v14 offset:10240
    v_mfma_f32_16x16x32_bf16 v[124:127], v[84:87], v[164:167], v[124:127]
    v_mfma_f32_16x16x32_bf16 v[140:143], v[80:83], v[168:171], v[140:143]
    ds_read_b128 v[52:55], v14 offset:11264
    v_mfma_f32_16x16x32_bf16 v[140:143], v[84:87], v[172:175], v[140:143]
    s_waitcnt lgkmcnt(6)
    v_mfma_f32_16x16x32_bf16 v[116:119], v[88:91], v[176:179], v[116:119]
    s_setprio 2
    ds_read_b128 v[80:83], v14 offset:16384
    v_mfma_f32_16x16x32_bf16 v[116:119], v[92:95], v[180:183], v[116:119]
    buffer_load_dwordx4 v[24:27], v5, s[12:15], s51 offen sc1
    buffer_load_dwordx2 v[28:29], v11, s[12:15], s52 offen sc1
    v_mfma_f32_16x16x32_bf16 v[132:135], v[88:91], v[184:187], v[132:135]
    ds_read_b128 v[84:87], v14 offset:17408
    v_mfma_f32_16x16x32_bf16 v[132:135], v[92:95], v[188:191], v[132:135]
    s_waitcnt lgkmcnt(6)
    v_mfma_f32_16x16x32_bf16 v[124:127], v[96:99], v[176:179], v[124:127]
    ds_read_b128 v[88:91], v14 offset:18432
    v_mfma_f32_16x16x32_bf16 v[124:127], v[100:103], v[180:183], v[124:127]
    buffer_load_dword v32, v12, s[12:15], s36 offen offset:0 sc1
    v_mfma_f32_16x16x32_bf16 v[140:143], v[96:99], v[184:187], v[140:143]
    ds_read_b128 v[92:95], v14 offset:19456
    v_mfma_f32_16x16x32_bf16 v[140:143], v[100:103], v[188:191], v[140:143]
    buffer_load_dword v33, v12, s[12:15], s36 offen offset:64 sc1
    s_waitcnt lgkmcnt(6)
    v_mfma_f32_16x16x32_bf16 v[116:119], v[104:107], v[192:195], v[116:119]
    ds_read_b128 v[96:99], v14 offset:24576
    v_mfma_f32_16x16x32_bf16 v[116:119], v[108:111], v[196:199], v[116:119]
    buffer_load_dword v34, v12, s[12:15], s36 offen offset:128 sc1
    v_mfma_f32_16x16x32_bf16 v[132:135], v[104:107], v[200:203], v[132:135]
    ds_read_b128 v[100:103], v14 offset:25600
    v_mfma_f32_16x16x32_bf16 v[132:135], v[108:111], v[204:207], v[132:135]
    buffer_load_dword v35, v12, s[12:15], s36 offen offset:192 sc1
    s_waitcnt lgkmcnt(6)
    v_mfma_f32_16x16x32_bf16 v[124:127], v[48:51], v[192:195], v[124:127]
    s_setprio 1
    ds_read_b128 v[104:107], v14 offset:26624
    v_mfma_f32_16x16x32_bf16 v[124:127], v[52:55], v[196:199], v[124:127]
    v_lshlrev_b32 v2, 13, v0
    s_lshl_b32 s29, s48, 13
    s_sub_u32 s51, s10, s29
    v_mfma_f32_16x16x32_bf16 v[140:143], v[48:51], v[200:203], v[140:143]
    ds_read_b128 v[108:111], v14 offset:27648
    v_mfma_f32_16x16x32_bf16 v[140:143], v[52:55], v[204:207], v[140:143]
    s_waitcnt lgkmcnt(6)
    v_mfma_f32_16x16x32_bf16 v[116:119], v[80:83], v[208:211], v[116:119]
    ds_read_b128 v[48:51], v14 offset:32768
    v_mfma_f32_16x16x32_bf16 v[116:119], v[84:87], v[212:215], v[116:119]
    s_mul_i32 s29, s4, 9
    s_add_u32 s29, s29, s63
    s_add_u32 s35, s29, 4096
    v_mfma_f32_16x16x32_bf16 v[132:135], v[80:83], v[216:219], v[132:135]
    ds_read_b128 v[52:55], v14 offset:33792
    v_mfma_f32_16x16x32_bf16 v[132:135], v[84:87], v[220:223], v[132:135]
    s_lshl_b32 s30, s48, 10
    s_add_u32 s32, s29, s30
    s_waitcnt lgkmcnt(6)
    v_mfma_f32_16x16x32_bf16 v[124:127], v[88:91], v[208:211], v[124:127]
    ds_read_b128 v[80:83], v14 offset:34816
    v_mfma_f32_16x16x32_bf16 v[124:127], v[92:95], v[212:215], v[124:127]
    s_mul_i32 s29, s5, 9
    s_add_u32 s29, s29, s63
    s_add_u32 s37, s29, 4096
    v_mfma_f32_16x16x32_bf16 v[140:143], v[88:91], v[216:219], v[140:143]
    ds_read_b128 v[84:87], v14 offset:35840
    v_mfma_f32_16x16x32_bf16 v[140:143], v[92:95], v[220:223], v[140:143]
    s_lshl_b32 s30, s48, 10
    s_add_u32 s33, s29, s30
    s_waitcnt lgkmcnt(6)
    v_mfma_f32_16x16x32_bf16 v[116:119], v[96:99], v[224:227], v[116:119]
    s_mul_i32 s29, s9, 9
    s_add_u32 s29, s29, s63
    s_add_u32 s53, s29, 4096
    v_mfma_f32_16x16x32_bf16 v[116:119], v[100:103], v[228:231], v[116:119]
    s_lshl_b32 s30, s48, 10
    s_add_u32 s34, s29, s30
    v_mfma_f32_16x16x32_bf16 v[132:135], v[96:99], v[232:235], v[132:135]
    s_waitcnt vmcnt(6)
    s_lshl_b32 s29, 1, s48
    v_mov_b32 v1, 1
    s_xor_b32 exec_lo, s29, 15
    s_mov_b32 exec_hi, 0
    buffer_atomic_add v1, v2, s[12:15], s51 offen sc1
    s_mov_b64 exec, -1
    v_mfma_f32_16x16x32_bf16 v[132:135], v[100:103], v[236:239], v[132:135]
    s_waitcnt lgkmcnt(4)
    v_mfma_f32_16x16x32_bf16 v[124:127], v[104:107], v[224:227], v[124:127]
    s_setprio 0
    v_mfma_f32_16x16x32_bf16 v[124:127], v[108:111], v[228:231], v[124:127]
    v_mfma_f32_16x16x32_bf16 v[140:143], v[104:107], v[232:235], v[140:143]
    v_mfma_f32_16x16x32_bf16 v[140:143], v[108:111], v[236:239], v[140:143]
    s_waitcnt lgkmcnt(2)
    v_mfma_f32_16x16x32_bf16 v[132:135], v[48:51], v[248:251], v[132:135]
    v_mfma_f32_16x16x32_bf16 v[132:135], v[52:55], v[252:255], v[132:135]
    v_mfma_f32_16x16x32_bf16 v[116:119], v[48:51], v[240:243], v[116:119]
    v_mfma_f32_16x16x32_bf16 v[116:119], v[52:55], v[244:247], v[116:119]
    s_waitcnt lgkmcnt(0)
    v_mfma_f32_16x16x32_bf16 v[140:143], v[80:83], v[248:251], v[140:143]
    v_mfma_f32_16x16x32_bf16 v[140:143], v[84:87], v[252:255], v[140:143]
    v_mfma_f32_16x16x32_bf16 v[124:127], v[80:83], v[240:243], v[124:127]
    v_mfma_f32_16x16x32_bf16 v[124:127], v[84:87], v[244:247], v[124:127]
    s_mov_b64 exec, 1
    v_mov_b32 v13, 0
    buffer_atomic_or v13, v8, s[12:15], s10 offen sc0 sc1
    s_mov_b64 exec, -1
    ds_write_b128 v9, v[132:135]
    s_nop 2
    ds_write_b128 v9, v[140:143] offset:1024
    s_mov_b32 s20, s46
    s_mov_b32 s21, s47
    s_mov_b32 s22, 2359296
    s_mov_b32 s23, 0x20000
    v_mul_u32_u24 v3, 1152, v6
    v_lshl_add_u32 v3, v7, 3, v3
    v_and_b32 v4, 1, v7
    v_mul_u32_u24 v4, 24, v4
    v_add_u32 v4, v4, v3
    s_mul_i32 s38, s49, 18432
    s_lshl_b32 s29, s50, 8
    s_add_u32 s39, s38, s29
    s_lshl_b32 s29, s48, 6
    s_add_u32 s39, s39, s29
    s_lshl_b32 s29, s50, 5
    s_add_u32 s38, s38, s29
    s_waitcnt vmcnt(2)
    v_lshlrev_b32 v56, 16, v24
    v_and_b32 v57, 0xffff0000, v24
    v_lshlrev_b32 v58, 16, v25
    v_and_b32 v59, 0xffff0000, v25
    v_lshlrev_b32 v60, 16, v26
    v_and_b32 v61, 0xffff0000, v26
    v_lshlrev_b32 v62, 16, v27
    v_and_b32 v63, 0xffff0000, v27
    v_lshlrev_b32 v64, 16, v28
    v_and_b32 v65, 0xffff0000, v28
    v_lshlrev_b32 v66, 16, v29
    v_and_b32 v67, 0xffff0000, v29
    v_add_f32 v32, v32, v33
    v_add_f32 v34, v34, v35
    v_add_f32 v32, v32, v34
    v_mov_b32 v33, v32
    s_nop 1
    v_permlane32_swap_b32 v32, v33
    s_nop 1
    v_add_f32 v32, v32, v33
    v_mov_b32 v33, v32
    s_nop 1
    v_permlane16_swap_b32 v32, v33
    s_nop 1
    v_add_f32 v32, v32, v33
    v_mul_f32 v32, 0x3ae38e39, v32
    v_max_f32 v32, 0, v32
    v_cvt_pk_bf16_f32 v32, v32, v32
    v_lshlrev_b32 v32, 16, v32
    v_add_f32 v32, 0x3727c5ac, v32
    v_cvt_pk_bf16_f32 v32, v32, v32
    v_lshlrev_b32 v32, 16, v32
    v_sqrt_f32 v32, v32
    s_nop 0
    v_cvt_pk_bf16_f32 v32, v32, v32
    v_lshlrev_b32 v32, 16, v32
    v_rcp_f32 v33, v32
    s_nop 0
    v_mul_f32 v32, v33, v33
    v_mov_b32 v33, v32
    s_waitcnt vmcnt(0)
    v_readfirstlane_b32 s31, v13
    s_cmp_lt_u32 s31, 3
    s_cbranch_scc1 LM_f0
    buffer_load_dwordx4 v[160:163], v5, s[12:15], s32 offen sc1
    buffer_load_dwordx4 v[164:167], v5, s[12:15], s33 offen sc1
    buffer_load_dwordx4 v[168:171], v5, s[12:15], s34 offen sc1
    s_cmp_lg_u32 s25, s48
    s_cbranch_scc1 LM_f20
    buffer_load_dwordx2 v[172:173], v11, s[12:15], s35 offen sc1
    buffer_load_dwordx2 v[174:175], v11, s[12:15], s37 offen sc1
    buffer_load_dwordx2 v[176:177], v11, s[12:15], s53 offen sc1
LM_f20:
LM_f0:
    s_waitcnt lgkmcnt(0)
    s_barrier
    ds_read_b128 v[132:135], v10 offset:0
    ds_read_b128 v[140:143], v10 offset:1024
    s_waitcnt lgkmcnt(0)
    v_pk_add_f32 v[116:117], v[116:117], v[132:133]
    v_pk_add_f32 v[118:119], v[118:119], v[134:135]
    v_pk_add_f32 v[124:125], v[124:125], v[140:141]
    v_pk_add_f32 v[126:127], v[126:127], v[142:143]
    s_cmp_ge_u32 s31, 3
    s_cbranch_scc1 LM_f1
    s_mov_b64 exec, 1
    LM_ap15:
    v_mov_b32 v1, 0
    s_sub_u32 s60, s60, 1
    buffer_atomic_or v1, v8, s[12:15], s10 offen sc0 sc1
    s_cmp_lt_i32 s60, 1
    s_waitcnt vmcnt(0)
    v_cmp_gt_u32 vcc, 3, v1
    s_cbranch_scc1 LM_aq15
    s_cbranch_vccnz LM_ap15
    LM_aq15:
    s_mov_b64 exec, -1
    buffer_load_dwordx4 v[160:163], v5, s[12:15], s32 offen sc1
    buffer_load_dwordx4 v[164:167], v5, s[12:15], s33 offen sc1
    buffer_load_dwordx4 v[168:171], v5, s[12:15], s34 offen sc1
    s_cmp_lg_u32 s25, s48
    s_cbranch_scc1 LM_f21
    buffer_load_dwordx2 v[172:173], v11, s[12:15], s35 offen sc1
    buffer_load_dwordx2 v[174:175], v11, s[12:15], s37 offen sc1
    buffer_load_dwordx2 v[176:177], v11, s[12:15], s53 offen sc1
LM_f21:
LM_f1:
    s_waitcnt vmcnt(0)
    v_lshlrev_b32 v180, 16, v160
    v_and_b32 v181, 0xffff0000, v160
    v_lshlrev_b32 v182, 16, v161
    v_and_b32 v183, 0xffff0000, v161
    v_pk_add_f32 v[116:117], v[116:117], v[180:181]
    v_pk_add_f32 v[118:119], v[118:119], v[182:183]
    v_lshlrev_b32 v180, 16, v164
    v_and_b32 v181, 0xffff0000, v164
    v_lshlrev_b32 v182, 16, v165
    v_and_b32 v183, 0xffff0000, v165
    v_pk_add_f32 v[116:117], v[116:117], v[180:181]
    v_pk_add_f32 v[118:119], v[118:119], v[182:183]
    v_lshlrev_b32 v180, 16, v168
    v_and_b32 v181, 0xffff0000, v168
    v_lshlrev_b32 v182, 16, v169
    v_and_b32 v183, 0xffff0000, v169
    v_pk_add_f32 v[116:117], v[116:117], v[180:181]
    v_pk_add_f32 v[118:119], v[118:119], v[182:183]
    v_pk_fma_f32 v[116:117], v[116:117], v[32:33], v[56:57]
    v_pk_fma_f32 v[118:119], v[118:119], v[32:33], v[58:59]
    v_cvt_pk_bf16_f32 v24, v116, v117
    v_cvt_pk_bf16_f32 v25, v118, v119
    v_lshlrev_b32 v180, 16, v162
    v_and_b32 v181, 0xffff0000, v162
    v_lshlrev_b32 v182, 16, v163
    v_and_b32 v183, 0xffff0000, v163
    v_pk_add_f32 v[124:125], v[124:125], v[180:181]
    v_pk_add_f32 v[126:127], v[126:127], v[182:183]
    v_lshlrev_b32 v180, 16, v166
    v_and_b32 v181, 0xffff0000, v166
    v_lshlrev_b32 v182, 16, v167
    v_and_b32 v183, 0xffff0000, v167
    v_pk_add_f32 v[124:125], v[124:125], v[180:181]
    v_pk_add_f32 v[126:127], v[126:127], v[182:183]
    v_lshlrev_b32 v180, 16, v170
    v_and_b32 v181, 0xffff0000, v170
    v_lshlrev_b32 v182, 16, v171
    v_and_b32 v183, 0xffff0000, v171
    v_pk_add_f32 v[124:125], v[124:125], v[180:181]
    v_pk_add_f32 v[126:127], v[126:127], v[182:183]
    v_pk_fma_f32 v[124:125], v[124:125], v[32:33], v[60:61]
    v_pk_fma_f32 v[126:127], v[126:127], v[32:33], v[62:63]
    v_cvt_pk_bf16_f32 v26, v124, v125
    v_cvt_pk_bf16_f32 v27, v126, v127
    s_nop 1
    v_permlane16_swap_b32 v24, v26
    v_permlane16_swap_b32 v25, v27
    buffer_store_dwordx4 v[24:27], v4, s[20:23], s39 offen
    s_cmp_lg_u32 s25, s48
    s_cbranch_scc1 LM_f3
    v_lshlrev_b32 v180, 16, v172
    v_and_b32 v181, 0xffff0000, v172
    v_lshlrev_b32 v182, 16, v173
    v_and_b32 v183, 0xffff0000, v173
    v_pk_add_f32 v[16:17], v[16:17], v[180:181]
    v_pk_add_f32 v[18:19], v[18:19], v[182:183]
    v_lshlrev_b32 v180, 16, v174
    v_and_b32 v181, 0xffff0000, v174
    v_lshlrev_b32 v182, 16, v175
    v_and_b32 v183, 0xffff0000, v175
    v_pk_add_f32 v[16:17], v[16:17], v[180:181]
    v_pk_add_f32 v[18:19], v[18:19], v[182:183]
    v_lshlrev_b32 v180, 16, v176
    v_and_b32 v181, 0xffff0000, v176
    v_lshlrev_b32 v182, 16, v177
    v_and_b32 v183, 0xffff0000, v177
    v_pk_add_f32 v[16:17], v[16:17], v[180:181]
    v_pk_add_f32 v[18:19], v[18:19], v[182:183]
    v_pk_fma_f32 v[16:17], v[16:17], v[32:33], v[64:65]
    v_pk_fma_f32 v[18:19], v[18:19], v[32:33], v[66:67]
    v_cvt_pk_bf16_f32 v28, v16, v17
    v_cvt_pk_bf16_f32 v29, v18, v19
    buffer_store_dwordx2 v[28:29], v3, s[20:23], s38 offen offset:1024
LM_f3:
    s_endpgm
LA_cnt0:
    s_cmp_lt_i32 s60, 1
    s_cbranch_scc1 LA_cntok0
    s_sub_u32 s60, s60, 1
    s_sleep 2
    global_load_dword v220, v221, s[56:57] sc1
    s_waitcnt vmcnt(0)
    s_branch LA_cntchk0
LA_cnt1:
    s_cmp_lt_i32 s60, 1
    s_cbranch_scc1 LA_cntok1
    s_sub_u32 s60, s60, 1
    s_sleep 2
    global_load_dword v220, v221, s[56:57] sc1
    s_waitcnt vmcnt(0)
    s_branch LA_cntchk1
LM_cnt:
    s_cmp_lt_i32 s60, 1
    s_cbranch_scc1 LM_cntok
    s_sub_u32 s60, s60, 1
    s_sleep 2
    global_load_dword v4, v3, s[56:57] sc1
    s_waitcnt vmcnt(0)
    s_branch LM_cntchk
LM_pkg:
    s_sub_u32 s56, s56, 324
    s_cmp_lt_u32 s56, 72
    s_cselect_b32 s18, 5308416, 0
    s_cselect_b32 s58, 0, 0x40000000
    s_lshl_b32 s31, s31, 1
    s_cmp_ge_u32 s56, 36
    s_cselect_b32 s29, 36, 0
    s_addc_u32 s31, s31, 0
    s_sub_u32 s56, s56, s29
    s_lshl_b32 s29, s56, 10
    s_add_u32 s58, s58, s29
    s_mul_i32 s29, s31, 147456
    s_add_u32 s58, s58, s29
    s_add_u32 s58, s58, 51904512
    s_add_u32 s61, s58, 36864
    s_add_u32 s62, s61, 36864
    s_add_u32 s63, s62, 36864
    s_cmp_ge_u32 s56, 18
    s_cselect_b32 s16, s42, s40
    s_cselect_b32 s17, s43, s41
    s_cselect_b32 s29, 18, 0
    s_sub_u32 s56, s56, s29
    s_mul_i32 s54, s56, 294912
    s_cmp_ge_u32 s56, 16
    s_cselect_b32 s56, 4, 0
    s_mul_i32 s29, s31, 1152
    s_add_u32 s54, s54, s29
    s_add_u32 s54, s54, 1024
    s_mov_b32 s55, 147456
    s_mov_b32 s31, 9216
    s_branch LM_pkd
LM_rc:
    s_cmp_lt_i32 s60, 1
    s_cbranch_scc1 LM_rcok
    s_sub_u32 s60, s60, 1
    s_sleep 2
    global_load_dword v191, v190, s[0:1] offset:128 sc1
    s_waitcnt vmcnt(0)
    s_branch LM_rcchk
LM_exact:
    s_mov_b32 s32, 1
    s_barrier
    s_add_u32 m0, s39, 0
    s_add_u32 s29, m0, s34
    buffer_load_dwordx4 v5, s[12:15], s29 offen sc1 lds
    s_add_u32 m0, s38, 0
    s_add_u32 s29, m0, s34
    buffer_load_dwordx4 v5, s[12:15], s29 offen sc1 lds
    s_add_u32 m0, s35, 0
    s_add_u32 s29, m0, s34
    buffer_load_dwordx4 v5, s[12:15], s29 offen sc1 lds
    s_add_u32 m0, s35, 4096
    s_add_u32 s29, m0, s34
    buffer_load_dwordx4 v5, s[12:15], s29 offen sc1 lds
    s_add_u32 m0, s39, 4096
    s_add_u32 s29, m0, s34
    buffer_load_dwordx4 v5, s[12:15], s29 offen sc1 lds
    s_add_u32 m0, s35, 8192
    s_add_u32 s29, m0, s34
    buffer_load_dwordx4 v5, s[12:15], s29 offen sc1 lds
    s_add_u32 m0, s39, 8192
    s_add_u32 s29, m0, s34
    buffer_load_dwordx4 v5, s[12:15], s29 offen sc1 lds
    s_add_u32 m0, s35, 12288
    s_add_u32 s29, m0, s34
    buffer_load_dwordx4 v5, s[12:15], s29 offen sc1 lds
    s_add_u32 m0, s39, 12288
    s_add_u32 s29, m0, s34
    buffer_load_dwordx4 v5, s[12:15], s29 offen sc1 lds
    s_add_u32 m0, s35, 16384
    s_add_u32 s29, m0, s34
    buffer_load_dwordx4 v5, s[12:15], s29 offen sc1 lds
    s_add_u32 m0, s39, 16384
    s_add_u32 s29, m0, s34
    buffer_load_dwordx4 v5, s[12:15], s29 offen sc1 lds
    s_add_u32 m0, s35, 20480
    s_add_u32 s29, m0, s34
    buffer_load_dwordx4 v5, s[12:15], s29 offen sc1 lds
    s_add_u32 m0, s39, 20480
    s_add_u32 s29, m0, s34
    buffer_load_dwordx4 v5, s[12:15], s29 offen sc1 lds
    s_add_u32 m0, s35, 24576
    s_add_u32 s29, m0, s34
    buffer_load_dwordx4 v5, s[12:15], s29 offen sc1 lds
    s_add_u32 m0, s39, 24576
    s_add_u32 s29, m0, s34
    buffer_load_dwordx4 v5, s[12:15], s29 offen sc1 lds
    s_add_u32 m0, s35, 28672
    s_add_u32 s29, m0, s34
    buffer_load_dwordx4 v5, s[12:15], s29 offen sc1 lds
    s_add_u32 m0, s39, 28672
    s_add_u32 s29, m0, s34
    buffer_load_dwordx4 v5, s[12:15], s29 offen sc1 lds
    s_add_u32 m0, s35, 32768
    s_add_u32 s29, m0, s34
    buffer_load_dwordx4 v5, s[12:15], s29 offen sc1 lds
    s_mov_b32 s33, 32
    v_mov_b32 v133, 0
    v_mov_b32 v3, 0xff800000
    v_mov_b32 v4, 0xff800000
    v_mov_b32 v184, v5
    v_lshlrev_b32 v185, 2, v0
    v_add_u32 v185, 139264, v185
    s_waitcnt vmcnt(0)
    s_barrier
LM_maxloop:
    ds_read_b128 v[136:139], v184
    ds_read_b128 v[140:143], v184 offset:1024
    ds_read_b32 v160, v185
    v_add_u32 v184, 2048, v184
    v_add_u32 v185, 256, v185
    s_waitcnt lgkmcnt(0)
    v_mfma_f32_32x32x4_2b_bf16 v[12:43], v[160:161], v[132:133], 0 cbsz:1 abid:0
    v_mfma_f32_32x32x4_2b_bf16 v[44:75], v[160:161], v[132:133], 0 cbsz:1 abid:1
    s_nop 15
    s_nop 1
    v_mfma_f32_32x32x16_bf16 v[12:27], v[136:139], v[124:127], v[12:27]
    v_mfma_f32_32x32x16_bf16 v[28:43], v[136:139], v[128:131], v[28:43]
    v_mfma_f32_32x32x16_bf16 v[44:59], v[140:143], v[124:127], v[44:59]
    v_mfma_f32_32x32x16_bf16 v[60:75], v[140:143], v[128:131], v[60:75]
    s_nop 11
    v_max3_f32 v3, v12, v13, v3
    v_max3_f32 v3, v14, v15, v3
    v_max3_f32 v3, v16, v17, v3
    v_max3_f32 v3, v18, v19, v3
    v_max3_f32 v3, v20, v21, v3
    v_max3_f32 v3, v22, v23, v3
    v_max3_f32 v3, v24, v25, v3
    v_max3_f32 v3, v26, v27, v3
    v_max3_f32 v4, v28, v29, v4
    v_max3_f32 v4, v30, v31, v4
    v_max3_f32 v4, v32, v33, v4
    v_max3_f32 v4, v34, v35, v4
    v_max3_f32 v4, v36, v37, v4
    v_max3_f32 v4, v38, v39, v4
    v_max3_f32 v4, v40, v41, v4
    v_max3_f32 v4, v42, v43, v4
    v_max3_f32 v3, v44, v45, v3
    v_max3_f32 v3, v46, v47, v3
    v_max3_f32 v3, v48, v49, v3
    v_max3_f32 v3, v50, v51, v3
    v_max3_f32 v3, v52, v53, v3
    v_max3_f32 v3, v54, v55, v3
    v_max3_f32 v3, v56, v57, v3
    v_max3_f32 v3, v58, v59, v3
    v_max3_f32 v4, v60, v61, v4
    v_max3_f32 v4, v62, v63, v4
    v_max3_f32 v4, v64, v65, v4
    v_max3_f32 v4, v66, v67, v4
    v_max3_f32 v4, v68, v69, v4
    v_max3_f32 v4, v70, v71, v4
    v_max3_f32 v4, v72, v73, v4
    v_max3_f32 v4, v74, v75, v4
    s_sub_u32 s33, s33, 1
    s_cmp_lg_u32 s33, 0
    s_cbranch_scc1 LM_maxloop
    v_mov_b32 v1, v3
    v_mov_b32 v2, v4
    s_mov_b32 s33, 16
    s_nop 0
    v_permlane32_swap_b32 v1, v3
    v_permlane32_swap_b32 v2, v4
    s_nop 1
    v_max_f32 v3, v1, v3
    v_max_f32 v4, v2, v4
    v_mov_b32 v76, 0
    v_mov_b32 v77, 0
    v_mov_b32 v78, 0
    v_mov_b32 v79, 0
    v_mov_b32 v80, 0
    v_mov_b32 v81, 0
    v_mov_b32 v82, 0
    v_mov_b32 v83, 0
    v_mov_b32 v84, 0
    v_mov_b32 v85, 0
    v_mov_b32 v86, 0
    v_mov_b32 v87, 0
    v_mov_b32 v88, 0
    v_mov_b32 v89, 0
    v_mov_b32 v90, 0
    v_mov_b32 v91, 0
    v_mov_b32 v92, 0
    v_mov_b32 v93, 0
    v_mov_b32 v94, 0
    v_mov_b32 v95, 0
    v_mov_b32 v96, 0
    v_mov_b32 v97, 0
    v_mov_b32 v98, 0
    v_mov_b32 v99, 0
    v_mov_b32 v100, 0
    v_mov_b32 v101, 0
    v_mov_b32 v102, 0
    v_mov_b32 v103, 0
    v_mov_b32 v104, 0
    v_mov_b32 v105, 0
    v_mov_b32 v106, 0
    v_mov_b32 v107, 0
LM_slow:
    ds_read_b128 v[136:139], v180
    ds_read_b128 v[140:143], v180 offset:1024
    ds_read_b32 v160, v181
    s_mov_b64 exec, s[48:49]
    ds_read_b128 v[164:167], v182 offset:0
    ds_read_b128 v[168:171], v183 offset:0
    s_mov_b64 exec, -1
    s_mov_b64 exec, s[48:49]
    ds_read_b128 v[172:175], v182 offset:1152
    ds_read_b128 v[176:179], v183 offset:1152
    s_mov_b64 exec, -1
    v_add_u32 v180, 2048, v180
    v_add_u32 v181, 256, v181
    v_add_u32 v182, 2304, v182
    v_add_u32 v183, 2304, v183
    s_waitcnt lgkmcnt(0)
    v_mfma_f32_32x32x4_2b_bf16 v[12:43], v[160:161], v[132:133], 0 cbsz:1 abid:0
    v_mfma_f32_32x32x4_2b_bf16 v[44:75], v[160:161], v[132:133], 0 cbsz:1 abid:1
    s_nop 15
    s_nop 1
    v_mfma_f32_32x32x16_bf16 v[12:27], v[136:139], v[124:127], v[12:27]
    v_mfma_f32_32x32x16_bf16 v[28:43], v[136:139], v[128:131], v[28:43]
    v_mfma_f32_32x32x16_bf16 v[44:59], v[140:143], v[124:127], v[44:59]
    v_mfma_f32_32x32x16_bf16 v[60:75], v[140:143], v[128:131], v[60:75]
    s_nop 11
    v_sub_f32 v12, v12, v3
    v_sub_f32 v13, v13, v3
    v_sub_f32 v14, v14, v3
    v_sub_f32 v15, v15, v3
    v_sub_f32 v16, v16, v3
    v_sub_f32 v17, v17, v3
    v_sub_f32 v18, v18, v3
    v_sub_f32 v19, v19, v3
    v_sub_f32 v20, v20, v3
    v_sub_f32 v21, v21, v3
    v_sub_f32 v22, v22, v3
    v_sub_f32 v23, v23, v3
    v_sub_f32 v24, v24, v3
    v_sub_f32 v25, v25, v3
    v_sub_f32 v26, v26, v3
    v_sub_f32 v27, v27, v3
    v_exp_f32 v12, v12
    v_exp_f32 v13, v13
    v_exp_f32 v14, v14
    v_exp_f32 v15, v15
    v_exp_f32 v16, v16
    v_exp_f32 v17, v17
    v_exp_f32 v18, v18
    v_exp_f32 v19, v19
    v_exp_f32 v20, v20
    v_exp_f32 v21, v21
    v_exp_f32 v22, v22
    v_exp_f32 v23, v23
    v_exp_f32 v24, v24
    v_exp_f32 v25, v25
    v_exp_f32 v26, v26
    v_exp_f32 v27, v27
    v_cvt_pk_bf16_f32 v108, v12, v13
    v_cvt_pk_bf16_f32 v109, v14, v15
    v_cvt_pk_bf16_f32 v110, v16, v17
    v_cvt_pk_bf16_f32 v111, v18, v19
    v_cvt_pk_bf16_f32 v112, v20, v21
    v_cvt_pk_bf16_f32 v113, v22, v23
    v_cvt_pk_bf16_f32 v114, v24, v25
    v_cvt_pk_bf16_f32 v115, v26, v27
    s_nop 1
    v_mfma_f32_32x32x16_bf16 v[76:91], v[164:167], v[108:111], v[76:91]
    v_mfma_f32_32x32x16_bf16 v[76:91], v[168:171], v[112:115], v[76:91]
    v_sub_f32 v28, v28, v4
    v_sub_f32 v29, v29, v4
    v_sub_f32 v30, v30, v4
    v_sub_f32 v31, v31, v4
    v_sub_f32 v32, v32, v4
    v_sub_f32 v33, v33, v4
    v_sub_f32 v34, v34, v4
    v_sub_f32 v35, v35, v4
    v_sub_f32 v36, v36, v4
    v_sub_f32 v37, v37, v4
    v_sub_f32 v38, v38, v4
    v_sub_f32 v39, v39, v4
    v_sub_f32 v40, v40, v4
    v_sub_f32 v41, v41, v4
    v_sub_f32 v42, v42, v4
    v_sub_f32 v43, v43, v4
    v_exp_f32 v28, v28
    v_exp_f32 v29, v29
    v_exp_f32 v30, v30
    v_exp_f32 v31, v31
    v_exp_f32 v32, v32
    v_exp_f32 v33, v33
    v_exp_f32 v34, v34
    v_exp_f32 v35, v35
    v_exp_f32 v36, v36
    v_exp_f32 v37, v37
    v_exp_f32 v38, v38
    v_exp_f32 v39, v39
    v_exp_f32 v40, v40
    v_exp_f32 v41, v41
    v_exp_f32 v42, v42
    v_exp_f32 v43, v43
    v_cvt_pk_bf16_f32 v116, v28, v29
    v_cvt_pk_bf16_f32 v117, v30, v31
    v_cvt_pk_bf16_f32 v118, v32, v33
    v_cvt_pk_bf16_f32 v119, v34, v35
    v_cvt_pk_bf16_f32 v120, v36, v37
    v_cvt_pk_bf16_f32 v121, v38, v39
    v_cvt_pk_bf16_f32 v122, v40, v41
    v_cvt_pk_bf16_f32 v123, v42, v43
    s_nop 1
    v_mfma_f32_32x32x16_bf16 v[92:107], v[164:167], v[116:119], v[92:107]
    v_mfma_f32_32x32x16_bf16 v[92:107], v[168:171], v[120:123], v[92:107]
    v_sub_f32 v44, v44, v3
    v_sub_f32 v45, v45, v3
    v_sub_f32 v46, v46, v3
    v_sub_f32 v47, v47, v3
    v_sub_f32 v48, v48, v3
    v_sub_f32 v49, v49, v3
    v_sub_f32 v50, v50, v3
    v_sub_f32 v51, v51, v3
    v_sub_f32 v52, v52, v3
    v_sub_f32 v53, v53, v3
    v_sub_f32 v54, v54, v3
    v_sub_f32 v55, v55, v3
    v_sub_f32 v56, v56, v3
    v_sub_f32 v57, v57, v3
    v_sub_f32 v58, v58, v3
    v_sub_f32 v59, v59, v3
    v_exp_f32 v44, v44
    v_exp_f32 v45, v45
    v_exp_f32 v46, v46
    v_exp_f32 v47, v47
    v_exp_f32 v48, v48
    v_exp_f32 v49, v49
    v_exp_f32 v50, v50
    v_exp_f32 v51, v51
    v_exp_f32 v52, v52
    v_exp_f32 v53, v53
    v_exp_f32 v54, v54
    v_exp_f32 v55, v55
    v_exp_f32 v56, v56
    v_exp_f32 v57, v57
    v_exp_f32 v58, v58
    v_exp_f32 v59, v59
    v_cvt_pk_bf16_f32 v108, v44, v45
    v_cvt_pk_bf16_f32 v109, v46, v47
    v_cvt_pk_bf16_f32 v110, v48, v49
    v_cvt_pk_bf16_f32 v111, v50, v51
    v_cvt_pk_bf16_f32 v112, v52, v53
    v_cvt_pk_bf16_f32 v113, v54, v55
    v_cvt_pk_bf16_f32 v114, v56, v57
    v_cvt_pk_bf16_f32 v115, v58, v59
    s_nop 1
    v_mfma_f32_32x32x16_bf16 v[76:91], v[172:175], v[108:111], v[76:91]
    v_mfma_f32_32x32x16_bf16 v[76:91], v[176:179], v[112:115], v[76:91]
    v_sub_f32 v60, v60, v4
    v_sub_f32 v61, v61, v4
    v_sub_f32 v62, v62, v4
    v_sub_f32 v63, v63, v4
    v_sub_f32 v64, v64, v4
    v_sub_f32 v65, v65, v4
    v_sub_f32 v66, v66, v4
    v_sub_f32 v67, v67, v4
    v_sub_f32 v68, v68, v4
    v_sub_f32 v69, v69, v4
    v_sub_f32 v70, v70, v4
    v_sub_f32 v71, v71, v4
    v_sub_f32 v72, v72, v4
    v_sub_f32 v73, v73, v4
    v_sub_f32 v74, v74, v4
    v_sub_f32 v75, v75, v4
    v_exp_f32 v60, v60
    v_exp_f32 v61, v61
    v_exp_f32 v62, v62
    v_exp_f32 v63, v63
    v_exp_f32 v64, v64
    v_exp_f32 v65, v65
    v_exp_f32 v66, v66
    v_exp_f32 v67, v67
    v_exp_f32 v68, v68
    v_exp_f32 v69, v69
    v_exp_f32 v70, v70
    v_exp_f32 v71, v71
    v_exp_f32 v72, v72
    v_exp_f32 v73, v73
    v_exp_f32 v74, v74
    v_exp_f32 v75, v75
    v_cvt_pk_bf16_f32 v116, v60, v61
    v_cvt_pk_bf16_f32 v117, v62, v63
    v_cvt_pk_bf16_f32 v118, v64, v65
    v_cvt_pk_bf16_f32 v119, v66, v67
    v_cvt_pk_bf16_f32 v120, v68, v69
    v_cvt_pk_bf16_f32 v121, v70, v71
    v_cvt_pk_bf16_f32 v122, v72, v73
    v_cvt_pk_bf16_f32 v123, v74, v75
    s_nop 1
    v_mfma_f32_32x32x16_bf16 v[92:107], v[172:175], v[116:119], v[92:107]
    v_mfma_f32_32x32x16_bf16 v[92:107], v[176:179], v[120:123], v[92:107]
    s_sub_u32 s33, s33, 1
    s_cmp_lg_u32 s33, 0
    s_cbranch_scc1 LM_slow
    s_barrier
    s_mov_b32 exec_hi, 0xff
    s_add_u32 m0, s66, 0
    s_mov_b32 s29, 0
    buffer_load_dwordx4 v186, s[16:19], s29 offen lds
    s_mov_b32 exec_hi, -1
    s_mov_b32 exec_hi, 0xff
    s_add_u32 m0, s66, 640
    s_mov_b32 s29, 4608
    buffer_load_dwordx4 v186, s[16:19], s29 offen lds
    s_mov_b32 exec_hi, -1
    s_mov_b32 exec_hi, 0xff
    s_add_u32 m0, s66, 1280
    s_mov_b32 s29, 9216
    buffer_load_dwordx4 v186, s[16:19], s29 offen lds
    s_mov_b32 exec_hi, -1
    s_mov_b32 exec_hi, 0xff
    s_add_u32 m0, s66, 1920
    s_mov_b32 s29, 13824
    buffer_load_dwordx4 v186, s[16:19], s29 offen lds
    s_mov_b32 exec_hi, -1
    s_mov_b32 exec_hi, 0xff
    s_add_u32 m0, s67, 0
    s_mov_b32 s29, 18432
    buffer_load_dwordx4 v186, s[16:19], s29 offen lds
    s_mov_b32 exec_hi, -1
    s_mov_b32 exec_hi, 0xff
    s_add_u32 m0, s66, 2560
    s_mov_b32 s29, 23040
    buffer_load_dwordx4 v186, s[16:19], s29 offen lds
    s_mov_b32 exec_hi, -1
    s_mov_b32 exec_hi, 0xff
    s_add_u32 m0, s66, 3200
    s_mov_b32 s29, 27648
    buffer_load_dwordx4 v186, s[16:19], s29 offen lds
    s_mov_b32 exec_hi, -1
    s_mov_b32 exec_hi, 0xff
    s_add_u32 m0, s66, 3840
    s_mov_b32 s29, 32256
    buffer_load_dwordx4 v186, s[16:19], s29 offen lds
    s_mov_b32 exec_hi, -1
    s_mov_b32 exec_hi, 0xff
    s_add_u32 m0, s66, 4480
    s_mov_b32 s29, 36864
    buffer_load_dwordx4 v186, s[16:19], s29 offen lds
    s_mov_b32 exec_hi, -1
    s_mov_b32 exec_hi, 0xff
    s_add_u32 m0, s66, 5120
    s_mov_b32 s29, 41472
    buffer_load_dwordx4 v186, s[16:19], s29 offen lds
    s_mov_b32 exec_hi, -1
    s_mov_b32 exec_hi, 0xff
    s_add_u32 m0, s66, 5760
    s_mov_b32 s29, 46080
    buffer_load_dwordx4 v186, s[16:19], s29 offen lds
    s_mov_b32 exec_hi, -1
    s_mov_b32 exec_hi, 0xff
    s_add_u32 m0, s66, 6400
    s_mov_b32 s29, 50688
    buffer_load_dwordx4 v186, s[16:19], s29 offen lds
    s_mov_b32 exec_hi, -1
    s_mov_b32 exec_hi, 0xff
    s_add_u32 m0, s66, 7040
    s_mov_b32 s29, 55296
    buffer_load_dwordx4 v186, s[16:19], s29 offen lds
    s_mov_b32 exec_hi, -1
    s_mov_b32 exec_hi, 0xff
    s_add_u32 m0, s67, 640
    s_mov_b32 s29, 59904
    buffer_load_dwordx4 v186, s[16:19], s29 offen lds
    s_mov_b32 exec_hi, -1
    s_mov_b32 exec_hi, 0xff
    s_add_u32 m0, s66, 7680
    s_mov_b32 s29, 64512
    buffer_load_dwordx4 v186, s[16:19], s29 offen lds
    s_mov_b32 exec_hi, -1
    s_mov_b32 exec_hi, 0xff
    s_add_u32 m0, s66, 8320
    s_mov_b32 s29, 69120
    buffer_load_dwordx4 v186, s[16:19], s29 offen lds
    s_mov_b32 exec_hi, -1
    s_mov_b32 exec_hi, 0xff
    s_add_u32 m0, s66, 8960
    s_mov_b32 s29, 73728
    buffer_load_dwordx4 v186, s[16:19], s29 offen lds
    s_mov_b32 exec_hi, -1
    s_mov_b32 exec_hi, 0xff
    s_add_u32 m0, s66, 9600
    s_mov_b32 s29, 78336
    buffer_load_dwordx4 v186, s[16:19], s29 offen lds
    s_mov_b32 exec_hi, -1
    s_mul_i32 s29, s24, 288
    s_add_u32 m0, s29, 157696
    s_add_u32 s29, s29, 54534144
    s_mov_b64 exec, 0x3ffff
    buffer_load_dwordx4 v5, s[12:15], s29 offen sc1 lds
    s_mov_b64 exec, -1
    s_branch LM_bend
LM_retry5:
    s_cmp_lt_i32 s60, 1
    s_cbranch_scc1 LM_ok5
    s_sub_u32 s60, s60, 1
    s_and_b32 s29, s27, 7
    s_lshl_b64 exec, 1, s29
    v_mov_b32 v4, 0
    buffer_atomic_or v4, v8, s[12:15], s8 offen sc0 sc1
    s_mov_b64 exec, -1
    s_waitcnt vmcnt(0)
    s_branch LM_chk5
LM_retry8:
    s_cmp_lt_i32 s60, 1
    s_cbranch_scc1 LM_ok8
    s_sub_u32 s60, s60, 1
    s_and_b32 s29, s27, 7
    s_lshl_b64 exec, 1, s29
    v_mov_b32 v4, 0
    buffer_atomic_or v4, v8, s[12:15], s65 offen sc0 sc1
    s_mov_b64 exec, -1
    s_waitcnt vmcnt(0)
    s_branch LM_chk8
LM_retry11:
    s_cmp_lt_i32 s60, 1
    s_cbranch_scc1 LM_ok11
    s_sub_u32 s60, s60, 1
    s_and_b32 s29, s27, 7
    s_lshl_b64 exec, 1, s29
    v_mov_b32 v13, 0
    buffer_atomic_or v13, v8, s[12:15], s66 offen sc0 sc1
    s_mov_b64 exec, -1
    s_waitcnt vmcnt(0)
    s_branch LM_chk11
LM_retry14:
    s_cmp_lt_i32 s60, 1
    s_cbranch_scc1 LM_ok14
    s_sub_u32 s60, s60, 1
    s_and_b32 s29, s27, 7
    s_lshl_b64 exec, 1, s29
    v_mov_b32 v13, 0
    buffer_atomic_or v13, v8, s[12:15], s67 offen sc0 sc1
    s_mov_b64 exec, -1
    s_waitcnt vmcnt(0)
    s_branch LM_chk14
LM_done:
L_exit:
    s_endpgm
.section .rodata,"a"
.p2align 6
.amdhsa_kernel sequential_preLN__softmax_full_mha__glu_gated_bilinear__prompt_kernel
  .amdhsa_next_free_vgpr 256
  .amdhsa_next_free_sgpr 70
  .amdhsa_accum_offset 256
  .amdhsa_group_segment_fixed_size 0
  .amdhsa_kernarg_size 80
  .amdhsa_user_sgpr_count 2
  .amdhsa_user_sgpr_kernarg_segment_ptr 1
  .amdhsa_system_sgpr_workgroup_id_x 1
.end_amdhsa_kernel
```
